```python
import torch

def _softmax(x, axis=-1):
    return torch.softmax(x, dim=axis)
def _gelu(x):
    return torch.nn.functional.gelu(x, approximate="tanh")
def _silu(x):
    return torch.nn.functional.silu(x)
def _sigmoid(x):
    return torch.sigmoid(x)
def _layernorm(x, axis=-1, eps=1e-5):
    m = x.mean(dim=axis, keepdim=True)
    v = x.var(dim=axis, keepdim=True, unbiased=False)
    return (x - m) / torch.sqrt(v + eps)
def _scatter_add(tgt, idx, src, axis=0):
    return tgt.clone().index_add_(axis, idx, src)
def _segment_sum(src, seg, n):
    out = torch.zeros((n,) + src.shape[1:], dtype=src.dtype)
    return out.index_add_(0, seg, src)
def _pad(x, pw):
    flat = tuple(v for pair in reversed(pw) for v in pair)
    return torch.nn.functional.pad(x, flat)

kernel_name = 'interleave_layers__linear_kernel_hedgehog__dense_activation_gelu__prompt'

def setup_inputs():

    _w = (lambda a: (lambda t: t.to(torch.bfloat16) if t.is_floating_point() else t)(torch.as_tensor(a)))
    def _A_setup():
        B, S, D, H = 1, 2048, 448, 16
        Dh = D // H
        return {
            "x": _w((lambda *s: torch.randn(*s, dtype=torch.bfloat16) * 0.05)(B, S, D)),
            "wqkv": _w((lambda *s: torch.randn(*s, dtype=torch.bfloat16) * 0.4)(D, 3 * D)),
            "w_phi": _w((lambda *s: torch.randn(*s, dtype=torch.bfloat16) * 0.4)(H, Dh, Dh) * (Dh ** -0.5)),
            "wo": _w((lambda *s: torch.randn(*s, dtype=torch.bfloat16) * 0.05)(D, D)),
        }
    _A_in = _A_setup()

    def _B_setup():
        B, S, D, F = 1, 2048, 448, 1792
        return {
            "x": _w((lambda *s: torch.randn(*s, dtype=torch.bfloat16) * 0.05)(B, S, D)),
            "w1": _w((lambda *s: torch.randn(*s, dtype=torch.bfloat16) * 1.6)(D, F) * (D ** -0.5)),
            "b1": _w((lambda *s: torch.randn(*s, dtype=torch.bfloat16) * 1.6)(F) * 0.01),
            "w2": _w((lambda *s: torch.randn(*s, dtype=torch.bfloat16) * 1.6)(F, D) * (F ** -0.5)),
            "b2": _w((lambda *s: torch.randn(*s, dtype=torch.bfloat16) * 1.6)(D) * 0.01),
        }
    _B_in = _B_setup()

    return {
        "A_x": _A_in["x"],
        "A_wqkv": _A_in["wqkv"],
        "A_w_phi": _A_in["w_phi"],
        "A_wo": _A_in["wo"],
        "B_x": _B_in["x"],
        "B_w1": _B_in["w1"],
        "B_b1": _B_in["b1"],
        "B_w2": _B_in["w2"],
        "B_b2": _B_in["b2"],
    }

def reference(A_x, A_wqkv, A_w_phi, A_wo, B_x, B_w1, B_b1, B_w2, B_b2):
    def _A_ref(x, wqkv, w_phi, wo):
        B, S, D = x.shape
        H = 16; Dh = D // H
        qkv = (lambda x, *d: x.permute(*d))((x @ wqkv).reshape(B, S, 3, H, Dh), 2, 0, 3, 1, 4)
        q, k, v = qkv[0], qkv[1], qkv[2]
        pq = torch.einsum("bhsd,hdf->bhsf", q, w_phi)
        pk = torch.einsum("bhsd,hdf->bhsf", k, w_phi)
        phi_q = torch.concatenate([_softmax(pq, axis=-1), _softmax(-pq, axis=-1)], axis=-1)
        phi_k = torch.concatenate([_softmax(pk, axis=-1), _softmax(-pk, axis=-1)], axis=-1)
        kv = torch.einsum("bhsf,bhsd->bhfd", phi_k, v)
        z  = torch.einsum("bhsf->bhf", phi_k)
        num = torch.einsum("bhqf,bhfd->bhqd", phi_q, kv)
        den = torch.einsum("bhqf,bhf->bhq", phi_q, z)[..., None] + 1e-6
        o = num / den
        return (lambda x, *d: x.permute(*d))(o, 0, 2, 1, 3).reshape(B, S, D) @ wo

    def _B_ref(x, w1, b1, w2, b2):
        h = torch.einsum("bsd,df->bsf", x, w1) + b1
        h = _gelu(h)
        return torch.einsum("bsf,fd->bsd", h, w2) + b2

    x = A_x
    x = x + _A_ref(_layernorm(x, axis=-1), A_wqkv, A_w_phi, A_wo)
    x = x + _B_ref(_layernorm(x, axis=-1), B_w1, B_b1, B_w2, B_b2)
    x = x + _A_ref(_layernorm(x, axis=-1), A_wqkv, A_w_phi, A_wo)
    x = x + _B_ref(_layernorm(x, axis=-1), B_w1, B_b1, B_w2, B_b2)
    return x
```

```asm
; @launch kernel=k1a_kernel grid=(256,1,1) block=(512,1,1) lds=125952
; @launch kernel=k2a_kernel grid=(252,1,1) block=(512,1,1) lds=131072
; @launch kernel=k3a_kernel grid=(224,1,1) block=(512,1,1) lds=114688
; @launch kernel=k4a_kernel grid=(237,1,1) block=(512,1,1) lds=131072
; @launch kernel=k1b_kernel grid=(256,1,1) block=(512,1,1) lds=125952
; @launch kernel=k2b_kernel grid=(224,1,1) block=(512,1,1) lds=131072
; @launch kernel=k3b_kernel grid=(224,1,1) block=(512,1,1) lds=114688
; @launch kernel=k4b_kernel grid=(224,1,1) block=(512,1,1) lds=131072
.amdgcn_target "amdgcn-amd-amdhsa--gfx950"
.text
.globl k1a_kernel
.p2align 8
.type k1a_kernel,@function
k1a_kernel:
    s_cmp_ge_u32 s2, 256
    s_cbranch_scc1 L_end_k1a_kernel
    s_load_dwordx2 s[4:5], s[0:1], 88
    s_load_dwordx2 s[16:17], s[0:1], 80
    s_load_dwordx2 s[12:13], s[0:1], 8
    s_load_dwordx2 s[32:33], s[0:1], 16
    s_load_dwordx2 s[36:37], s[0:1], 0
    s_load_dwordx2 s[96:97], s[0:1], 24
    v_and_b32 v1, 63, v0
    v_lshrrev_b32 v2, 6, v0
    s_nop 0
    v_readfirstlane_b32 s20, v2
    v_and_b32 v3, 15, v1
    v_lshrrev_b32 v4, 4, v1
    v_lshlrev_b32 v5, 4, v1
    s_waitcnt lgkmcnt(0)
    s_mov_b32 s8, s4
    s_and_b32 s9, s5, 65535
    s_mov_b32 s10, 268435456
    s_mov_b32 s11, 131072
    s_and_b32 s17, s17, 65535
    s_mov_b32 s18, 256
    s_mov_b32 s19, 131072
    s_and_b32 s13, s13, 65535
    s_mov_b32 s14, 1204224
    s_mov_b32 s15, 131072
    s_and_b32 s33, s33, 65535
    s_mov_b32 s34, 25088
    s_mov_b32 s35, 131072
    s_and_b32 s37, s37, 65535
    s_mov_b32 s38, 1835008
    s_mov_b32 s39, 131072
    s_and_b32 s97, s97, 65535
    s_mov_b32 s98, 401408
    s_mov_b32 s99, 131072
    s_and_b32 s26, s2, 7
    s_lshr_b32 s27, s2, 3
    s_lshr_b32 s21, s26, 1
    s_lshl_b32 s21, s21, 2
    s_lshr_b32 s28, s27, 3
    s_add_u32 s21, s21, s28
    s_and_b32 s22, s26, 1
    s_lshl_b32 s22, s22, 3
    s_and_b32 s28, s27, 7
    s_add_u32 s22, s22, s28
    s_lshl_b32 s23, s21, 3
    s_add_u32 s23, s23, s20
    s_mul_i32 s26, s23, 14336
    v_mul_u32_u24 v9, 147, v1
    v_lshrrev_b32 v9, 11, v9
    v_mul_u32_u24 v10, 14, v9
    v_sub_u32 v10, v1, v10
    v_mul_u32_u24 v6, 2688, v9
    v_lshrrev_b32 v9, 2, v10
    v_mul_u32_u24 v9, 896, v9
    v_add_u32 v6, v6, v9
    v_and_b32 v9, 3, v10
    v_lshl_add_u32 v6, v9, 4, v6
    v_cmp_gt_u32 vcc, 12, v10
    v_mov_b32 v9, 1073741824
    s_nop 0
    v_cndmask_b32 v6, v9, v6, vcc
    s_mul_i32 s24, s20, 10752
    s_mul_i32 s27, s22, 56
    s_add_u32 s24, s24, s27
    s_mul_i32 s25, s20, 896
    s_mov_b32 s58, -1
    s_mov_b32 s59, 16777215
    v_mul_u32_u24 v7, 896, v3
    v_lshl_add_u32 v7, v4, 4, v7
    v_mov_b32 v15, 0
    s_lshl_b32 s31, s22, 2
    s_or_b32 s56, s20, s21
    s_cmp_lg_u32 s56, 0
    s_cbranch_scc1 L_noclaim_k1a_kernel
    v_mov_b32 v120, 0
    v_mov_b32 v121, 0
    v_mov_b32 v122, 0
    v_mov_b32 v123, 0
    s_lshl_b32 s27, s22, 13
    s_add_u32 s27, s27, 20971520
    buffer_store_dwordx4 v[120:123], v5, s[8:11], s27 offen offset:0 sc1
    buffer_store_dwordx4 v[120:123], v5, s[8:11], s27 offen offset:1024 sc1
    buffer_store_dwordx4 v[120:123], v5, s[8:11], s27 offen offset:2048 sc1
    buffer_store_dwordx4 v[120:123], v5, s[8:11], s27 offen offset:3072 sc1
    s_add_u32 s27, s27, 4096
    buffer_store_dwordx4 v[120:123], v5, s[8:11], s27 offen offset:0 sc1
    buffer_store_dwordx4 v[120:123], v5, s[8:11], s27 offen offset:1024 sc1
    buffer_store_dwordx4 v[120:123], v5, s[8:11], s27 offen offset:2048 sc1
    buffer_store_dwordx4 v[120:123], v5, s[8:11], s27 offen offset:3072 sc1
    s_nop 4
L_noclaim_k1a_kernel:
    s_add_u32 s28, s25, 0
    s_mov_b32 m0, s28
    s_add_u32 s27, s24, 0
    s_mov_b64 exec, s[58:59]
    buffer_load_dwordx4 v6, s[12:15], s27 offen lds
    s_mov_b64 exec, -1
    buffer_load_dwordx4 v[16:19], v7, s[36:39], s26 offen offset:0
    s_add_u32 s28, s25, 7168
    s_mov_b32 m0, s28
    s_add_u32 s27, s24, 86016
    s_mov_b64 exec, s[58:59]
    buffer_load_dwordx4 v6, s[12:15], s27 offen lds
    s_mov_b64 exec, -1
    buffer_load_dwordx4 v[20:23], v7, s[36:39], s26 offen offset:64
    s_add_u32 s28, s25, 14336
    s_mov_b32 m0, s28
    s_add_u32 s27, s24, 172032
    s_mov_b64 exec, s[58:59]
    buffer_load_dwordx4 v6, s[12:15], s27 offen lds
    s_mov_b64 exec, -1
    buffer_load_dwordx4 v[24:27], v7, s[36:39], s26 offen offset:128
    s_add_u32 s28, s25, 21504
    s_mov_b32 m0, s28
    s_add_u32 s27, s24, 258048
    s_mov_b64 exec, s[58:59]
    buffer_load_dwordx4 v6, s[12:15], s27 offen lds
    s_mov_b64 exec, -1
    buffer_load_dwordx4 v[28:31], v7, s[36:39], s26 offen offset:192
    s_add_u32 s28, s25, 28672
    s_mov_b32 m0, s28
    s_add_u32 s27, s24, 344064
    s_mov_b64 exec, s[58:59]
    buffer_load_dwordx4 v6, s[12:15], s27 offen lds
    s_mov_b64 exec, -1
    buffer_load_dwordx4 v[32:35], v7, s[36:39], s26 offen offset:256
    s_add_u32 s28, s25, 35840
    s_mov_b32 m0, s28
    s_add_u32 s27, s24, 430080
    s_mov_b64 exec, s[58:59]
    buffer_load_dwordx4 v6, s[12:15], s27 offen lds
    s_mov_b64 exec, -1
    buffer_load_dwordx4 v[36:39], v7, s[36:39], s26 offen offset:320
    v_mul_u32_u24 v240, 224, v4
    v_lshl_add_u32 v240, v3, 1, v240
    v_add_u32 v241, 896, v240
    v_cmp_gt_u32 vcc, 3, v4
    s_nop 1
    v_cndmask_b32 v241, v9, v241, vcc
    v_add_u32 v242, 32, v240
    v_add_u32 v243, 32, v241
    v_cmp_gt_u32 vcc, 12, v3
    s_nop 1
    v_cndmask_b32 v242, v9, v242, vcc
    v_cndmask_b32 v243, v9, v243, vcc
    s_mul_i32 s30, s22, 1568
    s_cmp_ge_u32 s2, 224
    s_cbranch_scc1 L_nowo_k1a_kernel
    s_cmp_ge_u32 s20, 2
    s_cbranch_scc1 L_nowo_k1a_kernel
    s_lshl_b32 s27, s2, 1
    s_add_u32 s27, s27, s20
    s_lshr_b32 s28, s27, 4
    s_and_b32 s29, s27, 15
    s_lshl_b32 s28, s28, 5
    s_mul_i32 s29, s29, 25088
    s_add_u32 s28, s28, s29
    v_mul_u32_u24 v244, 3584, v4
    v_lshl_add_u32 v244, v3, 1, v244
    v_add_u32 v245, 14336, v244
    v_cmp_gt_u32 vcc, 3, v4
    s_nop 1
    v_cndmask_b32 v245, v9, v245, vcc
    s_add_u32 s29, s28, 0
    buffer_load_ushort v246, v244, s[96:99], s29 offen
    s_add_u32 s29, s28, 896
    buffer_load_ushort v247, v244, s[96:99], s29 offen
    s_add_u32 s29, s28, 1792
    buffer_load_ushort v248, v244, s[96:99], s29 offen
    s_add_u32 s29, s28, 2688
    buffer_load_ushort v249, v244, s[96:99], s29 offen
    s_add_u32 s29, s28, 0
    buffer_load_ushort v250, v245, s[96:99], s29 offen
    s_add_u32 s29, s28, 896
    buffer_load_ushort v251, v245, s[96:99], s29 offen
    s_add_u32 s29, s28, 1792
    buffer_load_ushort v252, v245, s[96:99], s29 offen
    s_add_u32 s29, s28, 2688
    buffer_load_ushort v253, v245, s[96:99], s29 offen
    s_waitcnt vmcnt(6)
    v_lshl_or_b32 v180, v247, 16, v246
    s_waitcnt vmcnt(4)
    v_lshl_or_b32 v181, v249, 16, v248
    s_waitcnt vmcnt(2)
    v_lshl_or_b32 v182, v251, 16, v250
    s_waitcnt vmcnt(0)
    v_lshl_or_b32 v183, v253, 16, v252
    s_lshl_b32 s27, s27, 10
    s_add_u32 s27, s27, 24182784
    buffer_store_dwordx4 v[180:183], v5, s[8:11], s27 offen
    s_nop 4
L_nowo_k1a_kernel:
    v_mov_b32 v152, 1065369472
    v_mov_b32 v153, 1065369472
    v_mov_b32 v154, 1065369472
    v_mov_b32 v155, 1065369472
    v_and_b32 v12, 3, v3
    v_lshrrev_b32 v13, 2, v3
    v_cmp_eq_u32 s[40:41], 1, v12
    v_cmp_eq_u32 s[42:43], 2, v12
    v_cmp_eq_u32 s[44:45], 3, v12
    v_cmp_eq_u32 s[46:47], v4, v13
    v_cmp_eq_u32 s[48:49], 3, v4
    v_cmp_eq_u32 s[50:51], 12, v3
    v_cmp_le_u32 s[52:53], 12, v3
    v_and_b32 v10, 1, v4
    v_cmp_eq_u32 s[94:95], 1, v10
    v_lshl_add_u32 v8, v4, 3, v13
    v_lshl_add_u32 v254, v10, 2, v8
    v_xor_b32 v10, 1, v10
    v_lshl_add_u32 v255, v10, 2, v8
    v_mul_u32_u24 v8, 224, v254
    v_lshl_add_u32 v8, v12, 3, v8
    v_mul_u32_u24 v11, 224, v255
    v_lshl_add_u32 v11, v12, 3, v11
    v_add_u32 v254, 57344, v8
    v_add_u32 v255, 57344, v11
    s_waitcnt vmcnt(8)
    s_barrier
    s_cmp_lg_u32 s56, 0
    s_cbranch_scc1 L_nozero_k1a_kernel
    s_mov_b64 exec, 1
    v_mov_b32 v14, 1
    buffer_store_dword v14, v15, s[16:19], s31 offen offset:64 sc1
    s_mov_b64 exec, -1
    s_nop 4
L_nozero_k1a_kernel:
    ds_read_b64_tr_b16 v[72:73], v8 offset:0
    ds_read_b64_tr_b16 v[74:75], v11 offset:0
    ds_read_b64_tr_b16 v[76:77], v8 offset:32
    ds_read_b64_tr_b16 v[78:79], v11 offset:32
    ds_read_b64_tr_b16 v[80:81], v8 offset:64
    ds_read_b64_tr_b16 v[82:83], v11 offset:64
    ds_read_b64_tr_b16 v[84:85], v8 offset:96
    ds_read_b64_tr_b16 v[86:87], v11 offset:96
    ds_read_b64_tr_b16 v[88:89], v8 offset:128
    ds_read_b64_tr_b16 v[90:91], v11 offset:128
    ds_read_b64_tr_b16 v[92:93], v8 offset:160
    ds_read_b64_tr_b16 v[94:95], v11 offset:160
    ds_read_b64_tr_b16 v[96:97], v8 offset:7168
    ds_read_b64_tr_b16 v[98:99], v11 offset:7168
    ds_read_b64_tr_b16 v[100:101], v8 offset:7200
    ds_read_b64_tr_b16 v[102:103], v11 offset:7200
    ds_read_b64_tr_b16 v[104:105], v8 offset:7232
    ds_read_b64_tr_b16 v[106:107], v11 offset:7232
    ds_read_b64_tr_b16 v[108:109], v8 offset:7264
    ds_read_b64_tr_b16 v[110:111], v11 offset:7264
    ds_read_b64_tr_b16 v[112:113], v8 offset:7296
    ds_read_b64_tr_b16 v[114:115], v11 offset:7296
    ds_read_b64_tr_b16 v[116:117], v8 offset:7328
    ds_read_b64_tr_b16 v[118:119], v11 offset:7328
    v_mov_b32 v9, v16
    v_mov_b32 v10, v17
    v_cndmask_b32 v16, v16, v18, s[94:95]
    v_cndmask_b32 v17, v17, v19, s[94:95]
    v_cndmask_b32 v18, v18, v9, s[94:95]
    v_cndmask_b32 v19, v19, v10, s[94:95]
    s_nop 1
    v_mfma_f32_16x16x32_bf16 v[144:147], v[152:155], v[16:19], 0
    v_mfma_f32_16x16x32_bf16 v[148:151], v[16:19], v[16:19], 0
    s_add_u32 s28, s25, 43008
    s_mov_b32 m0, s28
    s_add_u32 s27, s24, 516096
    s_mov_b64 exec, s[58:59]
    buffer_load_dwordx4 v6, s[12:15], s27 offen lds
    s_mov_b64 exec, -1
    s_waitcnt lgkmcnt(15)
    v_mfma_f32_16x16x32_bf16 v[120:123], v[72:75], v[16:19], 0
    v_mfma_f32_16x16x32_bf16 v[156:159], v[72:75], v[152:155], 0
    v_mfma_f32_16x16x32_bf16 v[124:127], v[76:79], v[16:19], 0
    v_mfma_f32_16x16x32_bf16 v[160:163], v[76:79], v[152:155], 0
    buffer_load_dwordx4 v[40:43], v7, s[36:39], s26 offen offset:384
    v_mfma_f32_16x16x32_bf16 v[128:131], v[80:83], v[16:19], 0
    v_mfma_f32_16x16x32_bf16 v[164:167], v[80:83], v[152:155], 0
    v_mfma_f32_16x16x32_bf16 v[132:135], v[84:87], v[16:19], 0
    v_mfma_f32_16x16x32_bf16 v[168:171], v[84:87], v[152:155], 0
    s_waitcnt lgkmcnt(14)
    v_mfma_f32_16x16x32_bf16 v[136:139], v[16:19], v[88:91], 0
    v_mfma_f32_16x16x32_bf16 v[172:175], v[152:155], v[88:91], 0
    s_waitcnt lgkmcnt(12)
    v_mfma_f32_16x16x32_bf16 v[140:143], v[16:19], v[92:95], 0
    v_mfma_f32_16x16x32_bf16 v[176:179], v[152:155], v[92:95], 0
    v_mov_b32 v9, v20
    v_mov_b32 v10, v21
    v_cndmask_b32 v20, v20, v22, s[94:95]
    v_cndmask_b32 v21, v21, v23, s[94:95]
    v_cndmask_b32 v22, v22, v9, s[94:95]
    v_cndmask_b32 v23, v23, v10, s[94:95]
    s_nop 1
    v_mfma_f32_16x16x32_bf16 v[144:147], v[152:155], v[20:23], v[144:147]
    v_mfma_f32_16x16x32_bf16 v[148:151], v[20:23], v[20:23], v[148:151]
    s_add_u32 s28, s25, 50176
    s_mov_b32 m0, s28
    s_add_u32 s27, s24, 602112
    s_mov_b64 exec, s[58:59]
    buffer_load_dwordx4 v6, s[12:15], s27 offen lds
    s_mov_b64 exec, -1
    s_waitcnt lgkmcnt(10)
    v_mfma_f32_16x16x32_bf16 v[120:123], v[96:99], v[20:23], v[120:123]
    v_mfma_f32_16x16x32_bf16 v[156:159], v[96:99], v[152:155], v[156:159]
    s_waitcnt lgkmcnt(8)
    v_mfma_f32_16x16x32_bf16 v[124:127], v[100:103], v[20:23], v[124:127]
    v_mfma_f32_16x16x32_bf16 v[160:163], v[100:103], v[152:155], v[160:163]
    buffer_load_dwordx4 v[44:47], v7, s[36:39], s26 offen offset:448
    s_waitcnt lgkmcnt(6)
    v_mfma_f32_16x16x32_bf16 v[128:131], v[104:107], v[20:23], v[128:131]
    v_mfma_f32_16x16x32_bf16 v[164:167], v[104:107], v[152:155], v[164:167]
    s_waitcnt lgkmcnt(4)
    v_mfma_f32_16x16x32_bf16 v[132:135], v[108:111], v[20:23], v[132:135]
    v_mfma_f32_16x16x32_bf16 v[168:171], v[108:111], v[152:155], v[168:171]
    s_waitcnt lgkmcnt(2)
    v_mfma_f32_16x16x32_bf16 v[136:139], v[20:23], v[112:115], v[136:139]
    v_mfma_f32_16x16x32_bf16 v[172:175], v[152:155], v[112:115], v[172:175]
    s_waitcnt lgkmcnt(0)
    v_mfma_f32_16x16x32_bf16 v[140:143], v[20:23], v[116:119], v[140:143]
    v_mfma_f32_16x16x32_bf16 v[176:179], v[152:155], v[116:119], v[176:179]
    s_waitcnt vmcnt(8)
    s_barrier
    ds_read_b64_tr_b16 v[72:73], v8 offset:14336
    ds_read_b64_tr_b16 v[74:75], v11 offset:14336
    ds_read_b64_tr_b16 v[76:77], v8 offset:14368
    ds_read_b64_tr_b16 v[78:79], v11 offset:14368
    ds_read_b64_tr_b16 v[80:81], v8 offset:14400
    ds_read_b64_tr_b16 v[82:83], v11 offset:14400
    ds_read_b64_tr_b16 v[84:85], v8 offset:14432
    ds_read_b64_tr_b16 v[86:87], v11 offset:14432
    ds_read_b64_tr_b16 v[88:89], v8 offset:14464
    ds_read_b64_tr_b16 v[90:91], v11 offset:14464
    ds_read_b64_tr_b16 v[92:93], v8 offset:14496
    ds_read_b64_tr_b16 v[94:95], v11 offset:14496
    ds_read_b64_tr_b16 v[96:97], v8 offset:21504
    ds_read_b64_tr_b16 v[98:99], v11 offset:21504
    ds_read_b64_tr_b16 v[100:101], v8 offset:21536
    ds_read_b64_tr_b16 v[102:103], v11 offset:21536
    ds_read_b64_tr_b16 v[104:105], v8 offset:21568
    ds_read_b64_tr_b16 v[106:107], v11 offset:21568
    ds_read_b64_tr_b16 v[108:109], v8 offset:21600
    ds_read_b64_tr_b16 v[110:111], v11 offset:21600
    ds_read_b64_tr_b16 v[112:113], v8 offset:21632
    ds_read_b64_tr_b16 v[114:115], v11 offset:21632
    ds_read_b64_tr_b16 v[116:117], v8 offset:21664
    ds_read_b64_tr_b16 v[118:119], v11 offset:21664
    v_mov_b32 v9, v24
    v_mov_b32 v10, v25
    v_cndmask_b32 v24, v24, v26, s[94:95]
    v_cndmask_b32 v25, v25, v27, s[94:95]
    v_cndmask_b32 v26, v26, v9, s[94:95]
    v_cndmask_b32 v27, v27, v10, s[94:95]
    s_nop 1
    v_mfma_f32_16x16x32_bf16 v[144:147], v[152:155], v[24:27], v[144:147]
    v_mfma_f32_16x16x32_bf16 v[148:151], v[24:27], v[24:27], v[148:151]
    s_add_u32 s28, s25, 57344
    s_mov_b32 m0, s28
    s_add_u32 s27, s24, 688128
    s_mov_b64 exec, s[58:59]
    buffer_load_dwordx4 v6, s[12:15], s27 offen lds
    s_mov_b64 exec, -1
    s_waitcnt lgkmcnt(15)
    v_mfma_f32_16x16x32_bf16 v[120:123], v[72:75], v[24:27], v[120:123]
    v_mfma_f32_16x16x32_bf16 v[156:159], v[72:75], v[152:155], v[156:159]
    v_mfma_f32_16x16x32_bf16 v[124:127], v[76:79], v[24:27], v[124:127]
    v_mfma_f32_16x16x32_bf16 v[160:163], v[76:79], v[152:155], v[160:163]
    buffer_load_dwordx4 v[48:51], v7, s[36:39], s26 offen offset:512
    v_mfma_f32_16x16x32_bf16 v[128:131], v[80:83], v[24:27], v[128:131]
    v_mfma_f32_16x16x32_bf16 v[164:167], v[80:83], v[152:155], v[164:167]
    v_mfma_f32_16x16x32_bf16 v[132:135], v[84:87], v[24:27], v[132:135]
    v_mfma_f32_16x16x32_bf16 v[168:171], v[84:87], v[152:155], v[168:171]
    s_waitcnt lgkmcnt(14)
    v_mfma_f32_16x16x32_bf16 v[136:139], v[24:27], v[88:91], v[136:139]
    v_mfma_f32_16x16x32_bf16 v[172:175], v[152:155], v[88:91], v[172:175]
    s_waitcnt lgkmcnt(12)
    v_mfma_f32_16x16x32_bf16 v[140:143], v[24:27], v[92:95], v[140:143]
    v_mfma_f32_16x16x32_bf16 v[176:179], v[152:155], v[92:95], v[176:179]
    v_mov_b32 v9, v28
    v_mov_b32 v10, v29
    v_cndmask_b32 v28, v28, v30, s[94:95]
    v_cndmask_b32 v29, v29, v31, s[94:95]
    v_cndmask_b32 v30, v30, v9, s[94:95]
    v_cndmask_b32 v31, v31, v10, s[94:95]
    s_nop 1
    v_mfma_f32_16x16x32_bf16 v[144:147], v[152:155], v[28:31], v[144:147]
    v_mfma_f32_16x16x32_bf16 v[148:151], v[28:31], v[28:31], v[148:151]
    s_add_u32 s28, s25, 64512
    s_mov_b32 m0, s28
    s_add_u32 s27, s24, 774144
    s_mov_b64 exec, s[58:59]
    buffer_load_dwordx4 v6, s[12:15], s27 offen lds
    s_mov_b64 exec, -1
    s_waitcnt lgkmcnt(10)
    v_mfma_f32_16x16x32_bf16 v[120:123], v[96:99], v[28:31], v[120:123]
    v_mfma_f32_16x16x32_bf16 v[156:159], v[96:99], v[152:155], v[156:159]
    s_waitcnt lgkmcnt(8)
    v_mfma_f32_16x16x32_bf16 v[124:127], v[100:103], v[28:31], v[124:127]
    v_mfma_f32_16x16x32_bf16 v[160:163], v[100:103], v[152:155], v[160:163]
    buffer_load_dwordx4 v[52:55], v7, s[36:39], s26 offen offset:576
    s_waitcnt lgkmcnt(6)
    v_mfma_f32_16x16x32_bf16 v[128:131], v[104:107], v[28:31], v[128:131]
    v_mfma_f32_16x16x32_bf16 v[164:167], v[104:107], v[152:155], v[164:167]
    s_waitcnt lgkmcnt(4)
    v_mfma_f32_16x16x32_bf16 v[132:135], v[108:111], v[28:31], v[132:135]
    v_mfma_f32_16x16x32_bf16 v[168:171], v[108:111], v[152:155], v[168:171]
    s_waitcnt lgkmcnt(2)
    v_mfma_f32_16x16x32_bf16 v[136:139], v[28:31], v[112:115], v[136:139]
    v_mfma_f32_16x16x32_bf16 v[172:175], v[152:155], v[112:115], v[172:175]
    s_waitcnt lgkmcnt(0)
    v_mfma_f32_16x16x32_bf16 v[140:143], v[28:31], v[116:119], v[140:143]
    v_mfma_f32_16x16x32_bf16 v[176:179], v[152:155], v[116:119], v[176:179]
    s_waitcnt vmcnt(8)
    s_barrier
    ds_read_b64_tr_b16 v[72:73], v8 offset:28672
    ds_read_b64_tr_b16 v[74:75], v11 offset:28672
    ds_read_b64_tr_b16 v[76:77], v8 offset:28704
    ds_read_b64_tr_b16 v[78:79], v11 offset:28704
    ds_read_b64_tr_b16 v[80:81], v8 offset:28736
    ds_read_b64_tr_b16 v[82:83], v11 offset:28736
    ds_read_b64_tr_b16 v[84:85], v8 offset:28768
    ds_read_b64_tr_b16 v[86:87], v11 offset:28768
    ds_read_b64_tr_b16 v[88:89], v8 offset:28800
    ds_read_b64_tr_b16 v[90:91], v11 offset:28800
    ds_read_b64_tr_b16 v[92:93], v8 offset:28832
    ds_read_b64_tr_b16 v[94:95], v11 offset:28832
    ds_read_b64_tr_b16 v[96:97], v8 offset:35840
    ds_read_b64_tr_b16 v[98:99], v11 offset:35840
    ds_read_b64_tr_b16 v[100:101], v8 offset:35872
    ds_read_b64_tr_b16 v[102:103], v11 offset:35872
    ds_read_b64_tr_b16 v[104:105], v8 offset:35904
    ds_read_b64_tr_b16 v[106:107], v11 offset:35904
    ds_read_b64_tr_b16 v[108:109], v8 offset:35936
    ds_read_b64_tr_b16 v[110:111], v11 offset:35936
    ds_read_b64_tr_b16 v[112:113], v8 offset:35968
    ds_read_b64_tr_b16 v[114:115], v11 offset:35968
    ds_read_b64_tr_b16 v[116:117], v8 offset:36000
    ds_read_b64_tr_b16 v[118:119], v11 offset:36000
    v_mov_b32 v9, v32
    v_mov_b32 v10, v33
    v_cndmask_b32 v32, v32, v34, s[94:95]
    v_cndmask_b32 v33, v33, v35, s[94:95]
    v_cndmask_b32 v34, v34, v9, s[94:95]
    v_cndmask_b32 v35, v35, v10, s[94:95]
    s_nop 1
    v_mfma_f32_16x16x32_bf16 v[144:147], v[152:155], v[32:35], v[144:147]
    v_mfma_f32_16x16x32_bf16 v[148:151], v[32:35], v[32:35], v[148:151]
    s_add_u32 s28, s25, 71680
    s_mov_b32 m0, s28
    s_add_u32 s27, s24, 860160
    s_mov_b64 exec, s[58:59]
    buffer_load_dwordx4 v6, s[12:15], s27 offen lds
    s_mov_b64 exec, -1
    s_waitcnt lgkmcnt(15)
    v_mfma_f32_16x16x32_bf16 v[120:123], v[72:75], v[32:35], v[120:123]
    v_mfma_f32_16x16x32_bf16 v[156:159], v[72:75], v[152:155], v[156:159]
    v_mfma_f32_16x16x32_bf16 v[124:127], v[76:79], v[32:35], v[124:127]
    v_mfma_f32_16x16x32_bf16 v[160:163], v[76:79], v[152:155], v[160:163]
    buffer_load_dwordx4 v[56:59], v7, s[36:39], s26 offen offset:640
    v_mfma_f32_16x16x32_bf16 v[128:131], v[80:83], v[32:35], v[128:131]
    v_mfma_f32_16x16x32_bf16 v[164:167], v[80:83], v[152:155], v[164:167]
    v_mfma_f32_16x16x32_bf16 v[132:135], v[84:87], v[32:35], v[132:135]
    v_mfma_f32_16x16x32_bf16 v[168:171], v[84:87], v[152:155], v[168:171]
    s_waitcnt lgkmcnt(14)
    v_mfma_f32_16x16x32_bf16 v[136:139], v[32:35], v[88:91], v[136:139]
    v_mfma_f32_16x16x32_bf16 v[172:175], v[152:155], v[88:91], v[172:175]
    s_waitcnt lgkmcnt(12)
    v_mfma_f32_16x16x32_bf16 v[140:143], v[32:35], v[92:95], v[140:143]
    v_mfma_f32_16x16x32_bf16 v[176:179], v[152:155], v[92:95], v[176:179]
    v_mov_b32 v9, v36
    v_mov_b32 v10, v37
    v_cndmask_b32 v36, v36, v38, s[94:95]
    v_cndmask_b32 v37, v37, v39, s[94:95]
    v_cndmask_b32 v38, v38, v9, s[94:95]
    v_cndmask_b32 v39, v39, v10, s[94:95]
    s_nop 1
    v_mfma_f32_16x16x32_bf16 v[144:147], v[152:155], v[36:39], v[144:147]
    v_mfma_f32_16x16x32_bf16 v[148:151], v[36:39], v[36:39], v[148:151]
    s_add_u32 s28, s25, 78848
    s_mov_b32 m0, s28
    s_add_u32 s27, s24, 946176
    s_mov_b64 exec, s[58:59]
    buffer_load_dwordx4 v6, s[12:15], s27 offen lds
    s_mov_b64 exec, -1
    s_waitcnt lgkmcnt(10)
    v_mfma_f32_16x16x32_bf16 v[120:123], v[96:99], v[36:39], v[120:123]
    v_mfma_f32_16x16x32_bf16 v[156:159], v[96:99], v[152:155], v[156:159]
    s_waitcnt lgkmcnt(8)
    v_mfma_f32_16x16x32_bf16 v[124:127], v[100:103], v[36:39], v[124:127]
    v_mfma_f32_16x16x32_bf16 v[160:163], v[100:103], v[152:155], v[160:163]
    buffer_load_dwordx4 v[60:63], v7, s[36:39], s26 offen offset:704
    s_waitcnt lgkmcnt(6)
    v_mfma_f32_16x16x32_bf16 v[128:131], v[104:107], v[36:39], v[128:131]
    v_mfma_f32_16x16x32_bf16 v[164:167], v[104:107], v[152:155], v[164:167]
    s_waitcnt lgkmcnt(4)
    v_mfma_f32_16x16x32_bf16 v[132:135], v[108:111], v[36:39], v[132:135]
    v_mfma_f32_16x16x32_bf16 v[168:171], v[108:111], v[152:155], v[168:171]
    s_waitcnt lgkmcnt(2)
    v_mfma_f32_16x16x32_bf16 v[136:139], v[36:39], v[112:115], v[136:139]
    v_mfma_f32_16x16x32_bf16 v[172:175], v[152:155], v[112:115], v[172:175]
    s_waitcnt lgkmcnt(0)
    v_mfma_f32_16x16x32_bf16 v[140:143], v[36:39], v[116:119], v[140:143]
    v_mfma_f32_16x16x32_bf16 v[176:179], v[152:155], v[116:119], v[176:179]
    s_waitcnt vmcnt(8)
    s_barrier
    ds_read_b64_tr_b16 v[72:73], v8 offset:43008
    ds_read_b64_tr_b16 v[74:75], v11 offset:43008
    ds_read_b64_tr_b16 v[76:77], v8 offset:43040
    ds_read_b64_tr_b16 v[78:79], v11 offset:43040
    ds_read_b64_tr_b16 v[80:81], v8 offset:43072
    ds_read_b64_tr_b16 v[82:83], v11 offset:43072
    ds_read_b64_tr_b16 v[84:85], v8 offset:43104
    ds_read_b64_tr_b16 v[86:87], v11 offset:43104
    ds_read_b64_tr_b16 v[88:89], v8 offset:43136
    ds_read_b64_tr_b16 v[90:91], v11 offset:43136
    ds_read_b64_tr_b16 v[92:93], v8 offset:43168
    ds_read_b64_tr_b16 v[94:95], v11 offset:43168
    ds_read_b64_tr_b16 v[96:97], v8 offset:50176
    ds_read_b64_tr_b16 v[98:99], v11 offset:50176
    ds_read_b64_tr_b16 v[100:101], v8 offset:50208
    ds_read_b64_tr_b16 v[102:103], v11 offset:50208
    ds_read_b64_tr_b16 v[104:105], v8 offset:50240
    ds_read_b64_tr_b16 v[106:107], v11 offset:50240
    ds_read_b64_tr_b16 v[108:109], v8 offset:50272
    ds_read_b64_tr_b16 v[110:111], v11 offset:50272
    ds_read_b64_tr_b16 v[112:113], v8 offset:50304
    ds_read_b64_tr_b16 v[114:115], v11 offset:50304
    ds_read_b64_tr_b16 v[116:117], v8 offset:50336
    ds_read_b64_tr_b16 v[118:119], v11 offset:50336
    v_mov_b32 v9, v40
    v_mov_b32 v10, v41
    v_cndmask_b32 v40, v40, v42, s[94:95]
    v_cndmask_b32 v41, v41, v43, s[94:95]
    v_cndmask_b32 v42, v42, v9, s[94:95]
    v_cndmask_b32 v43, v43, v10, s[94:95]
    s_nop 1
    v_mfma_f32_16x16x32_bf16 v[144:147], v[152:155], v[40:43], v[144:147]
    v_mfma_f32_16x16x32_bf16 v[148:151], v[40:43], v[40:43], v[148:151]
    s_add_u32 s28, s25, 86016
    s_mov_b32 m0, s28
    s_add_u32 s27, s24, 1032192
    s_mov_b64 exec, s[58:59]
    buffer_load_dwordx4 v6, s[12:15], s27 offen lds
    s_mov_b64 exec, -1
    s_waitcnt lgkmcnt(15)
    v_mfma_f32_16x16x32_bf16 v[120:123], v[72:75], v[40:43], v[120:123]
    v_mfma_f32_16x16x32_bf16 v[156:159], v[72:75], v[152:155], v[156:159]
    v_mfma_f32_16x16x32_bf16 v[124:127], v[76:79], v[40:43], v[124:127]
    v_mfma_f32_16x16x32_bf16 v[160:163], v[76:79], v[152:155], v[160:163]
    buffer_load_dwordx4 v[64:67], v7, s[36:39], s26 offen offset:768
    v_mfma_f32_16x16x32_bf16 v[128:131], v[80:83], v[40:43], v[128:131]
    v_mfma_f32_16x16x32_bf16 v[164:167], v[80:83], v[152:155], v[164:167]
    v_mfma_f32_16x16x32_bf16 v[132:135], v[84:87], v[40:43], v[132:135]
    v_mfma_f32_16x16x32_bf16 v[168:171], v[84:87], v[152:155], v[168:171]
    s_waitcnt lgkmcnt(14)
    v_mfma_f32_16x16x32_bf16 v[136:139], v[40:43], v[88:91], v[136:139]
    v_mfma_f32_16x16x32_bf16 v[172:175], v[152:155], v[88:91], v[172:175]
    s_waitcnt lgkmcnt(12)
    v_mfma_f32_16x16x32_bf16 v[140:143], v[40:43], v[92:95], v[140:143]
    v_mfma_f32_16x16x32_bf16 v[176:179], v[152:155], v[92:95], v[176:179]
    v_mov_b32 v9, v44
    v_mov_b32 v10, v45
    v_cndmask_b32 v44, v44, v46, s[94:95]
    v_cndmask_b32 v45, v45, v47, s[94:95]
    v_cndmask_b32 v46, v46, v9, s[94:95]
    v_cndmask_b32 v47, v47, v10, s[94:95]
    s_nop 1
    v_mfma_f32_16x16x32_bf16 v[144:147], v[152:155], v[44:47], v[144:147]
    v_mfma_f32_16x16x32_bf16 v[148:151], v[44:47], v[44:47], v[148:151]
    s_add_u32 s28, s25, 93184
    s_mov_b32 m0, s28
    s_add_u32 s27, s24, 1118208
    s_mov_b64 exec, s[58:59]
    buffer_load_dwordx4 v6, s[12:15], s27 offen lds
    s_mov_b64 exec, -1
    s_waitcnt lgkmcnt(10)
    v_mfma_f32_16x16x32_bf16 v[120:123], v[96:99], v[44:47], v[120:123]
    v_mfma_f32_16x16x32_bf16 v[156:159], v[96:99], v[152:155], v[156:159]
    s_waitcnt lgkmcnt(8)
    v_mfma_f32_16x16x32_bf16 v[124:127], v[100:103], v[44:47], v[124:127]
    v_mfma_f32_16x16x32_bf16 v[160:163], v[100:103], v[152:155], v[160:163]
    buffer_load_dwordx4 v[68:71], v7, s[36:39], s26 offen offset:832
    s_waitcnt lgkmcnt(6)
    v_mfma_f32_16x16x32_bf16 v[128:131], v[104:107], v[44:47], v[128:131]
    v_mfma_f32_16x16x32_bf16 v[164:167], v[104:107], v[152:155], v[164:167]
    s_waitcnt lgkmcnt(4)
    v_mfma_f32_16x16x32_bf16 v[132:135], v[108:111], v[44:47], v[132:135]
    v_mfma_f32_16x16x32_bf16 v[168:171], v[108:111], v[152:155], v[168:171]
    s_waitcnt lgkmcnt(2)
    v_mfma_f32_16x16x32_bf16 v[136:139], v[44:47], v[112:115], v[136:139]
    v_mfma_f32_16x16x32_bf16 v[172:175], v[152:155], v[112:115], v[172:175]
    s_waitcnt lgkmcnt(0)
    v_mfma_f32_16x16x32_bf16 v[140:143], v[44:47], v[116:119], v[140:143]
    v_mfma_f32_16x16x32_bf16 v[176:179], v[152:155], v[116:119], v[176:179]
    s_waitcnt vmcnt(8)
    s_barrier
    ds_read_b64_tr_b16 v[72:73], v254 offset:0
    ds_read_b64_tr_b16 v[74:75], v255 offset:0
    ds_read_b64_tr_b16 v[76:77], v254 offset:32
    ds_read_b64_tr_b16 v[78:79], v255 offset:32
    ds_read_b64_tr_b16 v[80:81], v254 offset:64
    ds_read_b64_tr_b16 v[82:83], v255 offset:64
    ds_read_b64_tr_b16 v[84:85], v254 offset:96
    ds_read_b64_tr_b16 v[86:87], v255 offset:96
    ds_read_b64_tr_b16 v[88:89], v254 offset:128
    ds_read_b64_tr_b16 v[90:91], v255 offset:128
    ds_read_b64_tr_b16 v[92:93], v254 offset:160
    ds_read_b64_tr_b16 v[94:95], v255 offset:160
    ds_read_b64_tr_b16 v[96:97], v254 offset:7168
    ds_read_b64_tr_b16 v[98:99], v255 offset:7168
    ds_read_b64_tr_b16 v[100:101], v254 offset:7200
    ds_read_b64_tr_b16 v[102:103], v255 offset:7200
    ds_read_b64_tr_b16 v[104:105], v254 offset:7232
    ds_read_b64_tr_b16 v[106:107], v255 offset:7232
    ds_read_b64_tr_b16 v[108:109], v254 offset:7264
    ds_read_b64_tr_b16 v[110:111], v255 offset:7264
    ds_read_b64_tr_b16 v[112:113], v254 offset:7296
    ds_read_b64_tr_b16 v[114:115], v255 offset:7296
    ds_read_b64_tr_b16 v[116:117], v254 offset:7328
    ds_read_b64_tr_b16 v[118:119], v255 offset:7328
    v_mov_b32 v9, v48
    v_mov_b32 v10, v49
    v_cndmask_b32 v48, v48, v50, s[94:95]
    v_cndmask_b32 v49, v49, v51, s[94:95]
    v_cndmask_b32 v50, v50, v9, s[94:95]
    v_cndmask_b32 v51, v51, v10, s[94:95]
    s_nop 1
    v_mfma_f32_16x16x32_bf16 v[144:147], v[152:155], v[48:51], v[144:147]
    v_mfma_f32_16x16x32_bf16 v[148:151], v[48:51], v[48:51], v[148:151]
    s_add_u32 s29, s30, 0
    buffer_load_ushort v224, v240, s[32:35], s29 offen
    s_add_u32 s29, s30, 56
    buffer_load_ushort v225, v240, s[32:35], s29 offen
    s_waitcnt lgkmcnt(15)
    v_mfma_f32_16x16x32_bf16 v[120:123], v[72:75], v[48:51], v[120:123]
    v_mfma_f32_16x16x32_bf16 v[156:159], v[72:75], v[152:155], v[156:159]
    v_mfma_f32_16x16x32_bf16 v[124:127], v[76:79], v[48:51], v[124:127]
    v_mfma_f32_16x16x32_bf16 v[160:163], v[76:79], v[152:155], v[160:163]
    s_add_u32 s29, s30, 112
    buffer_load_ushort v226, v240, s[32:35], s29 offen
    s_add_u32 s29, s30, 168
    buffer_load_ushort v227, v240, s[32:35], s29 offen
    v_mfma_f32_16x16x32_bf16 v[128:131], v[80:83], v[48:51], v[128:131]
    v_mfma_f32_16x16x32_bf16 v[164:167], v[80:83], v[152:155], v[164:167]
    v_mfma_f32_16x16x32_bf16 v[132:135], v[84:87], v[48:51], v[132:135]
    v_mfma_f32_16x16x32_bf16 v[168:171], v[84:87], v[152:155], v[168:171]
    s_waitcnt lgkmcnt(14)
    v_mfma_f32_16x16x32_bf16 v[136:139], v[48:51], v[88:91], v[136:139]
    v_mfma_f32_16x16x32_bf16 v[172:175], v[152:155], v[88:91], v[172:175]
    s_waitcnt lgkmcnt(12)
    v_mfma_f32_16x16x32_bf16 v[140:143], v[48:51], v[92:95], v[140:143]
    v_mfma_f32_16x16x32_bf16 v[176:179], v[152:155], v[92:95], v[176:179]
    v_mov_b32 v9, v52
    v_mov_b32 v10, v53
    v_cndmask_b32 v52, v52, v54, s[94:95]
    v_cndmask_b32 v53, v53, v55, s[94:95]
    v_cndmask_b32 v54, v54, v9, s[94:95]
    v_cndmask_b32 v55, v55, v10, s[94:95]
    s_nop 1
    v_mfma_f32_16x16x32_bf16 v[144:147], v[152:155], v[52:55], v[144:147]
    v_mfma_f32_16x16x32_bf16 v[148:151], v[52:55], v[52:55], v[148:151]
    s_add_u32 s29, s30, 0
    buffer_load_ushort v228, v241, s[32:35], s29 offen
    s_add_u32 s29, s30, 56
    buffer_load_ushort v229, v241, s[32:35], s29 offen
    s_waitcnt lgkmcnt(10)
    v_mfma_f32_16x16x32_bf16 v[120:123], v[96:99], v[52:55], v[120:123]
    v_mfma_f32_16x16x32_bf16 v[156:159], v[96:99], v[152:155], v[156:159]
    s_waitcnt lgkmcnt(8)
    v_mfma_f32_16x16x32_bf16 v[124:127], v[100:103], v[52:55], v[124:127]
    v_mfma_f32_16x16x32_bf16 v[160:163], v[100:103], v[152:155], v[160:163]
    s_add_u32 s29, s30, 112
    buffer_load_ushort v230, v241, s[32:35], s29 offen
    s_add_u32 s29, s30, 168
    buffer_load_ushort v231, v241, s[32:35], s29 offen
    s_waitcnt lgkmcnt(6)
    v_mfma_f32_16x16x32_bf16 v[128:131], v[104:107], v[52:55], v[128:131]
    v_mfma_f32_16x16x32_bf16 v[164:167], v[104:107], v[152:155], v[164:167]
    s_waitcnt lgkmcnt(4)
    v_mfma_f32_16x16x32_bf16 v[132:135], v[108:111], v[52:55], v[132:135]
    v_mfma_f32_16x16x32_bf16 v[168:171], v[108:111], v[152:155], v[168:171]
    s_waitcnt lgkmcnt(2)
    v_mfma_f32_16x16x32_bf16 v[136:139], v[52:55], v[112:115], v[136:139]
    v_mfma_f32_16x16x32_bf16 v[172:175], v[152:155], v[112:115], v[172:175]
    s_waitcnt lgkmcnt(0)
    v_mfma_f32_16x16x32_bf16 v[140:143], v[52:55], v[116:119], v[140:143]
    v_mfma_f32_16x16x32_bf16 v[176:179], v[152:155], v[116:119], v[176:179]
    s_waitcnt vmcnt(12)
    s_barrier
    ds_read_b64_tr_b16 v[72:73], v254 offset:14336
    ds_read_b64_tr_b16 v[74:75], v255 offset:14336
    ds_read_b64_tr_b16 v[76:77], v254 offset:14368
    ds_read_b64_tr_b16 v[78:79], v255 offset:14368
    ds_read_b64_tr_b16 v[80:81], v254 offset:14400
    ds_read_b64_tr_b16 v[82:83], v255 offset:14400
    ds_read_b64_tr_b16 v[84:85], v254 offset:14432
    ds_read_b64_tr_b16 v[86:87], v255 offset:14432
    ds_read_b64_tr_b16 v[88:89], v254 offset:14464
    ds_read_b64_tr_b16 v[90:91], v255 offset:14464
    ds_read_b64_tr_b16 v[92:93], v254 offset:14496
    ds_read_b64_tr_b16 v[94:95], v255 offset:14496
    ds_read_b64_tr_b16 v[96:97], v254 offset:21504
    ds_read_b64_tr_b16 v[98:99], v255 offset:21504
    ds_read_b64_tr_b16 v[100:101], v254 offset:21536
    ds_read_b64_tr_b16 v[102:103], v255 offset:21536
    ds_read_b64_tr_b16 v[104:105], v254 offset:21568
    ds_read_b64_tr_b16 v[106:107], v255 offset:21568
    ds_read_b64_tr_b16 v[108:109], v254 offset:21600
    ds_read_b64_tr_b16 v[110:111], v255 offset:21600
    ds_read_b64_tr_b16 v[112:113], v254 offset:21632
    ds_read_b64_tr_b16 v[114:115], v255 offset:21632
    ds_read_b64_tr_b16 v[116:117], v254 offset:21664
    ds_read_b64_tr_b16 v[118:119], v255 offset:21664
    v_mov_b32 v9, v56
    v_mov_b32 v10, v57
    v_cndmask_b32 v56, v56, v58, s[94:95]
    v_cndmask_b32 v57, v57, v59, s[94:95]
    v_cndmask_b32 v58, v58, v9, s[94:95]
    v_cndmask_b32 v59, v59, v10, s[94:95]
    s_nop 1
    v_mfma_f32_16x16x32_bf16 v[144:147], v[152:155], v[56:59], v[144:147]
    v_mfma_f32_16x16x32_bf16 v[148:151], v[56:59], v[56:59], v[148:151]
    s_add_u32 s29, s30, 0
    buffer_load_ushort v232, v242, s[32:35], s29 offen
    s_add_u32 s29, s30, 56
    buffer_load_ushort v233, v242, s[32:35], s29 offen
    s_waitcnt lgkmcnt(15)
    v_mfma_f32_16x16x32_bf16 v[120:123], v[72:75], v[56:59], v[120:123]
    v_mfma_f32_16x16x32_bf16 v[156:159], v[72:75], v[152:155], v[156:159]
    v_mfma_f32_16x16x32_bf16 v[124:127], v[76:79], v[56:59], v[124:127]
    v_mfma_f32_16x16x32_bf16 v[160:163], v[76:79], v[152:155], v[160:163]
    s_add_u32 s29, s30, 112
    buffer_load_ushort v234, v242, s[32:35], s29 offen
    s_add_u32 s29, s30, 168
    buffer_load_ushort v235, v242, s[32:35], s29 offen
    v_mfma_f32_16x16x32_bf16 v[128:131], v[80:83], v[56:59], v[128:131]
    v_mfma_f32_16x16x32_bf16 v[164:167], v[80:83], v[152:155], v[164:167]
    v_mfma_f32_16x16x32_bf16 v[132:135], v[84:87], v[56:59], v[132:135]
    v_mfma_f32_16x16x32_bf16 v[168:171], v[84:87], v[152:155], v[168:171]
    s_waitcnt lgkmcnt(14)
    v_mfma_f32_16x16x32_bf16 v[136:139], v[56:59], v[88:91], v[136:139]
    v_mfma_f32_16x16x32_bf16 v[172:175], v[152:155], v[88:91], v[172:175]
    s_waitcnt lgkmcnt(12)
    v_mfma_f32_16x16x32_bf16 v[140:143], v[56:59], v[92:95], v[140:143]
    v_mfma_f32_16x16x32_bf16 v[176:179], v[152:155], v[92:95], v[176:179]
    v_mov_b32 v9, v60
    v_mov_b32 v10, v61
    v_cndmask_b32 v60, v60, v62, s[94:95]
    v_cndmask_b32 v61, v61, v63, s[94:95]
    v_cndmask_b32 v62, v62, v9, s[94:95]
    v_cndmask_b32 v63, v63, v10, s[94:95]
    s_nop 1
    v_mfma_f32_16x16x32_bf16 v[144:147], v[152:155], v[60:63], v[144:147]
    v_mfma_f32_16x16x32_bf16 v[148:151], v[60:63], v[60:63], v[148:151]
    s_add_u32 s29, s30, 0
    buffer_load_ushort v236, v243, s[32:35], s29 offen
    s_add_u32 s29, s30, 56
    buffer_load_ushort v237, v243, s[32:35], s29 offen
    s_waitcnt lgkmcnt(10)
    v_mfma_f32_16x16x32_bf16 v[120:123], v[96:99], v[60:63], v[120:123]
    v_mfma_f32_16x16x32_bf16 v[156:159], v[96:99], v[152:155], v[156:159]
    s_waitcnt lgkmcnt(8)
    v_mfma_f32_16x16x32_bf16 v[124:127], v[100:103], v[60:63], v[124:127]
    v_mfma_f32_16x16x32_bf16 v[160:163], v[100:103], v[152:155], v[160:163]
    s_add_u32 s29, s30, 112
    buffer_load_ushort v238, v243, s[32:35], s29 offen
    s_add_u32 s29, s30, 168
    buffer_load_ushort v239, v243, s[32:35], s29 offen
    s_waitcnt lgkmcnt(6)
    v_mfma_f32_16x16x32_bf16 v[128:131], v[104:107], v[60:63], v[128:131]
    v_mfma_f32_16x16x32_bf16 v[164:167], v[104:107], v[152:155], v[164:167]
    s_waitcnt lgkmcnt(4)
    v_mfma_f32_16x16x32_bf16 v[132:135], v[108:111], v[60:63], v[132:135]
    v_mfma_f32_16x16x32_bf16 v[168:171], v[108:111], v[152:155], v[168:171]
    s_waitcnt lgkmcnt(2)
    v_mfma_f32_16x16x32_bf16 v[136:139], v[60:63], v[112:115], v[136:139]
    v_mfma_f32_16x16x32_bf16 v[172:175], v[152:155], v[112:115], v[172:175]
    s_waitcnt lgkmcnt(0)
    v_mfma_f32_16x16x32_bf16 v[140:143], v[60:63], v[116:119], v[140:143]
    v_mfma_f32_16x16x32_bf16 v[176:179], v[152:155], v[116:119], v[176:179]
    s_waitcnt vmcnt(16)
    s_barrier
    ds_read_b64_tr_b16 v[72:73], v254 offset:28672
    ds_read_b64_tr_b16 v[74:75], v255 offset:28672
    ds_read_b64_tr_b16 v[76:77], v254 offset:28704
    ds_read_b64_tr_b16 v[78:79], v255 offset:28704
    ds_read_b64_tr_b16 v[80:81], v254 offset:28736
    ds_read_b64_tr_b16 v[82:83], v255 offset:28736
    ds_read_b64_tr_b16 v[84:85], v254 offset:28768
    ds_read_b64_tr_b16 v[86:87], v255 offset:28768
    ds_read_b64_tr_b16 v[88:89], v254 offset:28800
    ds_read_b64_tr_b16 v[90:91], v255 offset:28800
    ds_read_b64_tr_b16 v[92:93], v254 offset:28832
    ds_read_b64_tr_b16 v[94:95], v255 offset:28832
    ds_read_b64_tr_b16 v[96:97], v254 offset:35840
    ds_read_b64_tr_b16 v[98:99], v255 offset:35840
    ds_read_b64_tr_b16 v[100:101], v254 offset:35872
    ds_read_b64_tr_b16 v[102:103], v255 offset:35872
    ds_read_b64_tr_b16 v[104:105], v254 offset:35904
    ds_read_b64_tr_b16 v[106:107], v255 offset:35904
    ds_read_b64_tr_b16 v[108:109], v254 offset:35936
    ds_read_b64_tr_b16 v[110:111], v255 offset:35936
    ds_read_b64_tr_b16 v[112:113], v254 offset:35968
    ds_read_b64_tr_b16 v[114:115], v255 offset:35968
    ds_read_b64_tr_b16 v[116:117], v254 offset:36000
    ds_read_b64_tr_b16 v[118:119], v255 offset:36000
    v_mov_b32 v9, v64
    v_mov_b32 v10, v65
    v_cndmask_b32 v64, v64, v66, s[94:95]
    v_cndmask_b32 v65, v65, v67, s[94:95]
    v_cndmask_b32 v66, v66, v9, s[94:95]
    v_cndmask_b32 v67, v67, v10, s[94:95]
    s_nop 1
    v_mfma_f32_16x16x32_bf16 v[144:147], v[152:155], v[64:67], v[144:147]
    v_mfma_f32_16x16x32_bf16 v[148:151], v[64:67], v[64:67], v[148:151]
    s_waitcnt lgkmcnt(15)
    v_mfma_f32_16x16x32_bf16 v[120:123], v[72:75], v[64:67], v[120:123]
    v_mfma_f32_16x16x32_bf16 v[156:159], v[72:75], v[152:155], v[156:159]
    v_mfma_f32_16x16x32_bf16 v[124:127], v[76:79], v[64:67], v[124:127]
    v_mfma_f32_16x16x32_bf16 v[160:163], v[76:79], v[152:155], v[160:163]
    v_mfma_f32_16x16x32_bf16 v[128:131], v[80:83], v[64:67], v[128:131]
    v_mfma_f32_16x16x32_bf16 v[164:167], v[80:83], v[152:155], v[164:167]
    v_mfma_f32_16x16x32_bf16 v[132:135], v[84:87], v[64:67], v[132:135]
    v_mfma_f32_16x16x32_bf16 v[168:171], v[84:87], v[152:155], v[168:171]
    s_waitcnt lgkmcnt(14)
    v_mfma_f32_16x16x32_bf16 v[136:139], v[64:67], v[88:91], v[136:139]
    v_mfma_f32_16x16x32_bf16 v[172:175], v[152:155], v[88:91], v[172:175]
    s_waitcnt lgkmcnt(12)
    v_mfma_f32_16x16x32_bf16 v[140:143], v[64:67], v[92:95], v[140:143]
    v_mfma_f32_16x16x32_bf16 v[176:179], v[152:155], v[92:95], v[176:179]
    v_mov_b32 v9, v68
    v_mov_b32 v10, v69
    v_cndmask_b32 v68, v68, v70, s[94:95]
    v_cndmask_b32 v69, v69, v71, s[94:95]
    v_cndmask_b32 v70, v70, v9, s[94:95]
    v_cndmask_b32 v71, v71, v10, s[94:95]
    s_nop 1
    v_mfma_f32_16x16x32_bf16 v[144:147], v[152:155], v[68:71], v[144:147]
    v_mfma_f32_16x16x32_bf16 v[148:151], v[68:71], v[68:71], v[148:151]
    s_waitcnt lgkmcnt(10)
    v_mfma_f32_16x16x32_bf16 v[120:123], v[96:99], v[68:71], v[120:123]
    v_mfma_f32_16x16x32_bf16 v[156:159], v[96:99], v[152:155], v[156:159]
    s_waitcnt lgkmcnt(8)
    v_mfma_f32_16x16x32_bf16 v[124:127], v[100:103], v[68:71], v[124:127]
    v_mfma_f32_16x16x32_bf16 v[160:163], v[100:103], v[152:155], v[160:163]
    s_waitcnt lgkmcnt(6)
    v_mfma_f32_16x16x32_bf16 v[128:131], v[104:107], v[68:71], v[128:131]
    v_mfma_f32_16x16x32_bf16 v[164:167], v[104:107], v[152:155], v[164:167]
    s_waitcnt lgkmcnt(4)
    v_mfma_f32_16x16x32_bf16 v[132:135], v[108:111], v[68:71], v[132:135]
    v_mfma_f32_16x16x32_bf16 v[168:171], v[108:111], v[152:155], v[168:171]
    s_waitcnt lgkmcnt(2)
    v_mfma_f32_16x16x32_bf16 v[136:139], v[68:71], v[112:115], v[136:139]
    v_mfma_f32_16x16x32_bf16 v[172:175], v[152:155], v[112:115], v[172:175]
    s_waitcnt lgkmcnt(0)
    v_mfma_f32_16x16x32_bf16 v[140:143], v[68:71], v[116:119], v[140:143]
    v_mfma_f32_16x16x32_bf16 v[176:179], v[152:155], v[116:119], v[176:179]
    s_waitcnt vmcnt(14)
    v_lshl_or_b32 v216, v225, 16, v224
    s_waitcnt vmcnt(12)
    v_lshl_or_b32 v217, v227, 16, v226
    s_waitcnt vmcnt(10)
    v_lshl_or_b32 v218, v229, 16, v228
    s_waitcnt vmcnt(8)
    v_lshl_or_b32 v219, v231, 16, v230
    s_waitcnt vmcnt(6)
    v_lshl_or_b32 v220, v233, 16, v232
    s_waitcnt vmcnt(4)
    v_lshl_or_b32 v221, v235, 16, v234
    s_waitcnt vmcnt(2)
    v_lshl_or_b32 v222, v237, 16, v236
    s_waitcnt vmcnt(0)
    v_lshl_or_b32 v223, v239, 16, v238
    buffer_load_dword v14, v15, s[16:19], s31 offen offset:64 sc1
    v_cndmask_b32 v186, v148, v149, s[40:41]
    v_cndmask_b32 v186, v186, v150, s[42:43]
    v_cndmask_b32 v186, v186, v151, s[44:45]
    v_cndmask_b32 v186, 0, v186, s[46:47]
    v_mov_b32 v187, v186
    s_nop 1
    v_permlane16_swap_b32 v186, v187
    v_add_f32 v186, v186, v187
    v_mov_b32 v187, v186
    s_nop 1
    v_permlane32_swap_b32 v186, v187
    v_add_f32 v186, v186, v187
    v_mul_f32 v187, 991054117, v144
    v_mul_f32 v186, 991054117, v186
    v_fma_f32 v186, -v187, v187, v186
    v_max_f32 v186, 0, v186
    v_add_f32 v186, 925353388, v186
    v_rsq_f32 v185, v186
    s_nop 0
    v_mul_f32 v184, v187, v185
    v_sub_f32 v184, 0, v184
    s_lshl_b32 s26, s20, 7
    s_add_u32 s26, s26, 100352
    v_lshl_add_u32 v9, v3, 3, s26
    v_lshl_add_u32 v10, v4, 5, s26
    ds_write_b64 v9, v[184:185]
    s_waitcnt lgkmcnt(0)
    ds_read_b128 v[188:191], v10
    ds_read_b128 v[192:195], v10 offset:16
    v_mul_f32 v204, v184, v156
    v_mul_f32 v205, v184, v157
    v_mul_f32 v206, v184, v158
    v_mul_f32 v207, v184, v159
    v_fmac_f32 v204, v120, v185
    v_fmac_f32 v205, v121, v185
    v_fmac_f32 v206, v122, v185
    v_fmac_f32 v207, v123, v185
    v_cvt_pk_bf16_f32 v196, v204, v205
    v_cvt_pk_bf16_f32 v197, v206, v207
    v_mul_f32 v208, v184, v160
    v_mul_f32 v209, v184, v161
    v_mul_f32 v210, v184, v162
    v_mul_f32 v211, v184, v163
    v_fmac_f32 v208, v124, v185
    v_fmac_f32 v209, v125, v185
    v_fmac_f32 v210, v126, v185
    v_fmac_f32 v211, v127, v185
    v_cvt_pk_bf16_f32 v198, v208, v209
    v_cvt_pk_bf16_f32 v199, v210, v211
    v_mul_f32 v204, v184, v164
    v_mul_f32 v205, v184, v165
    v_mul_f32 v206, v184, v166
    v_mul_f32 v207, v184, v167
    v_fmac_f32 v204, v128, v185
    v_fmac_f32 v205, v129, v185
    v_fmac_f32 v206, v130, v185
    v_fmac_f32 v207, v131, v185
    v_cvt_pk_bf16_f32 v200, v204, v205
    v_cvt_pk_bf16_f32 v201, v206, v207
    v_mul_f32 v208, v184, v168
    v_mul_f32 v209, v184, v169
    v_mul_f32 v210, v184, v170
    v_mul_f32 v211, v184, v171
    v_fmac_f32 v208, v132, v185
    v_fmac_f32 v209, v133, v185
    v_fmac_f32 v210, v134, v185
    v_fmac_f32 v211, v135, v185
    v_cvt_pk_bf16_f32 v202, v208, v209
    v_cvt_pk_bf16_f32 v203, v210, v211
    s_nop 1
    v_mfma_f32_16x16x32_bf16 v[128:131], v[200:203], v[216:219], 0
    v_mfma_f32_16x16x32_bf16 v[132:135], v[200:203], v[220:223], 0
    v_mfma_f32_16x16x32_bf16 v[120:123], v[216:219], v[196:199], 0
    v_mfma_f32_16x16x32_bf16 v[124:127], v[220:223], v[196:199], 0
    s_waitcnt lgkmcnt(1)
    v_mul_f32 v204, v188, v172
    v_fmac_f32 v204, v136, v189
    v_mul_f32 v205, v190, v172
    v_fmac_f32 v205, v137, v191
    s_waitcnt lgkmcnt(0)
    v_mul_f32 v206, v192, v172
    v_fmac_f32 v206, v138, v193
    v_mul_f32 v207, v194, v172
    v_fmac_f32 v207, v139, v195
    v_cvt_pk_bf16_f32 v212, v204, v205
    v_cvt_pk_bf16_f32 v213, v206, v207
    v_mul_f32 v208, v188, v176
    v_fmac_f32 v208, v140, v189
    v_cndmask_b32 v208, v208, 1.0, s[50:51]
    v_mul_f32 v209, v190, v176
    v_fmac_f32 v209, v141, v191
    v_cndmask_b32 v209, v209, 1.0, s[50:51]
    v_mul_f32 v210, v192, v176
    v_fmac_f32 v210, v142, v193
    v_cndmask_b32 v210, v210, 1.0, s[50:51]
    v_mul_f32 v211, v194, v176
    v_fmac_f32 v211, v143, v195
    v_cndmask_b32 v211, v211, 1.0, s[50:51]
    v_cvt_pk_bf16_f32 v214, v208, v209
    v_cvt_pk_bf16_f32 v215, v210, v211
    v_mov_b32 v224, 4286578687
    v_mov_b32 v225, 2139095039
    s_mov_b32 s26, 1069066811
    v_cvt_pk_bf16_f32 v248, v128, v129
    v_cvt_pk_bf16_f32 v249, v130, v131
    v_cvt_pk_bf16_f32 v250, v132, v133
    v_cvt_pk_bf16_f32 v251, v134, v135
    v_lshlrev_b32 v128, 16, v248
    v_and_b32 v129, 4294901760, v248
    v_lshlrev_b32 v130, 16, v249
    v_and_b32 v131, 4294901760, v249
    v_lshlrev_b32 v132, 16, v250
    v_and_b32 v133, 4294901760, v250
    v_lshlrev_b32 v134, 16, v251
    v_and_b32 v135, 4294901760, v251
    v_cndmask_b32 v216, v132, v224, s[52:53]
    v_cndmask_b32 v220, v132, v225, s[52:53]
    v_cndmask_b32 v217, v133, v224, s[52:53]
    v_cndmask_b32 v221, v133, v225, s[52:53]
    v_cndmask_b32 v218, v134, v224, s[52:53]
    v_cndmask_b32 v222, v134, v225, s[52:53]
    v_cndmask_b32 v219, v135, v224, s[52:53]
    v_cndmask_b32 v223, v135, v225, s[52:53]
    v_max_f32 v248, v128, v216
    v_min_f32 v252, v128, v220
    v_max_f32 v249, v129, v217
    v_min_f32 v253, v129, v221
    v_max_f32 v250, v130, v218
    v_min_f32 v254, v130, v222
    v_max_f32 v251, v131, v219
    v_min_f32 v255, v131, v223
    v_max_f32_dpp v248, v248, v248 row_ror:8 row_mask:0xf bank_mask:0xf
    v_min_f32_dpp v252, v252, v252 row_ror:8 row_mask:0xf bank_mask:0xf
    v_max_f32_dpp v249, v249, v249 row_ror:8 row_mask:0xf bank_mask:0xf
    v_min_f32_dpp v253, v253, v253 row_ror:8 row_mask:0xf bank_mask:0xf
    v_max_f32_dpp v250, v250, v250 row_ror:8 row_mask:0xf bank_mask:0xf
    v_min_f32_dpp v254, v254, v254 row_ror:8 row_mask:0xf bank_mask:0xf
    v_max_f32_dpp v251, v251, v251 row_ror:8 row_mask:0xf bank_mask:0xf
    v_min_f32_dpp v255, v255, v255 row_ror:8 row_mask:0xf bank_mask:0xf
    v_max_f32_dpp v248, v248, v248 row_ror:4 row_mask:0xf bank_mask:0xf
    v_min_f32_dpp v252, v252, v252 row_ror:4 row_mask:0xf bank_mask:0xf
    v_max_f32_dpp v249, v249, v249 row_ror:4 row_mask:0xf bank_mask:0xf
    v_min_f32_dpp v253, v253, v253 row_ror:4 row_mask:0xf bank_mask:0xf
    v_max_f32_dpp v250, v250, v250 row_ror:4 row_mask:0xf bank_mask:0xf
    v_min_f32_dpp v254, v254, v254 row_ror:4 row_mask:0xf bank_mask:0xf
    v_max_f32_dpp v251, v251, v251 row_ror:4 row_mask:0xf bank_mask:0xf
    v_min_f32_dpp v255, v255, v255 row_ror:4 row_mask:0xf bank_mask:0xf
    v_max_f32_dpp v248, v248, v248 row_ror:2 row_mask:0xf bank_mask:0xf
    v_min_f32_dpp v252, v252, v252 row_ror:2 row_mask:0xf bank_mask:0xf
    v_max_f32_dpp v249, v249, v249 row_ror:2 row_mask:0xf bank_mask:0xf
    v_min_f32_dpp v253, v253, v253 row_ror:2 row_mask:0xf bank_mask:0xf
    v_max_f32_dpp v250, v250, v250 row_ror:2 row_mask:0xf bank_mask:0xf
    v_min_f32_dpp v254, v254, v254 row_ror:2 row_mask:0xf bank_mask:0xf
    v_max_f32_dpp v251, v251, v251 row_ror:2 row_mask:0xf bank_mask:0xf
    v_min_f32_dpp v255, v255, v255 row_ror:2 row_mask:0xf bank_mask:0xf
    v_max_f32_dpp v248, v248, v248 row_ror:1 row_mask:0xf bank_mask:0xf
    v_min_f32_dpp v252, v252, v252 row_ror:1 row_mask:0xf bank_mask:0xf
    v_max_f32_dpp v249, v249, v249 row_ror:1 row_mask:0xf bank_mask:0xf
    v_min_f32_dpp v253, v253, v253 row_ror:1 row_mask:0xf bank_mask:0xf
    v_max_f32_dpp v250, v250, v250 row_ror:1 row_mask:0xf bank_mask:0xf
    v_min_f32_dpp v254, v254, v254 row_ror:1 row_mask:0xf bank_mask:0xf
    v_max_f32_dpp v251, v251, v251 row_ror:1 row_mask:0xf bank_mask:0xf
    v_min_f32_dpp v255, v255, v255 row_ror:1 row_mask:0xf bank_mask:0xf
    v_mul_f32 v248, 1069066811, v248
    v_mul_f32 v252, 1069066811, v252
    v_mul_f32 v249, 1069066811, v249
    v_mul_f32 v253, 1069066811, v253
    v_mul_f32 v250, 1069066811, v250
    v_mul_f32 v254, 1069066811, v254
    v_mul_f32 v251, 1069066811, v251
    v_mul_f32 v255, 1069066811, v255
    v_fma_f32 v232, v128, s26, -v248
    v_fma_f32 v240, -v128, s26, v252
    v_fma_f32 v233, v129, s26, -v249
    v_fma_f32 v241, -v129, s26, v253
    v_fma_f32 v234, v130, s26, -v250
    v_fma_f32 v242, -v130, s26, v254
    v_fma_f32 v235, v131, s26, -v251
    v_fma_f32 v243, -v131, s26, v255
    v_fma_f32 v236, v216, s26, -v248
    v_fma_f32 v244, -v220, s26, v252
    v_fma_f32 v237, v217, s26, -v249
    v_fma_f32 v245, -v221, s26, v253
    v_fma_f32 v238, v218, s26, -v250
    v_fma_f32 v246, -v222, s26, v254
    v_fma_f32 v239, v219, s26, -v251
    v_fma_f32 v247, -v223, s26, v255
    v_exp_f32 v232, v232
    v_exp_f32 v240, v240
    v_exp_f32 v233, v233
    v_exp_f32 v241, v241
    v_exp_f32 v234, v234
    v_exp_f32 v242, v242
    v_exp_f32 v235, v235
    v_exp_f32 v243, v243
    v_exp_f32 v236, v236
    v_exp_f32 v244, v244
    v_exp_f32 v237, v237
    v_exp_f32 v245, v245
    v_exp_f32 v238, v238
    v_exp_f32 v246, v246
    v_exp_f32 v239, v239
    v_exp_f32 v247, v247
    v_add_f32 v248, v232, v236
    v_add_f32 v252, v240, v244
    v_add_f32 v249, v233, v237
    v_add_f32 v253, v241, v245
    v_add_f32 v250, v234, v238
    v_add_f32 v254, v242, v246
    v_add_f32 v251, v235, v239
    v_add_f32 v255, v243, v247
    v_add_f32_dpp v248, v248, v248 row_ror:8 row_mask:0xf bank_mask:0xf
    v_add_f32_dpp v252, v252, v252 row_ror:8 row_mask:0xf bank_mask:0xf
    v_add_f32_dpp v249, v249, v249 row_ror:8 row_mask:0xf bank_mask:0xf
    v_add_f32_dpp v253, v253, v253 row_ror:8 row_mask:0xf bank_mask:0xf
    v_add_f32_dpp v250, v250, v250 row_ror:8 row_mask:0xf bank_mask:0xf
    v_add_f32_dpp v254, v254, v254 row_ror:8 row_mask:0xf bank_mask:0xf
    v_add_f32_dpp v251, v251, v251 row_ror:8 row_mask:0xf bank_mask:0xf
    v_add_f32_dpp v255, v255, v255 row_ror:8 row_mask:0xf bank_mask:0xf
    v_add_f32_dpp v248, v248, v248 row_ror:4 row_mask:0xf bank_mask:0xf
    v_add_f32_dpp v252, v252, v252 row_ror:4 row_mask:0xf bank_mask:0xf
    v_add_f32_dpp v249, v249, v249 row_ror:4 row_mask:0xf bank_mask:0xf
    v_add_f32_dpp v253, v253, v253 row_ror:4 row_mask:0xf bank_mask:0xf
    v_add_f32_dpp v250, v250, v250 row_ror:4 row_mask:0xf bank_mask:0xf
    v_add_f32_dpp v254, v254, v254 row_ror:4 row_mask:0xf bank_mask:0xf
    v_add_f32_dpp v251, v251, v251 row_ror:4 row_mask:0xf bank_mask:0xf
    v_add_f32_dpp v255, v255, v255 row_ror:4 row_mask:0xf bank_mask:0xf
    v_add_f32_dpp v248, v248, v248 row_ror:2 row_mask:0xf bank_mask:0xf
    v_add_f32_dpp v252, v252, v252 row_ror:2 row_mask:0xf bank_mask:0xf
    v_add_f32_dpp v249, v249, v249 row_ror:2 row_mask:0xf bank_mask:0xf
    v_add_f32_dpp v253, v253, v253 row_ror:2 row_mask:0xf bank_mask:0xf
    v_add_f32_dpp v250, v250, v250 row_ror:2 row_mask:0xf bank_mask:0xf
    v_add_f32_dpp v254, v254, v254 row_ror:2 row_mask:0xf bank_mask:0xf
    v_add_f32_dpp v251, v251, v251 row_ror:2 row_mask:0xf bank_mask:0xf
    v_add_f32_dpp v255, v255, v255 row_ror:2 row_mask:0xf bank_mask:0xf
    v_add_f32_dpp v248, v248, v248 row_ror:1 row_mask:0xf bank_mask:0xf
    v_add_f32_dpp v252, v252, v252 row_ror:1 row_mask:0xf bank_mask:0xf
    v_add_f32_dpp v249, v249, v249 row_ror:1 row_mask:0xf bank_mask:0xf
    v_add_f32_dpp v253, v253, v253 row_ror:1 row_mask:0xf bank_mask:0xf
    v_add_f32_dpp v250, v250, v250 row_ror:1 row_mask:0xf bank_mask:0xf
    v_add_f32_dpp v254, v254, v254 row_ror:1 row_mask:0xf bank_mask:0xf
    v_add_f32_dpp v251, v251, v251 row_ror:1 row_mask:0xf bank_mask:0xf
    v_add_f32_dpp v255, v255, v255 row_ror:1 row_mask:0xf bank_mask:0xf
    v_rcp_f32 v248, v248
    v_rcp_f32 v252, v252
    v_rcp_f32 v249, v249
    v_rcp_f32 v253, v253
    v_rcp_f32 v250, v250
    v_rcp_f32 v254, v254
    v_rcp_f32 v251, v251
    v_rcp_f32 v255, v255
    v_mul_f32 v232, v232, v248
    v_mul_f32 v240, v240, v252
    v_mul_f32 v233, v233, v249
    v_mul_f32 v241, v241, v253
    v_mul_f32 v234, v234, v250
    v_mul_f32 v242, v242, v254
    v_mul_f32 v235, v235, v251
    v_mul_f32 v243, v243, v255
    v_mul_f32 v236, v236, v248
    v_mul_f32 v244, v244, v252
    v_mul_f32 v237, v237, v249
    v_mul_f32 v245, v245, v253
    v_mul_f32 v238, v238, v250
    v_mul_f32 v246, v246, v254
    v_mul_f32 v239, v239, v251
    v_mul_f32 v247, v247, v255
    v_cvt_pk_bf16_f32 v72, v232, v233
    v_cvt_pk_bf16_f32 v73, v234, v235
    v_cvt_pk_bf16_f32 v76, v240, v241
    v_cvt_pk_bf16_f32 v77, v242, v243
    v_cvt_pk_bf16_f32 v74, v236, v237
    v_cvt_pk_bf16_f32 v75, v238, v239
    v_cvt_pk_bf16_f32 v78, v244, v245
    v_cvt_pk_bf16_f32 v79, v246, v247
    s_mul_i32 s27, s20, 3072
    s_add_u32 s27, s27, 101376
    v_lshl_add_u32 v9, v1, 3, s27
    ds_write_b64 v9, v[72:73] offset:0
    ds_write_b64 v9, v[74:75] offset:512
    ds_write_b64 v9, v[76:77] offset:1024
    ds_write_b64 v9, v[78:79] offset:1536
    ds_write_b64 v9, v[212:213] offset:2048
    ds_write_b64 v9, v[214:215] offset:2560
    v_cvt_pk_bf16_f32 v204, v120, v121
    v_cvt_pk_bf16_f32 v205, v122, v123
    v_cvt_pk_bf16_f32 v206, v124, v125
    v_cvt_pk_bf16_f32 v207, v126, v127
    v_lshlrev_b32 v120, 16, v204
    v_and_b32 v121, 4294901760, v204
    v_lshlrev_b32 v122, 16, v205
    v_and_b32 v123, 4294901760, v205
    v_lshlrev_b32 v124, 16, v206
    v_and_b32 v125, 4294901760, v206
    v_lshlrev_b32 v126, 16, v207
    v_and_b32 v127, 4294901760, v207
    v_cndmask_b32 v216, v124, v224, s[48:49]
    v_cndmask_b32 v220, v124, v225, s[48:49]
    v_cndmask_b32 v217, v125, v224, s[48:49]
    v_cndmask_b32 v221, v125, v225, s[48:49]
    v_cndmask_b32 v218, v126, v224, s[48:49]
    v_cndmask_b32 v222, v126, v225, s[48:49]
    v_cndmask_b32 v219, v127, v224, s[48:49]
    v_cndmask_b32 v223, v127, v225, s[48:49]
    v_max3_f32 v226, v120, v121, v122
    v_min3_f32 v227, v120, v121, v122
    v_max3_f32 v226, v226, v123, v216
    v_min3_f32 v227, v227, v123, v220
    v_max3_f32 v226, v226, v217, v218
    v_min3_f32 v227, v227, v221, v222
    v_max_f32 v226, v226, v219
    v_min_f32 v227, v227, v223
    s_waitcnt lgkmcnt(0)
    s_barrier
    s_and_b32 s27, s20, 3
    s_lshl_b32 s27, s27, 9
    s_lshr_b32 s28, s20, 2
    s_lshl_b32 s28, s28, 9
    s_add_u32 s28, s28, 2048
    s_add_u32 s27, s27, 101376
    s_add_u32 s28, s28, 101376
    v_lshl_add_u32 v9, v1, 3, s27
    v_lshl_add_u32 v10, v1, 3, s28
    ds_read_b64 v[88:89], v9 offset:0
    ds_read_b64 v[104:105], v10 offset:0
    ds_read_b64 v[90:91], v9 offset:3072
    ds_read_b64 v[106:107], v10 offset:3072
    ds_read_b64 v[92:93], v9 offset:6144
    ds_read_b64 v[108:109], v10 offset:6144
    ds_read_b64 v[94:95], v9 offset:9216
    ds_read_b64 v[110:111], v10 offset:9216
    ds_read_b64 v[96:97], v9 offset:12288
    ds_read_b64 v[112:113], v10 offset:12288
    ds_read_b64 v[98:99], v9 offset:15360
    ds_read_b64 v[114:115], v10 offset:15360
    ds_read_b64 v[100:101], v9 offset:18432
    ds_read_b64 v[116:117], v10 offset:18432
    ds_read_b64 v[102:103], v9 offset:21504
    ds_read_b64 v[118:119], v10 offset:21504
    v_mov_b32 v228, v226
    v_mov_b32 v231, v227
    s_nop 0
    v_permlane16_swap_b32 v226, v228
    v_permlane16_swap_b32 v227, v231
    v_max_f32 v226, v226, v228
    v_min_f32 v227, v227, v231
    v_mov_b32 v228, v226
    v_mov_b32 v231, v227
    s_nop 0
    v_permlane32_swap_b32 v226, v228
    v_permlane32_swap_b32 v227, v231
    v_max_f32 v226, v226, v228
    v_min_f32 v227, v227, v231
    v_mul_f32 v226, 1069066811, v226
    v_mul_f32 v227, 1069066811, v227
    v_fma_f32 v232, v120, s26, -v226
    v_fma_f32 v240, -v120, s26, v227
    v_fma_f32 v233, v121, s26, -v226
    v_fma_f32 v241, -v121, s26, v227
    v_fma_f32 v234, v122, s26, -v226
    v_fma_f32 v242, -v122, s26, v227
    v_fma_f32 v235, v123, s26, -v226
    v_fma_f32 v243, -v123, s26, v227
    v_fma_f32 v236, v216, s26, -v226
    v_fma_f32 v244, -v220, s26, v227
    v_fma_f32 v237, v217, s26, -v226
    v_fma_f32 v245, -v221, s26, v227
    v_fma_f32 v238, v218, s26, -v226
    v_fma_f32 v246, -v222, s26, v227
    v_fma_f32 v239, v219, s26, -v226
    v_fma_f32 v247, -v223, s26, v227
    s_waitcnt lgkmcnt(14)
    v_mfma_f32_16x16x16_bf16 v[72:75], v[88:89], v[104:105], 0
    s_waitcnt lgkmcnt(12)
    v_mfma_f32_16x16x16_bf16 v[72:75], v[90:91], v[106:107], v[72:75]
    s_waitcnt lgkmcnt(10)
    v_mfma_f32_16x16x16_bf16 v[72:75], v[92:93], v[108:109], v[72:75]
    s_waitcnt lgkmcnt(8)
    v_mfma_f32_16x16x16_bf16 v[72:75], v[94:95], v[110:111], v[72:75]
    s_waitcnt lgkmcnt(6)
    v_mfma_f32_16x16x16_bf16 v[72:75], v[96:97], v[112:113], v[72:75]
    s_waitcnt lgkmcnt(4)
    v_mfma_f32_16x16x16_bf16 v[72:75], v[98:99], v[114:115], v[72:75]
    s_waitcnt lgkmcnt(2)
    v_mfma_f32_16x16x16_bf16 v[72:75], v[100:101], v[116:117], v[72:75]
    s_waitcnt lgkmcnt(0)
    v_mfma_f32_16x16x16_bf16 v[72:75], v[102:103], v[118:119], v[72:75]
    v_exp_f32 v232, v232
    v_exp_f32 v240, v240
    v_exp_f32 v233, v233
    v_exp_f32 v241, v241
    v_exp_f32 v234, v234
    v_exp_f32 v242, v242
    v_exp_f32 v235, v235
    v_exp_f32 v243, v243
    v_exp_f32 v236, v236
    v_exp_f32 v244, v244
    v_exp_f32 v237, v237
    v_exp_f32 v245, v245
    v_exp_f32 v238, v238
    v_exp_f32 v246, v246
    v_exp_f32 v239, v239
    v_exp_f32 v247, v247
    v_add_f32 v229, v232, v233
    v_add_f32 v230, v240, v241
    v_add_f32 v229, v229, v234
    v_add_f32 v230, v230, v242
    v_add_f32 v229, v229, v235
    v_add_f32 v230, v230, v243
    v_add_f32 v229, v229, v236
    v_add_f32 v230, v230, v244
    v_add_f32 v229, v229, v237
    v_add_f32 v230, v230, v245
    v_add_f32 v229, v229, v238
    v_add_f32 v230, v230, v246
    v_add_f32 v229, v229, v239
    v_add_f32 v230, v230, v247
    s_lshl_b32 s27, s22, 13
    s_lshl_b32 s28, s20, 10
    s_add_u32 s27, s27, s28
    s_add_u32 s27, s27, 20971520
    v_lshlrev_b32 v9, 2, v1
    s_waitcnt vmcnt(0)
    v_readfirstlane_b32 s28, v14
    s_nop 3
    s_cmp_lg_u32 s28, 0
    s_cbranch_scc1 L_flagok_k1a_kernel
    s_nop 4
L_spin_k1a_kernel:
    s_sleep 2
    buffer_load_dword v14, v15, s[16:19], s31 offen offset:64 sc1
    s_waitcnt vmcnt(0) lgkmcnt(0)
    v_readfirstlane_b32 s28, v14
    s_nop 3
    s_cmp_eq_u32 s28, 0
    s_cbranch_scc1 L_spin_k1a_kernel
    s_nop 4
L_flagok_k1a_kernel:
    buffer_atomic_add_f32 v72, v9, s[8:11], s27 offen offset:0
    buffer_atomic_add_f32 v73, v9, s[8:11], s27 offen offset:256
    buffer_atomic_add_f32 v74, v9, s[8:11], s27 offen offset:512
    buffer_atomic_add_f32 v75, v9, s[8:11], s27 offen offset:768
    v_mov_b32 v228, v229
    v_mov_b32 v231, v230
    s_nop 0
    v_permlane16_swap_b32 v229, v228
    v_permlane16_swap_b32 v230, v231
    v_add_f32 v229, v229, v228
    v_add_f32 v230, v230, v231
    v_mov_b32 v228, v229
    v_mov_b32 v231, v230
    s_nop 0
    v_permlane32_swap_b32 v229, v228
    v_permlane32_swap_b32 v230, v231
    v_add_f32 v229, v229, v228
    v_add_f32 v230, v230, v231
    v_rcp_f32 v229, v229
    v_rcp_f32 v230, v230
    v_mul_f32 v232, v232, v229
    v_mul_f32 v240, v240, v230
    v_mul_f32 v233, v233, v229
    v_mul_f32 v241, v241, v230
    v_mul_f32 v234, v234, v229
    v_mul_f32 v242, v242, v230
    v_mul_f32 v235, v235, v229
    v_mul_f32 v243, v243, v230
    v_mul_f32 v236, v236, v229
    v_mul_f32 v244, v244, v230
    v_mul_f32 v237, v237, v229
    v_mul_f32 v245, v245, v230
    v_mul_f32 v238, v238, v229
    v_mul_f32 v246, v246, v230
    v_mul_f32 v239, v239, v229
    v_mul_f32 v247, v247, v230
    v_cvt_pk_bf16_f32 v204, v232, v233
    v_cvt_pk_bf16_f32 v208, v240, v241
    v_cvt_pk_bf16_f32 v205, v234, v235
    v_cvt_pk_bf16_f32 v209, v242, v243
    v_cvt_pk_bf16_f32 v206, v236, v237
    v_cvt_pk_bf16_f32 v210, v244, v245
    v_cvt_pk_bf16_f32 v207, v238, v239
    v_cvt_pk_bf16_f32 v211, v246, v247
    s_lshl_b32 s27, s23, 4
    s_add_u32 s27, s27, s22
    s_lshl_b32 s27, s27, 11
    s_add_u32 s27, s27, 16777216
    buffer_store_dwordx4 v[204:207], v5, s[8:11], s27 offen
    buffer_store_dwordx4 v[208:211], v5, s[8:11], s27 offen offset:1024
    s_nop 4
L_end_k1a_kernel:
    s_endpgm

.globl k2a_kernel
.p2align 8
.type k2a_kernel,@function
k2a_kernel:
    s_cmp_ge_u32 s2, 252
    s_cbranch_scc1 L_end_k2a_kernel
    s_load_dwordx2 s[4:5], s[0:1], 88
    s_load_dwordx2 s[12:13], s[0:1], 0
    v_and_b32 v1, 63, v0
    v_lshrrev_b32 v2, 6, v0
    s_nop 0
    v_readfirstlane_b32 s20, v2
    v_and_b32 v3, 15, v1
    v_lshrrev_b32 v4, 4, v1
    v_lshlrev_b32 v5, 4, v1
    s_waitcnt lgkmcnt(0)
    s_mov_b32 s8, s4
    s_and_b32 s9, s5, 65535
    s_mov_b32 s10, 268435456
    s_mov_b32 s11, 131072
    s_and_b32 s13, s13, 65535
    s_mov_b32 s14, 1835008
    s_mov_b32 s15, 131072
    s_cmp_ge_u32 s2, 224
    s_cbranch_scc1 L_prep_k2a_kernel
    s_and_b32 s26, s2, 7
    s_lshr_b32 s27, s2, 3
    s_mul_i32 s28, s27, 37
    s_lshr_b32 s28, s28, 8
    s_mul_i32 s22, s28, 7
    s_sub_u32 s22, s27, s22
    s_lshl_b32 s21, s26, 2
    s_add_u32 s21, s21, s28
    v_lshlrev_b32 v7, 2, v1
    v_cmp_eq_u32 s[48:49], 3, v4
    s_lshl_b32 s26, s20, 1
    s_add_u32 s26, s26, 0
    s_lshl_b32 s27, s26, 13
    s_add_u32 s27, s27, 20971520
    buffer_load_dword v128, v7, s[8:11], s27 offen offset:0
    buffer_load_dword v129, v7, s[8:11], s27 offen offset:256
    buffer_load_dword v130, v7, s[8:11], s27 offen offset:512
    buffer_load_dword v131, v7, s[8:11], s27 offen offset:768
    buffer_load_dword v132, v7, s[8:11], s27 offen offset:1024
    buffer_load_dword v133, v7, s[8:11], s27 offen offset:1280
    buffer_load_dword v134, v7, s[8:11], s27 offen offset:1536
    buffer_load_dword v135, v7, s[8:11], s27 offen offset:1792
    buffer_load_dword v136, v7, s[8:11], s27 offen offset:2048
    buffer_load_dword v137, v7, s[8:11], s27 offen offset:2304
    buffer_load_dword v138, v7, s[8:11], s27 offen offset:2560
    buffer_load_dword v139, v7, s[8:11], s27 offen offset:2816
    buffer_load_dword v140, v7, s[8:11], s27 offen offset:3072
    buffer_load_dword v141, v7, s[8:11], s27 offen offset:3328
    buffer_load_dword v142, v7, s[8:11], s27 offen offset:3584
    buffer_load_dword v143, v7, s[8:11], s27 offen offset:3840
    s_add_u32 s27, s27, 4096
    buffer_load_dword v144, v7, s[8:11], s27 offen offset:0
    buffer_load_dword v145, v7, s[8:11], s27 offen offset:256
    buffer_load_dword v146, v7, s[8:11], s27 offen offset:512
    buffer_load_dword v147, v7, s[8:11], s27 offen offset:768
    buffer_load_dword v148, v7, s[8:11], s27 offen offset:1024
    buffer_load_dword v149, v7, s[8:11], s27 offen offset:1280
    buffer_load_dword v150, v7, s[8:11], s27 offen offset:1536
    buffer_load_dword v151, v7, s[8:11], s27 offen offset:1792
    buffer_load_dword v152, v7, s[8:11], s27 offen offset:2048
    buffer_load_dword v153, v7, s[8:11], s27 offen offset:2304
    buffer_load_dword v154, v7, s[8:11], s27 offen offset:2560
    buffer_load_dword v155, v7, s[8:11], s27 offen offset:2816
    buffer_load_dword v156, v7, s[8:11], s27 offen offset:3072
    buffer_load_dword v157, v7, s[8:11], s27 offen offset:3328
    buffer_load_dword v158, v7, s[8:11], s27 offen offset:3584
    buffer_load_dword v159, v7, s[8:11], s27 offen offset:3840
    s_lshl_b32 s27, s21, 17
    s_lshl_b32 s28, s26, 11
    s_add_u32 s27, s27, s28
    s_add_u32 s27, s27, 16777216
    buffer_load_dwordx4 v[192:195], v5, s[8:11], s27 offen offset:0
    buffer_load_dwordx4 v[196:199], v5, s[8:11], s27 offen offset:1024
    s_add_u32 s27, s27, 32768
    buffer_load_dwordx4 v[200:203], v5, s[8:11], s27 offen offset:0
    buffer_load_dwordx4 v[204:207], v5, s[8:11], s27 offen offset:1024
    s_add_u32 s27, s27, 32768
    buffer_load_dwordx4 v[208:211], v5, s[8:11], s27 offen offset:0
    buffer_load_dwordx4 v[212:215], v5, s[8:11], s27 offen offset:1024
    s_add_u32 s27, s27, 32768
    buffer_load_dwordx4 v[216:219], v5, s[8:11], s27 offen offset:0
    buffer_load_dwordx4 v[220:223], v5, s[8:11], s27 offen offset:1024
    s_lshl_b32 s27, s22, 16
    s_lshl_b32 s28, s26, 10
    s_add_u32 s27, s27, s28
    s_add_u32 s27, s27, 24182784
    buffer_load_dwordx4 v[16:19], v5, s[8:11], s27 offen
    s_add_u32 s27, s27, 16384
    buffer_load_dwordx4 v[20:23], v5, s[8:11], s27 offen
    s_add_u32 s27, s27, 16384
    buffer_load_dwordx4 v[24:27], v5, s[8:11], s27 offen
    s_add_u32 s27, s27, 16384
    buffer_load_dwordx4 v[28:31], v5, s[8:11], s27 offen
    s_lshl_b32 s26, s20, 1
    s_add_u32 s26, s26, 1
    s_lshl_b32 s27, s26, 13
    s_add_u32 s27, s27, 20971520
    buffer_load_dword v160, v7, s[8:11], s27 offen offset:0
    buffer_load_dword v161, v7, s[8:11], s27 offen offset:256
    buffer_load_dword v162, v7, s[8:11], s27 offen offset:512
    buffer_load_dword v163, v7, s[8:11], s27 offen offset:768
    buffer_load_dword v164, v7, s[8:11], s27 offen offset:1024
    buffer_load_dword v165, v7, s[8:11], s27 offen offset:1280
    buffer_load_dword v166, v7, s[8:11], s27 offen offset:1536
    buffer_load_dword v167, v7, s[8:11], s27 offen offset:1792
    buffer_load_dword v168, v7, s[8:11], s27 offen offset:2048
    buffer_load_dword v169, v7, s[8:11], s27 offen offset:2304
    buffer_load_dword v170, v7, s[8:11], s27 offen offset:2560
    buffer_load_dword v171, v7, s[8:11], s27 offen offset:2816
    buffer_load_dword v172, v7, s[8:11], s27 offen offset:3072
    buffer_load_dword v173, v7, s[8:11], s27 offen offset:3328
    buffer_load_dword v174, v7, s[8:11], s27 offen offset:3584
    buffer_load_dword v175, v7, s[8:11], s27 offen offset:3840
    s_add_u32 s27, s27, 4096
    buffer_load_dword v176, v7, s[8:11], s27 offen offset:0
    buffer_load_dword v177, v7, s[8:11], s27 offen offset:256
    buffer_load_dword v178, v7, s[8:11], s27 offen offset:512
    buffer_load_dword v179, v7, s[8:11], s27 offen offset:768
    buffer_load_dword v180, v7, s[8:11], s27 offen offset:1024
    buffer_load_dword v181, v7, s[8:11], s27 offen offset:1280
    buffer_load_dword v182, v7, s[8:11], s27 offen offset:1536
    buffer_load_dword v183, v7, s[8:11], s27 offen offset:1792
    buffer_load_dword v184, v7, s[8:11], s27 offen offset:2048
    buffer_load_dword v185, v7, s[8:11], s27 offen offset:2304
    buffer_load_dword v186, v7, s[8:11], s27 offen offset:2560
    buffer_load_dword v187, v7, s[8:11], s27 offen offset:2816
    buffer_load_dword v188, v7, s[8:11], s27 offen offset:3072
    buffer_load_dword v189, v7, s[8:11], s27 offen offset:3328
    buffer_load_dword v190, v7, s[8:11], s27 offen offset:3584
    buffer_load_dword v191, v7, s[8:11], s27 offen offset:3840
    s_lshl_b32 s27, s21, 17
    s_lshl_b32 s28, s26, 11
    s_add_u32 s27, s27, s28
    s_add_u32 s27, s27, 16777216
    buffer_load_dwordx4 v[224:227], v5, s[8:11], s27 offen offset:0
    buffer_load_dwordx4 v[228:231], v5, s[8:11], s27 offen offset:1024
    s_add_u32 s27, s27, 32768
    buffer_load_dwordx4 v[232:235], v5, s[8:11], s27 offen offset:0
    buffer_load_dwordx4 v[236:239], v5, s[8:11], s27 offen offset:1024
    s_add_u32 s27, s27, 32768
    buffer_load_dwordx4 v[240:243], v5, s[8:11], s27 offen offset:0
    buffer_load_dwordx4 v[244:247], v5, s[8:11], s27 offen offset:1024
    s_add_u32 s27, s27, 32768
    buffer_load_dwordx4 v[248:251], v5, s[8:11], s27 offen offset:0
    buffer_load_dwordx4 v[252:255], v5, s[8:11], s27 offen offset:1024
    s_lshl_b32 s27, s22, 16
    s_lshl_b32 s28, s26, 10
    s_add_u32 s27, s27, s28
    s_add_u32 s27, s27, 24182784
    buffer_load_dwordx4 v[32:35], v5, s[8:11], s27 offen
    s_add_u32 s27, s27, 16384
    buffer_load_dwordx4 v[36:39], v5, s[8:11], s27 offen
    s_add_u32 s27, s27, 16384
    buffer_load_dwordx4 v[40:43], v5, s[8:11], s27 offen
    s_add_u32 s27, s27, 16384
    buffer_load_dwordx4 v[44:47], v5, s[8:11], s27 offen
    s_waitcnt vmcnt(63)
    v_cvt_pk_bf16_f32 v128, v128, v129
    v_cvt_pk_bf16_f32 v129, v130, v131
    v_cvt_pk_bf16_f32 v130, v132, v133
    v_cvt_pk_bf16_f32 v131, v134, v135
    v_cvt_pk_bf16_f32 v132, v136, v137
    v_cvt_pk_bf16_f32 v133, v138, v139
    v_cvt_pk_bf16_f32 v134, v140, v141
    v_cvt_pk_bf16_f32 v135, v142, v143
    v_cvt_pk_bf16_f32 v136, v144, v145
    v_cvt_pk_bf16_f32 v137, v146, v147
    v_cvt_pk_bf16_f32 v138, v148, v149
    v_cvt_pk_bf16_f32 v139, v150, v151
    s_waitcnt vmcnt(62)
    v_cvt_pk_bf16_f32 v140, v152, v153
    s_waitcnt vmcnt(60)
    v_cvt_pk_bf16_f32 v141, v154, v155
    s_waitcnt vmcnt(58)
    v_cvt_pk_bf16_f32 v142, v156, v157
    s_waitcnt vmcnt(56)
    v_cvt_pk_bf16_f32 v143, v158, v159
    s_waitcnt vmcnt(55)
    v_mfma_f32_16x16x32_bf16 v[48:51], v[128:131], v[192:195], 0
    s_waitcnt vmcnt(54)
    v_mfma_f32_16x16x32_bf16 v[48:51], v[132:135], v[196:199], v[48:51]
    v_mfma_f32_16x16x32_bf16 v[52:55], v[136:139], v[192:195], 0
    v_mfma_f32_16x16x32_bf16 v[52:55], v[140:143], v[196:199], v[52:55]
    s_waitcnt vmcnt(53)
    v_mfma_f32_16x16x32_bf16 v[56:59], v[128:131], v[200:203], 0
    s_waitcnt vmcnt(52)
    v_mfma_f32_16x16x32_bf16 v[56:59], v[132:135], v[204:207], v[56:59]
    v_mfma_f32_16x16x32_bf16 v[60:63], v[136:139], v[200:203], 0
    v_mfma_f32_16x16x32_bf16 v[60:63], v[140:143], v[204:207], v[60:63]
    v_cvt_pk_bf16_f32 v152, v48, v49
    v_cvt_pk_bf16_f32 v153, v50, v51
    v_cvt_pk_bf16_f32 v154, v52, v53
    v_cvt_pk_bf16_f32 v155, v54, v55
    v_lshlrev_b32 v48, 16, v152
    v_and_b32 v49, 4294901760, v152
    v_lshlrev_b32 v50, 16, v153
    v_and_b32 v51, 4294901760, v153
    v_lshlrev_b32 v52, 16, v154
    v_and_b32 v53, 4294901760, v154
    v_lshlrev_b32 v54, 16, v155
    v_and_b32 v55, 4294901760, v155
    v_cndmask_b32 v156, 0, v52, s[48:49]
    v_mov_b32 v157, v156
    s_nop 1
    v_permlane16_swap_b32 v156, v157
    v_add_f32 v156, v156, v157
    v_mov_b32 v157, v156
    s_nop 1
    v_permlane32_swap_b32 v156, v157
    v_add_f32 v156, v156, v157
    v_add_f32 v156, 897988541, v156
    v_cvt_pk_bf16_f32 v156, v156, v156
    v_lshlrev_b32 v156, 16, v156
    v_rcp_f32 v156, v156
    s_nop 0
    v_mul_f32 v48, v48, v156
    v_mul_f32 v49, v49, v156
    v_mul_f32 v50, v50, v156
    v_mul_f32 v51, v51, v156
    v_mul_f32 v52, v52, v156
    v_mul_f32 v53, v53, v156
    v_mul_f32 v54, v54, v156
    v_mul_f32 v55, v55, v156
    v_cvt_pk_bf16_f32 v144, v48, v49
    v_cvt_pk_bf16_f32 v145, v50, v51
    v_cvt_pk_bf16_f32 v146, v52, v53
    v_cvt_pk_bf16_f32 v147, v54, v55
    v_cvt_pk_bf16_f32 v152, v56, v57
    v_cvt_pk_bf16_f32 v153, v58, v59
    v_cvt_pk_bf16_f32 v154, v60, v61
    v_cvt_pk_bf16_f32 v155, v62, v63
    v_lshlrev_b32 v56, 16, v152
    v_and_b32 v57, 4294901760, v152
    v_lshlrev_b32 v58, 16, v153
    v_and_b32 v59, 4294901760, v153
    v_lshlrev_b32 v60, 16, v154
    v_and_b32 v61, 4294901760, v154
    v_lshlrev_b32 v62, 16, v155
    v_and_b32 v63, 4294901760, v155
    v_cndmask_b32 v156, 0, v60, s[48:49]
    v_mov_b32 v157, v156
    s_nop 1
    v_permlane16_swap_b32 v156, v157
    v_add_f32 v156, v156, v157
    v_mov_b32 v157, v156
    s_nop 1
    v_permlane32_swap_b32 v156, v157
    v_add_f32 v156, v156, v157
    v_add_f32 v156, 897988541, v156
    v_cvt_pk_bf16_f32 v156, v156, v156
    v_lshlrev_b32 v156, 16, v156
    v_rcp_f32 v156, v156
    s_nop 0
    v_mul_f32 v56, v56, v156
    v_mul_f32 v57, v57, v156
    v_mul_f32 v58, v58, v156
    v_mul_f32 v59, v59, v156
    v_mul_f32 v60, v60, v156
    v_mul_f32 v61, v61, v156
    v_mul_f32 v62, v62, v156
    v_mul_f32 v63, v63, v156
    v_cvt_pk_bf16_f32 v148, v56, v57
    v_cvt_pk_bf16_f32 v149, v58, v59
    v_cvt_pk_bf16_f32 v150, v60, v61
    v_cvt_pk_bf16_f32 v151, v62, v63
    s_waitcnt vmcnt(47)
    v_mfma_f32_16x16x32_bf16 v[64:67], v[16:19], v[144:147], 0
    s_waitcnt vmcnt(46)
    v_mfma_f32_16x16x32_bf16 v[68:71], v[20:23], v[144:147], 0
    s_waitcnt vmcnt(45)
    v_mfma_f32_16x16x32_bf16 v[72:75], v[24:27], v[144:147], 0
    s_waitcnt vmcnt(44)
    v_mfma_f32_16x16x32_bf16 v[76:79], v[28:31], v[144:147], 0
    v_mfma_f32_16x16x32_bf16 v[80:83], v[16:19], v[148:151], 0
    v_mfma_f32_16x16x32_bf16 v[84:87], v[20:23], v[148:151], 0
    v_mfma_f32_16x16x32_bf16 v[88:91], v[24:27], v[148:151], 0
    v_mfma_f32_16x16x32_bf16 v[92:95], v[28:31], v[148:151], 0
    v_mfma_f32_16x16x32_bf16 v[48:51], v[128:131], v[208:211], 0
    v_mfma_f32_16x16x32_bf16 v[48:51], v[132:135], v[212:215], v[48:51]
    v_mfma_f32_16x16x32_bf16 v[52:55], v[136:139], v[208:211], 0
    v_mfma_f32_16x16x32_bf16 v[52:55], v[140:143], v[212:215], v[52:55]
    v_mfma_f32_16x16x32_bf16 v[56:59], v[128:131], v[216:219], 0
    v_mfma_f32_16x16x32_bf16 v[56:59], v[132:135], v[220:223], v[56:59]
    v_mfma_f32_16x16x32_bf16 v[60:63], v[136:139], v[216:219], 0
    v_mfma_f32_16x16x32_bf16 v[60:63], v[140:143], v[220:223], v[60:63]
    s_nop 1
    v_cvt_pk_bf16_f32 v152, v48, v49
    v_cvt_pk_bf16_f32 v153, v50, v51
    v_cvt_pk_bf16_f32 v154, v52, v53
    v_cvt_pk_bf16_f32 v155, v54, v55
    v_lshlrev_b32 v48, 16, v152
    v_and_b32 v49, 4294901760, v152
    v_lshlrev_b32 v50, 16, v153
    v_and_b32 v51, 4294901760, v153
    v_lshlrev_b32 v52, 16, v154
    v_and_b32 v53, 4294901760, v154
    v_lshlrev_b32 v54, 16, v155
    v_and_b32 v55, 4294901760, v155
    v_cndmask_b32 v156, 0, v52, s[48:49]
    v_mov_b32 v157, v156
    s_nop 1
    v_permlane16_swap_b32 v156, v157
    v_add_f32 v156, v156, v157
    v_mov_b32 v157, v156
    s_nop 1
    v_permlane32_swap_b32 v156, v157
    v_add_f32 v156, v156, v157
    v_add_f32 v156, 897988541, v156
    v_cvt_pk_bf16_f32 v156, v156, v156
    v_lshlrev_b32 v156, 16, v156
    v_rcp_f32 v156, v156
    s_nop 0
    v_mul_f32 v48, v48, v156
    v_mul_f32 v49, v49, v156
    v_mul_f32 v50, v50, v156
    v_mul_f32 v51, v51, v156
    v_mul_f32 v52, v52, v156
    v_mul_f32 v53, v53, v156
    v_mul_f32 v54, v54, v156
    v_mul_f32 v55, v55, v156
    v_cvt_pk_bf16_f32 v144, v48, v49
    v_cvt_pk_bf16_f32 v145, v50, v51
    v_cvt_pk_bf16_f32 v146, v52, v53
    v_cvt_pk_bf16_f32 v147, v54, v55
    v_cvt_pk_bf16_f32 v152, v56, v57
    v_cvt_pk_bf16_f32 v153, v58, v59
    v_cvt_pk_bf16_f32 v154, v60, v61
    v_cvt_pk_bf16_f32 v155, v62, v63
    v_lshlrev_b32 v56, 16, v152
    v_and_b32 v57, 4294901760, v152
    v_lshlrev_b32 v58, 16, v153
    v_and_b32 v59, 4294901760, v153
    v_lshlrev_b32 v60, 16, v154
    v_and_b32 v61, 4294901760, v154
    v_lshlrev_b32 v62, 16, v155
    v_and_b32 v63, 4294901760, v155
    v_cndmask_b32 v156, 0, v60, s[48:49]
    v_mov_b32 v157, v156
    s_nop 1
    v_permlane16_swap_b32 v156, v157
    v_add_f32 v156, v156, v157
    v_mov_b32 v157, v156
    s_nop 1
    v_permlane32_swap_b32 v156, v157
    v_add_f32 v156, v156, v157
    v_add_f32 v156, 897988541, v156
    v_cvt_pk_bf16_f32 v156, v156, v156
    v_lshlrev_b32 v156, 16, v156
    v_rcp_f32 v156, v156
    s_nop 0
    v_mul_f32 v56, v56, v156
    v_mul_f32 v57, v57, v156
    v_mul_f32 v58, v58, v156
    v_mul_f32 v59, v59, v156
    v_mul_f32 v60, v60, v156
    v_mul_f32 v61, v61, v156
    v_mul_f32 v62, v62, v156
    v_mul_f32 v63, v63, v156
    v_cvt_pk_bf16_f32 v148, v56, v57
    v_cvt_pk_bf16_f32 v149, v58, v59
    v_cvt_pk_bf16_f32 v150, v60, v61
    v_cvt_pk_bf16_f32 v151, v62, v63
    v_mfma_f32_16x16x32_bf16 v[96:99], v[16:19], v[144:147], 0
    v_mfma_f32_16x16x32_bf16 v[100:103], v[20:23], v[144:147], 0
    v_mfma_f32_16x16x32_bf16 v[104:107], v[24:27], v[144:147], 0
    v_mfma_f32_16x16x32_bf16 v[108:111], v[28:31], v[144:147], 0
    v_mfma_f32_16x16x32_bf16 v[112:115], v[16:19], v[148:151], 0
    v_mfma_f32_16x16x32_bf16 v[116:119], v[20:23], v[148:151], 0
    v_mfma_f32_16x16x32_bf16 v[120:123], v[24:27], v[148:151], 0
    v_mfma_f32_16x16x32_bf16 v[124:127], v[28:31], v[148:151], 0
    s_waitcnt vmcnt(42)
    v_cvt_pk_bf16_f32 v160, v160, v161
    s_waitcnt vmcnt(40)
    v_cvt_pk_bf16_f32 v161, v162, v163
    s_waitcnt vmcnt(38)
    v_cvt_pk_bf16_f32 v162, v164, v165
    s_waitcnt vmcnt(36)
    v_cvt_pk_bf16_f32 v163, v166, v167
    s_waitcnt vmcnt(34)
    v_cvt_pk_bf16_f32 v164, v168, v169
    s_waitcnt vmcnt(32)
    v_cvt_pk_bf16_f32 v165, v170, v171
    s_waitcnt vmcnt(30)
    v_cvt_pk_bf16_f32 v166, v172, v173
    s_waitcnt vmcnt(28)
    v_cvt_pk_bf16_f32 v167, v174, v175
    s_waitcnt vmcnt(26)
    v_cvt_pk_bf16_f32 v168, v176, v177
    s_waitcnt vmcnt(24)
    v_cvt_pk_bf16_f32 v169, v178, v179
    s_waitcnt vmcnt(22)
    v_cvt_pk_bf16_f32 v170, v180, v181
    s_waitcnt vmcnt(20)
    v_cvt_pk_bf16_f32 v171, v182, v183
    s_waitcnt vmcnt(18)
    v_cvt_pk_bf16_f32 v172, v184, v185
    s_waitcnt vmcnt(16)
    v_cvt_pk_bf16_f32 v173, v186, v187
    s_waitcnt vmcnt(14)
    v_cvt_pk_bf16_f32 v174, v188, v189
    s_waitcnt vmcnt(12)
    v_cvt_pk_bf16_f32 v175, v190, v191
    s_waitcnt vmcnt(11)
    v_mfma_f32_16x16x32_bf16 v[48:51], v[160:163], v[224:227], 0
    s_waitcnt vmcnt(10)
    v_mfma_f32_16x16x32_bf16 v[48:51], v[164:167], v[228:231], v[48:51]
    v_mfma_f32_16x16x32_bf16 v[52:55], v[168:171], v[224:227], 0
    v_mfma_f32_16x16x32_bf16 v[52:55], v[172:175], v[228:231], v[52:55]
    s_waitcnt vmcnt(9)
    v_mfma_f32_16x16x32_bf16 v[56:59], v[160:163], v[232:235], 0
    s_waitcnt vmcnt(8)
    v_mfma_f32_16x16x32_bf16 v[56:59], v[164:167], v[236:239], v[56:59]
    v_mfma_f32_16x16x32_bf16 v[60:63], v[168:171], v[232:235], 0
    v_mfma_f32_16x16x32_bf16 v[60:63], v[172:175], v[236:239], v[60:63]
    v_cvt_pk_bf16_f32 v184, v48, v49
    v_cvt_pk_bf16_f32 v185, v50, v51
    v_cvt_pk_bf16_f32 v186, v52, v53
    v_cvt_pk_bf16_f32 v187, v54, v55
    v_lshlrev_b32 v48, 16, v184
    v_and_b32 v49, 4294901760, v184
    v_lshlrev_b32 v50, 16, v185
    v_and_b32 v51, 4294901760, v185
    v_lshlrev_b32 v52, 16, v186
    v_and_b32 v53, 4294901760, v186
    v_lshlrev_b32 v54, 16, v187
    v_and_b32 v55, 4294901760, v187
    v_cndmask_b32 v188, 0, v52, s[48:49]
    v_mov_b32 v189, v188
    s_nop 1
    v_permlane16_swap_b32 v188, v189
    v_add_f32 v188, v188, v189
    v_mov_b32 v189, v188
    s_nop 1
    v_permlane32_swap_b32 v188, v189
    v_add_f32 v188, v188, v189
    v_add_f32 v188, 897988541, v188
    v_cvt_pk_bf16_f32 v188, v188, v188
    v_lshlrev_b32 v188, 16, v188
    v_rcp_f32 v188, v188
    s_nop 0
    v_mul_f32 v48, v48, v188
    v_mul_f32 v49, v49, v188
    v_mul_f32 v50, v50, v188
    v_mul_f32 v51, v51, v188
    v_mul_f32 v52, v52, v188
    v_mul_f32 v53, v53, v188
    v_mul_f32 v54, v54, v188
    v_mul_f32 v55, v55, v188
    v_cvt_pk_bf16_f32 v176, v48, v49
    v_cvt_pk_bf16_f32 v177, v50, v51
    v_cvt_pk_bf16_f32 v178, v52, v53
    v_cvt_pk_bf16_f32 v179, v54, v55
    v_cvt_pk_bf16_f32 v184, v56, v57
    v_cvt_pk_bf16_f32 v185, v58, v59
    v_cvt_pk_bf16_f32 v186, v60, v61
    v_cvt_pk_bf16_f32 v187, v62, v63
    v_lshlrev_b32 v56, 16, v184
    v_and_b32 v57, 4294901760, v184
    v_lshlrev_b32 v58, 16, v185
    v_and_b32 v59, 4294901760, v185
    v_lshlrev_b32 v60, 16, v186
    v_and_b32 v61, 4294901760, v186
    v_lshlrev_b32 v62, 16, v187
    v_and_b32 v63, 4294901760, v187
    v_cndmask_b32 v188, 0, v60, s[48:49]
    v_mov_b32 v189, v188
    s_nop 1
    v_permlane16_swap_b32 v188, v189
    v_add_f32 v188, v188, v189
    v_mov_b32 v189, v188
    s_nop 1
    v_permlane32_swap_b32 v188, v189
    v_add_f32 v188, v188, v189
    v_add_f32 v188, 897988541, v188
    v_cvt_pk_bf16_f32 v188, v188, v188
    v_lshlrev_b32 v188, 16, v188
    v_rcp_f32 v188, v188
    s_nop 0
    v_mul_f32 v56, v56, v188
    v_mul_f32 v57, v57, v188
    v_mul_f32 v58, v58, v188
    v_mul_f32 v59, v59, v188
    v_mul_f32 v60, v60, v188
    v_mul_f32 v61, v61, v188
    v_mul_f32 v62, v62, v188
    v_mul_f32 v63, v63, v188
    v_cvt_pk_bf16_f32 v180, v56, v57
    v_cvt_pk_bf16_f32 v181, v58, v59
    v_cvt_pk_bf16_f32 v182, v60, v61
    v_cvt_pk_bf16_f32 v183, v62, v63
    s_waitcnt vmcnt(3)
    v_mfma_f32_16x16x32_bf16 v[64:67], v[32:35], v[176:179], v[64:67]
    s_waitcnt vmcnt(2)
    v_mfma_f32_16x16x32_bf16 v[68:71], v[36:39], v[176:179], v[68:71]
    s_waitcnt vmcnt(1)
    v_mfma_f32_16x16x32_bf16 v[72:75], v[40:43], v[176:179], v[72:75]
    s_waitcnt vmcnt(0)
    v_mfma_f32_16x16x32_bf16 v[76:79], v[44:47], v[176:179], v[76:79]
    v_mfma_f32_16x16x32_bf16 v[80:83], v[32:35], v[180:183], v[80:83]
    v_mfma_f32_16x16x32_bf16 v[84:87], v[36:39], v[180:183], v[84:87]
    v_mfma_f32_16x16x32_bf16 v[88:91], v[40:43], v[180:183], v[88:91]
    v_mfma_f32_16x16x32_bf16 v[92:95], v[44:47], v[180:183], v[92:95]
    v_mfma_f32_16x16x32_bf16 v[48:51], v[160:163], v[240:243], 0
    v_mfma_f32_16x16x32_bf16 v[48:51], v[164:167], v[244:247], v[48:51]
    v_mfma_f32_16x16x32_bf16 v[52:55], v[168:171], v[240:243], 0
    v_mfma_f32_16x16x32_bf16 v[52:55], v[172:175], v[244:247], v[52:55]
    v_mfma_f32_16x16x32_bf16 v[56:59], v[160:163], v[248:251], 0
    v_mfma_f32_16x16x32_bf16 v[56:59], v[164:167], v[252:255], v[56:59]
    v_mfma_f32_16x16x32_bf16 v[60:63], v[168:171], v[248:251], 0
    v_mfma_f32_16x16x32_bf16 v[60:63], v[172:175], v[252:255], v[60:63]
    s_nop 1
    v_cvt_pk_bf16_f32 v184, v48, v49
    v_cvt_pk_bf16_f32 v185, v50, v51
    v_cvt_pk_bf16_f32 v186, v52, v53
    v_cvt_pk_bf16_f32 v187, v54, v55
    v_lshlrev_b32 v48, 16, v184
    v_and_b32 v49, 4294901760, v184
    v_lshlrev_b32 v50, 16, v185
    v_and_b32 v51, 4294901760, v185
    v_lshlrev_b32 v52, 16, v186
    v_and_b32 v53, 4294901760, v186
    v_lshlrev_b32 v54, 16, v187
    v_and_b32 v55, 4294901760, v187
    v_cndmask_b32 v188, 0, v52, s[48:49]
    v_mov_b32 v189, v188
    s_nop 1
    v_permlane16_swap_b32 v188, v189
    v_add_f32 v188, v188, v189
    v_mov_b32 v189, v188
    s_nop 1
    v_permlane32_swap_b32 v188, v189
    v_add_f32 v188, v188, v189
    v_add_f32 v188, 897988541, v188
    v_cvt_pk_bf16_f32 v188, v188, v188
    v_lshlrev_b32 v188, 16, v188
    v_rcp_f32 v188, v188
    s_nop 0
    v_mul_f32 v48, v48, v188
    v_mul_f32 v49, v49, v188
    v_mul_f32 v50, v50, v188
    v_mul_f32 v51, v51, v188
    v_mul_f32 v52, v52, v188
    v_mul_f32 v53, v53, v188
    v_mul_f32 v54, v54, v188
    v_mul_f32 v55, v55, v188
    v_cvt_pk_bf16_f32 v176, v48, v49
    v_cvt_pk_bf16_f32 v177, v50, v51
    v_cvt_pk_bf16_f32 v178, v52, v53
    v_cvt_pk_bf16_f32 v179, v54, v55
    v_cvt_pk_bf16_f32 v184, v56, v57
    v_cvt_pk_bf16_f32 v185, v58, v59
    v_cvt_pk_bf16_f32 v186, v60, v61
    v_cvt_pk_bf16_f32 v187, v62, v63
    v_lshlrev_b32 v56, 16, v184
    v_and_b32 v57, 4294901760, v184
    v_lshlrev_b32 v58, 16, v185
    v_and_b32 v59, 4294901760, v185
    v_lshlrev_b32 v60, 16, v186
    v_and_b32 v61, 4294901760, v186
    v_lshlrev_b32 v62, 16, v187
    v_and_b32 v63, 4294901760, v187
    v_cndmask_b32 v188, 0, v60, s[48:49]
    v_mov_b32 v189, v188
    s_nop 1
    v_permlane16_swap_b32 v188, v189
    v_add_f32 v188, v188, v189
    v_mov_b32 v189, v188
    s_nop 1
    v_permlane32_swap_b32 v188, v189
    v_add_f32 v188, v188, v189
    v_add_f32 v188, 897988541, v188
    v_cvt_pk_bf16_f32 v188, v188, v188
    v_lshlrev_b32 v188, 16, v188
    v_rcp_f32 v188, v188
    s_nop 0
    v_mul_f32 v56, v56, v188
    v_mul_f32 v57, v57, v188
    v_mul_f32 v58, v58, v188
    v_mul_f32 v59, v59, v188
    v_mul_f32 v60, v60, v188
    v_mul_f32 v61, v61, v188
    v_mul_f32 v62, v62, v188
    v_mul_f32 v63, v63, v188
    v_cvt_pk_bf16_f32 v180, v56, v57
    v_cvt_pk_bf16_f32 v181, v58, v59
    v_cvt_pk_bf16_f32 v182, v60, v61
    v_cvt_pk_bf16_f32 v183, v62, v63
    v_mfma_f32_16x16x32_bf16 v[96:99], v[32:35], v[176:179], v[96:99]
    v_mfma_f32_16x16x32_bf16 v[100:103], v[36:39], v[176:179], v[100:103]
    v_mfma_f32_16x16x32_bf16 v[104:107], v[40:43], v[176:179], v[104:107]
    v_mfma_f32_16x16x32_bf16 v[108:111], v[44:47], v[176:179], v[108:111]
    v_mfma_f32_16x16x32_bf16 v[112:115], v[32:35], v[180:183], v[112:115]
    v_mfma_f32_16x16x32_bf16 v[116:119], v[36:39], v[180:183], v[116:119]
    v_mfma_f32_16x16x32_bf16 v[120:123], v[40:43], v[180:183], v[120:123]
    v_mfma_f32_16x16x32_bf16 v[124:127], v[44:47], v[180:183], v[124:127]
    s_nop 7
    s_nop 7
    s_lshr_b32 s26, s20, 1
    s_and_b32 s27, s20, 1
    s_lshl_b32 s28, s21, 2
    s_add_u32 s28, s28, s26
    s_lshl_b32 s29, s22, 1
    s_add_u32 s29, s29, s27
    s_mul_i32 s30, s28, 14336
    s_lshl_b32 s31, s29, 10
    s_add_u32 s30, s30, s31
    v_mul_u32_u24 v6, 896, v3
    v_lshl_add_u32 v6, v4, 3, v6
    s_mul_i32 s31, s28, 14336
    s_lshl_b32 s26, s29, 6
    s_add_u32 s31, s31, s26
    s_lshr_b32 s26, s20, 1
    buffer_load_dwordx2 v[200:201], v6, s[12:15], s31 offen
    buffer_load_dwordx2 v[202:203], v6, s[12:15], s31 offen offset:32
    s_lshl_b32 s31, s20, 14
    v_add_u32 v9, s31, v5
    ds_write_b128 v9, v[64:67] offset:0
    ds_write_b128 v9, v[68:71] offset:1024
    ds_write_b128 v9, v[72:75] offset:2048
    ds_write_b128 v9, v[76:79] offset:3072
    ds_write_b128 v9, v[80:83] offset:4096
    ds_write_b128 v9, v[84:87] offset:5120
    ds_write_b128 v9, v[88:91] offset:6144
    ds_write_b128 v9, v[92:95] offset:7168
    ds_write_b128 v9, v[96:99] offset:8192
    ds_write_b128 v9, v[100:103] offset:9216
    ds_write_b128 v9, v[104:107] offset:10240
    ds_write_b128 v9, v[108:111] offset:11264
    ds_write_b128 v9, v[112:115] offset:12288
    ds_write_b128 v9, v[116:119] offset:13312
    ds_write_b128 v9, v[120:123] offset:14336
    ds_write_b128 v9, v[124:127] offset:15360
    s_waitcnt lgkmcnt(0)
    s_barrier
    s_lshl_b32 s31, s26, 12
    s_lshl_b32 s26, s27, 11
    s_add_u32 s31, s31, s26
    v_add_u32 v9, s31, v5
    v_add_u32 v10, 65536, v9
    ds_read_b128 v[16:19], v9 offset:0
    ds_read_b128 v[20:23], v9 offset:1024
    ds_read_b128 v[24:27], v9 offset:16384
    ds_read_b128 v[28:31], v9 offset:17408
    ds_read_b128 v[32:35], v9 offset:32768
    ds_read_b128 v[36:39], v9 offset:33792
    ds_read_b128 v[40:43], v9 offset:49152
    ds_read_b128 v[44:47], v9 offset:50176
    ds_read_b128 v[48:51], v10 offset:0
    ds_read_b128 v[52:55], v10 offset:1024
    ds_read_b128 v[56:59], v10 offset:16384
    ds_read_b128 v[60:63], v10 offset:17408
    ds_read_b128 v[64:67], v10 offset:32768
    ds_read_b128 v[68:71], v10 offset:33792
    ds_read_b128 v[72:75], v10 offset:49152
    ds_read_b128 v[76:79], v10 offset:50176
    s_waitcnt lgkmcnt(13)
    v_add_f32 v16, v16, v24
    v_add_f32 v17, v17, v25
    v_add_f32 v18, v18, v26
    v_add_f32 v19, v19, v27
    s_waitcnt lgkmcnt(12)
    v_add_f32 v20, v20, v28
    v_add_f32 v21, v21, v29
    v_add_f32 v22, v22, v30
    v_add_f32 v23, v23, v31
    s_waitcnt lgkmcnt(11)
    v_add_f32 v16, v16, v32
    v_add_f32 v17, v17, v33
    v_add_f32 v18, v18, v34
    v_add_f32 v19, v19, v35
    s_waitcnt lgkmcnt(10)
    v_add_f32 v20, v20, v36
    v_add_f32 v21, v21, v37
    v_add_f32 v22, v22, v38
    v_add_f32 v23, v23, v39
    s_waitcnt lgkmcnt(9)
    v_add_f32 v16, v16, v40
    v_add_f32 v17, v17, v41
    v_add_f32 v18, v18, v42
    v_add_f32 v19, v19, v43
    s_waitcnt lgkmcnt(8)
    v_add_f32 v20, v20, v44
    v_add_f32 v21, v21, v45
    v_add_f32 v22, v22, v46
    v_add_f32 v23, v23, v47
    s_waitcnt lgkmcnt(7)
    v_add_f32 v16, v16, v48
    v_add_f32 v17, v17, v49
    v_add_f32 v18, v18, v50
    v_add_f32 v19, v19, v51
    s_waitcnt lgkmcnt(6)
    v_add_f32 v20, v20, v52
    v_add_f32 v21, v21, v53
    v_add_f32 v22, v22, v54
    v_add_f32 v23, v23, v55
    s_waitcnt lgkmcnt(5)
    v_add_f32 v16, v16, v56
    v_add_f32 v17, v17, v57
    v_add_f32 v18, v18, v58
    v_add_f32 v19, v19, v59
    s_waitcnt lgkmcnt(4)
    v_add_f32 v20, v20, v60
    v_add_f32 v21, v21, v61
    v_add_f32 v22, v22, v62
    v_add_f32 v23, v23, v63
    s_waitcnt lgkmcnt(3)
    v_add_f32 v16, v16, v64
    v_add_f32 v17, v17, v65
    v_add_f32 v18, v18, v66
    v_add_f32 v19, v19, v67
    s_waitcnt lgkmcnt(2)
    v_add_f32 v20, v20, v68
    v_add_f32 v21, v21, v69
    v_add_f32 v22, v22, v70
    v_add_f32 v23, v23, v71
    s_waitcnt lgkmcnt(1)
    v_add_f32 v16, v16, v72
    v_add_f32 v17, v17, v73
    v_add_f32 v18, v18, v74
    v_add_f32 v19, v19, v75
    s_waitcnt lgkmcnt(0)
    v_add_f32 v20, v20, v76
    v_add_f32 v21, v21, v77
    v_add_f32 v22, v22, v78
    v_add_f32 v23, v23, v79
    v_cvt_pk_bf16_f32 v24, v16, v17
    v_cvt_pk_bf16_f32 v25, v18, v19
    v_cvt_pk_bf16_f32 v26, v20, v21
    v_cvt_pk_bf16_f32 v27, v22, v23
    v_lshlrev_b32 v16, 16, v24
    v_and_b32 v17, 4294901760, v24
    v_lshlrev_b32 v18, 16, v25
    v_and_b32 v19, 4294901760, v25
    v_lshlrev_b32 v20, 16, v26
    v_and_b32 v21, 4294901760, v26
    v_lshlrev_b32 v22, 16, v27
    v_and_b32 v23, 4294901760, v27
    s_waitcnt vmcnt(1)
    v_lshlrev_b32 v24, 16, v200
    v_and_b32 v25, 4294901760, v200
    v_lshlrev_b32 v26, 16, v201
    v_and_b32 v27, 4294901760, v201
    s_waitcnt vmcnt(0)
    v_lshlrev_b32 v28, 16, v202
    v_and_b32 v29, 4294901760, v202
    v_lshlrev_b32 v30, 16, v203
    v_and_b32 v31, 4294901760, v203
    v_add_f32 v16, v16, v24
    v_add_f32 v17, v17, v25
    v_add_f32 v18, v18, v26
    v_add_f32 v19, v19, v27
    v_add_f32 v20, v20, v28
    v_add_f32 v21, v21, v29
    v_add_f32 v22, v22, v30
    v_add_f32 v23, v23, v31
    v_cvt_pk_bf16_f32 v32, v16, v17
    v_cvt_pk_bf16_f32 v33, v18, v19
    v_cvt_pk_bf16_f32 v34, v20, v21
    v_cvt_pk_bf16_f32 v35, v22, v23
    s_add_u32 s31, s30, 2097152
    buffer_store_dwordx4 v[32:35], v5, s[8:11], s31 offen
    s_branch L_end_k2a_kernel
    s_nop 4
L_prep_k2a_kernel:
    s_load_dwordx2 s[32:33], s[0:1], 40
    s_load_dwordx2 s[36:37], s[0:1], 56
    s_waitcnt lgkmcnt(0)
    s_and_b32 s33, s33, 65535
    s_mov_b32 s34, 1605632
    s_mov_b32 s35, 131072
    s_and_b32 s37, s37, 65535
    s_mov_b32 s38, 1605632
    s_mov_b32 s39, 131072
    s_sub_u32 s21, s2, 224
    s_lshl_b32 s21, s21, 3
    s_add_u32 s21, s21, s20
    s_cmp_lt_u32 s21, 112
    s_cbranch_scc1 L_p_w1_k2a_kernel
    s_cmp_lt_u32 s21, 224
    s_cbranch_scc1 L_p_w2_k2a_kernel
    s_branch L_end_k2a_kernel
    s_nop 4
L_p_w1_k2a_kernel:
    s_mov_b32 s40, s21
    s_lshl_b32 s22, s40, 5
    s_mov_b32 s46, 14336
    v_mul_lo_u32 v8, s46, v4
    v_lshl_add_u32 v8, v3, 1, v8
    v_add_u32 v9, 57344, v8
    s_lshr_b32 s47, s40, 3
    s_mul_i32 s47, s47, 114688
    s_and_b32 s46, s40, 7
    s_lshl_b32 s46, s46, 10
    s_add_u32 s47, s47, s46
    s_add_u32 s23, s22, 0
    buffer_load_ushort v96, v8, s[32:35], s23 offen
    s_add_u32 s23, s22, 3584
    buffer_load_ushort v97, v8, s[32:35], s23 offen
    s_add_u32 s23, s22, 7168
    buffer_load_ushort v98, v8, s[32:35], s23 offen
    s_add_u32 s23, s22, 10752
    buffer_load_ushort v99, v8, s[32:35], s23 offen
    s_add_u32 s23, s22, 0
    buffer_load_ushort v100, v9, s[32:35], s23 offen
    s_add_u32 s23, s22, 3584
    buffer_load_ushort v101, v9, s[32:35], s23 offen
    s_add_u32 s23, s22, 7168
    buffer_load_ushort v102, v9, s[32:35], s23 offen
    s_add_u32 s23, s22, 10752
    buffer_load_ushort v103, v9, s[32:35], s23 offen
    s_add_u32 s23, s22, 114688
    buffer_load_ushort v104, v8, s[32:35], s23 offen
    s_add_u32 s23, s22, 118272
    buffer_load_ushort v105, v8, s[32:35], s23 offen
    s_add_u32 s23, s22, 121856
    buffer_load_ushort v106, v8, s[32:35], s23 offen
    s_add_u32 s23, s22, 125440
    buffer_load_ushort v107, v8, s[32:35], s23 offen
    s_add_u32 s23, s22, 114688
    buffer_load_ushort v108, v9, s[32:35], s23 offen
    s_add_u32 s23, s22, 118272
    buffer_load_ushort v109, v9, s[32:35], s23 offen
    s_add_u32 s23, s22, 121856
    buffer_load_ushort v110, v9, s[32:35], s23 offen
    s_add_u32 s23, s22, 125440
    buffer_load_ushort v111, v9, s[32:35], s23 offen
    s_add_u32 s23, s22, 229376
    buffer_load_ushort v112, v8, s[32:35], s23 offen
    s_add_u32 s23, s22, 232960
    buffer_load_ushort v113, v8, s[32:35], s23 offen
    s_add_u32 s23, s22, 236544
    buffer_load_ushort v114, v8, s[32:35], s23 offen
    s_add_u32 s23, s22, 240128
    buffer_load_ushort v115, v8, s[32:35], s23 offen
    s_add_u32 s23, s22, 229376
    buffer_load_ushort v116, v9, s[32:35], s23 offen
    s_add_u32 s23, s22, 232960
    buffer_load_ushort v117, v9, s[32:35], s23 offen
    s_add_u32 s23, s22, 236544
    buffer_load_ushort v118, v9, s[32:35], s23 offen
    s_add_u32 s23, s22, 240128
    buffer_load_ushort v119, v9, s[32:35], s23 offen
    s_add_u32 s23, s22, 344064
    buffer_load_ushort v120, v8, s[32:35], s23 offen
    s_add_u32 s23, s22, 347648
    buffer_load_ushort v121, v8, s[32:35], s23 offen
    s_add_u32 s23, s22, 351232
    buffer_load_ushort v122, v8, s[32:35], s23 offen
    s_add_u32 s23, s22, 354816
    buffer_load_ushort v123, v8, s[32:35], s23 offen
    s_add_u32 s23, s22, 344064
    buffer_load_ushort v124, v9, s[32:35], s23 offen
    s_add_u32 s23, s22, 347648
    buffer_load_ushort v125, v9, s[32:35], s23 offen
    s_add_u32 s23, s22, 351232
    buffer_load_ushort v126, v9, s[32:35], s23 offen
    s_add_u32 s23, s22, 354816
    buffer_load_ushort v127, v9, s[32:35], s23 offen
    s_add_u32 s23, s22, 458752
    buffer_load_ushort v128, v8, s[32:35], s23 offen
    s_add_u32 s23, s22, 462336
    buffer_load_ushort v129, v8, s[32:35], s23 offen
    s_add_u32 s23, s22, 465920
    buffer_load_ushort v130, v8, s[32:35], s23 offen
    s_add_u32 s23, s22, 469504
    buffer_load_ushort v131, v8, s[32:35], s23 offen
    s_add_u32 s23, s22, 458752
    buffer_load_ushort v132, v9, s[32:35], s23 offen
    s_add_u32 s23, s22, 462336
    buffer_load_ushort v133, v9, s[32:35], s23 offen
    s_add_u32 s23, s22, 465920
    buffer_load_ushort v134, v9, s[32:35], s23 offen
    s_add_u32 s23, s22, 469504
    buffer_load_ushort v135, v9, s[32:35], s23 offen
    s_add_u32 s23, s22, 573440
    buffer_load_ushort v136, v8, s[32:35], s23 offen
    s_add_u32 s23, s22, 577024
    buffer_load_ushort v137, v8, s[32:35], s23 offen
    s_add_u32 s23, s22, 580608
    buffer_load_ushort v138, v8, s[32:35], s23 offen
    s_add_u32 s23, s22, 584192
    buffer_load_ushort v139, v8, s[32:35], s23 offen
    s_add_u32 s23, s22, 573440
    buffer_load_ushort v140, v9, s[32:35], s23 offen
    s_add_u32 s23, s22, 577024
    buffer_load_ushort v141, v9, s[32:35], s23 offen
    s_add_u32 s23, s22, 580608
    buffer_load_ushort v142, v9, s[32:35], s23 offen
    s_add_u32 s23, s22, 584192
    buffer_load_ushort v143, v9, s[32:35], s23 offen
    s_add_u32 s23, s22, 688128
    buffer_load_ushort v144, v8, s[32:35], s23 offen
    s_add_u32 s23, s22, 691712
    buffer_load_ushort v145, v8, s[32:35], s23 offen
    s_add_u32 s23, s22, 695296
    buffer_load_ushort v146, v8, s[32:35], s23 offen
    s_add_u32 s23, s22, 698880
    buffer_load_ushort v147, v8, s[32:35], s23 offen
    s_add_u32 s23, s22, 688128
    buffer_load_ushort v148, v9, s[32:35], s23 offen
    s_add_u32 s23, s22, 691712
    buffer_load_ushort v149, v9, s[32:35], s23 offen
    s_add_u32 s23, s22, 695296
    buffer_load_ushort v150, v9, s[32:35], s23 offen
    s_add_u32 s23, s22, 698880
    buffer_load_ushort v151, v9, s[32:35], s23 offen
    s_add_u32 s23, s22, 802816
    buffer_load_ushort v152, v8, s[32:35], s23 offen
    s_add_u32 s23, s22, 806400
    buffer_load_ushort v153, v8, s[32:35], s23 offen
    s_add_u32 s23, s22, 809984
    buffer_load_ushort v154, v8, s[32:35], s23 offen
    s_add_u32 s23, s22, 813568
    buffer_load_ushort v155, v8, s[32:35], s23 offen
    s_add_u32 s23, s22, 802816
    buffer_load_ushort v156, v9, s[32:35], s23 offen
    s_add_u32 s23, s22, 806400
    buffer_load_ushort v157, v9, s[32:35], s23 offen
    s_add_u32 s23, s22, 809984
    buffer_load_ushort v158, v9, s[32:35], s23 offen
    s_add_u32 s23, s22, 813568
    buffer_load_ushort v159, v9, s[32:35], s23 offen
    s_add_u32 s23, s22, 917504
    buffer_load_ushort v160, v8, s[32:35], s23 offen
    s_add_u32 s23, s22, 921088
    buffer_load_ushort v161, v8, s[32:35], s23 offen
    s_add_u32 s23, s22, 924672
    buffer_load_ushort v162, v8, s[32:35], s23 offen
    s_add_u32 s23, s22, 928256
    buffer_load_ushort v163, v8, s[32:35], s23 offen
    s_add_u32 s23, s22, 917504
    buffer_load_ushort v164, v9, s[32:35], s23 offen
    s_add_u32 s23, s22, 921088
    buffer_load_ushort v165, v9, s[32:35], s23 offen
    s_add_u32 s23, s22, 924672
    buffer_load_ushort v166, v9, s[32:35], s23 offen
    s_add_u32 s23, s22, 928256
    buffer_load_ushort v167, v9, s[32:35], s23 offen
    s_add_u32 s23, s22, 1032192
    buffer_load_ushort v168, v8, s[32:35], s23 offen
    s_add_u32 s23, s22, 1035776
    buffer_load_ushort v169, v8, s[32:35], s23 offen
    s_add_u32 s23, s22, 1039360
    buffer_load_ushort v170, v8, s[32:35], s23 offen
    s_add_u32 s23, s22, 1042944
    buffer_load_ushort v171, v8, s[32:35], s23 offen
    s_add_u32 s23, s22, 1032192
    buffer_load_ushort v172, v9, s[32:35], s23 offen
    s_add_u32 s23, s22, 1035776
    buffer_load_ushort v173, v9, s[32:35], s23 offen
    s_add_u32 s23, s22, 1039360
    buffer_load_ushort v174, v9, s[32:35], s23 offen
    s_add_u32 s23, s22, 1042944
    buffer_load_ushort v175, v9, s[32:35], s23 offen
    s_add_u32 s23, s22, 1146880
    buffer_load_ushort v176, v8, s[32:35], s23 offen
    s_add_u32 s23, s22, 1150464
    buffer_load_ushort v177, v8, s[32:35], s23 offen
    s_add_u32 s23, s22, 1154048
    buffer_load_ushort v178, v8, s[32:35], s23 offen
    s_add_u32 s23, s22, 1157632
    buffer_load_ushort v179, v8, s[32:35], s23 offen
    s_add_u32 s23, s22, 1146880
    buffer_load_ushort v180, v9, s[32:35], s23 offen
    s_add_u32 s23, s22, 1150464
    buffer_load_ushort v181, v9, s[32:35], s23 offen
    s_add_u32 s23, s22, 1154048
    buffer_load_ushort v182, v9, s[32:35], s23 offen
    s_add_u32 s23, s22, 1157632
    buffer_load_ushort v183, v9, s[32:35], s23 offen
    s_add_u32 s23, s22, 1261568
    buffer_load_ushort v184, v8, s[32:35], s23 offen
    s_add_u32 s23, s22, 1265152
    buffer_load_ushort v185, v8, s[32:35], s23 offen
    s_add_u32 s23, s22, 1268736
    buffer_load_ushort v186, v8, s[32:35], s23 offen
    s_add_u32 s23, s22, 1272320
    buffer_load_ushort v187, v8, s[32:35], s23 offen
    s_add_u32 s23, s22, 1261568
    buffer_load_ushort v188, v9, s[32:35], s23 offen
    s_add_u32 s23, s22, 1265152
    buffer_load_ushort v189, v9, s[32:35], s23 offen
    s_add_u32 s23, s22, 1268736
    buffer_load_ushort v190, v9, s[32:35], s23 offen
    s_add_u32 s23, s22, 1272320
    buffer_load_ushort v191, v9, s[32:35], s23 offen
    s_add_u32 s23, s22, 1376256
    buffer_load_ushort v192, v8, s[32:35], s23 offen
    s_add_u32 s23, s22, 1379840
    buffer_load_ushort v193, v8, s[32:35], s23 offen
    s_add_u32 s23, s22, 1383424
    buffer_load_ushort v194, v8, s[32:35], s23 offen
    s_add_u32 s23, s22, 1387008
    buffer_load_ushort v195, v8, s[32:35], s23 offen
    s_add_u32 s23, s22, 1376256
    buffer_load_ushort v196, v9, s[32:35], s23 offen
    s_add_u32 s23, s22, 1379840
    buffer_load_ushort v197, v9, s[32:35], s23 offen
    s_add_u32 s23, s22, 1383424
    buffer_load_ushort v198, v9, s[32:35], s23 offen
    s_add_u32 s23, s22, 1387008
    buffer_load_ushort v199, v9, s[32:35], s23 offen
    s_add_u32 s23, s22, 1490944
    buffer_load_ushort v200, v8, s[32:35], s23 offen
    s_add_u32 s23, s22, 1494528
    buffer_load_ushort v201, v8, s[32:35], s23 offen
    s_add_u32 s23, s22, 1498112
    buffer_load_ushort v202, v8, s[32:35], s23 offen
    s_add_u32 s23, s22, 1501696
    buffer_load_ushort v203, v8, s[32:35], s23 offen
    s_add_u32 s23, s22, 1490944
    buffer_load_ushort v204, v9, s[32:35], s23 offen
    s_add_u32 s23, s22, 1494528
    buffer_load_ushort v205, v9, s[32:35], s23 offen
    s_add_u32 s23, s22, 1498112
    buffer_load_ushort v206, v9, s[32:35], s23 offen
    s_add_u32 s23, s22, 1501696
    buffer_load_ushort v207, v9, s[32:35], s23 offen
    s_waitcnt vmcnt(63)
    v_lshl_or_b32 v16, v97, 16, v96
    v_lshl_or_b32 v17, v99, 16, v98
    v_lshl_or_b32 v18, v101, 16, v100
    v_lshl_or_b32 v19, v103, 16, v102
    v_lshl_or_b32 v20, v105, 16, v104
    v_lshl_or_b32 v21, v107, 16, v106
    v_lshl_or_b32 v22, v109, 16, v108
    v_lshl_or_b32 v23, v111, 16, v110
    v_lshl_or_b32 v24, v113, 16, v112
    v_lshl_or_b32 v25, v115, 16, v114
    v_lshl_or_b32 v26, v117, 16, v116
    v_lshl_or_b32 v27, v119, 16, v118
    v_lshl_or_b32 v28, v121, 16, v120
    v_lshl_or_b32 v29, v123, 16, v122
    v_lshl_or_b32 v30, v125, 16, v124
    v_lshl_or_b32 v31, v127, 16, v126
    v_lshl_or_b32 v32, v129, 16, v128
    v_lshl_or_b32 v33, v131, 16, v130
    v_lshl_or_b32 v34, v133, 16, v132
    v_lshl_or_b32 v35, v135, 16, v134
    v_lshl_or_b32 v36, v137, 16, v136
    v_lshl_or_b32 v37, v139, 16, v138
    v_lshl_or_b32 v38, v141, 16, v140
    v_lshl_or_b32 v39, v143, 16, v142
    s_waitcnt vmcnt(62)
    v_lshl_or_b32 v40, v145, 16, v144
    s_waitcnt vmcnt(60)
    v_lshl_or_b32 v41, v147, 16, v146
    s_waitcnt vmcnt(58)
    v_lshl_or_b32 v42, v149, 16, v148
    s_waitcnt vmcnt(56)
    v_lshl_or_b32 v43, v151, 16, v150
    s_waitcnt vmcnt(54)
    v_lshl_or_b32 v44, v153, 16, v152
    s_waitcnt vmcnt(52)
    v_lshl_or_b32 v45, v155, 16, v154
    s_waitcnt vmcnt(50)
    v_lshl_or_b32 v46, v157, 16, v156
    s_waitcnt vmcnt(48)
    v_lshl_or_b32 v47, v159, 16, v158
    s_waitcnt vmcnt(46)
    v_lshl_or_b32 v48, v161, 16, v160
    s_waitcnt vmcnt(44)
    v_lshl_or_b32 v49, v163, 16, v162
    s_waitcnt vmcnt(42)
    v_lshl_or_b32 v50, v165, 16, v164
    s_waitcnt vmcnt(40)
    v_lshl_or_b32 v51, v167, 16, v166
    s_waitcnt vmcnt(38)
    v_lshl_or_b32 v52, v169, 16, v168
    s_waitcnt vmcnt(36)
    v_lshl_or_b32 v53, v171, 16, v170
    s_waitcnt vmcnt(34)
    v_lshl_or_b32 v54, v173, 16, v172
    s_waitcnt vmcnt(32)
    v_lshl_or_b32 v55, v175, 16, v174
    s_waitcnt vmcnt(30)
    v_lshl_or_b32 v56, v177, 16, v176
    s_waitcnt vmcnt(28)
    v_lshl_or_b32 v57, v179, 16, v178
    s_waitcnt vmcnt(26)
    v_lshl_or_b32 v58, v181, 16, v180
    s_waitcnt vmcnt(24)
    v_lshl_or_b32 v59, v183, 16, v182
    s_waitcnt vmcnt(22)
    v_lshl_or_b32 v60, v185, 16, v184
    s_waitcnt vmcnt(20)
    v_lshl_or_b32 v61, v187, 16, v186
    s_waitcnt vmcnt(18)
    v_lshl_or_b32 v62, v189, 16, v188
    s_waitcnt vmcnt(16)
    v_lshl_or_b32 v63, v191, 16, v190
    s_waitcnt vmcnt(14)
    v_lshl_or_b32 v64, v193, 16, v192
    s_waitcnt vmcnt(12)
    v_lshl_or_b32 v65, v195, 16, v194
    s_waitcnt vmcnt(10)
    v_lshl_or_b32 v66, v197, 16, v196
    s_waitcnt vmcnt(8)
    v_lshl_or_b32 v67, v199, 16, v198
    s_waitcnt vmcnt(6)
    v_lshl_or_b32 v68, v201, 16, v200
    s_waitcnt vmcnt(4)
    v_lshl_or_b32 v69, v203, 16, v202
    s_waitcnt vmcnt(2)
    v_lshl_or_b32 v70, v205, 16, v204
    s_waitcnt vmcnt(0)
    v_lshl_or_b32 v71, v207, 16, v206
    s_add_u32 s23, s47, 25165824
    v_mov_b32 v10, 0
    buffer_store_dwordx4 v[16:19], v5, s[8:11], s23 offen
    v_lshlrev_b32 v11, 16, v16
    v_and_b32 v12, 4294901760, v16
    v_add_f32 v10, v10, v11
    v_add_f32 v10, v10, v12
    v_lshlrev_b32 v11, 16, v17
    v_and_b32 v12, 4294901760, v17
    v_add_f32 v10, v10, v11
    v_add_f32 v10, v10, v12
    v_lshlrev_b32 v11, 16, v18
    v_and_b32 v12, 4294901760, v18
    v_add_f32 v10, v10, v11
    v_add_f32 v10, v10, v12
    v_lshlrev_b32 v11, 16, v19
    v_and_b32 v12, 4294901760, v19
    v_add_f32 v10, v10, v11
    v_add_f32 v10, v10, v12
    s_add_u32 s23, s23, 8192
    buffer_store_dwordx4 v[20:23], v5, s[8:11], s23 offen
    v_lshlrev_b32 v11, 16, v20
    v_and_b32 v12, 4294901760, v20
    v_add_f32 v10, v10, v11
    v_add_f32 v10, v10, v12
    v_lshlrev_b32 v11, 16, v21
    v_and_b32 v12, 4294901760, v21
    v_add_f32 v10, v10, v11
    v_add_f32 v10, v10, v12
    v_lshlrev_b32 v11, 16, v22
    v_and_b32 v12, 4294901760, v22
    v_add_f32 v10, v10, v11
    v_add_f32 v10, v10, v12
    v_lshlrev_b32 v11, 16, v23
    v_and_b32 v12, 4294901760, v23
    v_add_f32 v10, v10, v11
    v_add_f32 v10, v10, v12
    s_add_u32 s23, s23, 8192
    buffer_store_dwordx4 v[24:27], v5, s[8:11], s23 offen
    v_lshlrev_b32 v11, 16, v24
    v_and_b32 v12, 4294901760, v24
    v_add_f32 v10, v10, v11
    v_add_f32 v10, v10, v12
    v_lshlrev_b32 v11, 16, v25
    v_and_b32 v12, 4294901760, v25
    v_add_f32 v10, v10, v11
    v_add_f32 v10, v10, v12
    v_lshlrev_b32 v11, 16, v26
    v_and_b32 v12, 4294901760, v26
    v_add_f32 v10, v10, v11
    v_add_f32 v10, v10, v12
    v_lshlrev_b32 v11, 16, v27
    v_and_b32 v12, 4294901760, v27
    v_add_f32 v10, v10, v11
    v_add_f32 v10, v10, v12
    s_add_u32 s23, s23, 8192
    buffer_store_dwordx4 v[28:31], v5, s[8:11], s23 offen
    v_lshlrev_b32 v11, 16, v28
    v_and_b32 v12, 4294901760, v28
    v_add_f32 v10, v10, v11
    v_add_f32 v10, v10, v12
    v_lshlrev_b32 v11, 16, v29
    v_and_b32 v12, 4294901760, v29
    v_add_f32 v10, v10, v11
    v_add_f32 v10, v10, v12
    v_lshlrev_b32 v11, 16, v30
    v_and_b32 v12, 4294901760, v30
    v_add_f32 v10, v10, v11
    v_add_f32 v10, v10, v12
    v_lshlrev_b32 v11, 16, v31
    v_and_b32 v12, 4294901760, v31
    v_add_f32 v10, v10, v11
    v_add_f32 v10, v10, v12
    s_add_u32 s23, s23, 8192
    buffer_store_dwordx4 v[32:35], v5, s[8:11], s23 offen
    v_lshlrev_b32 v11, 16, v32
    v_and_b32 v12, 4294901760, v32
    v_add_f32 v10, v10, v11
    v_add_f32 v10, v10, v12
    v_lshlrev_b32 v11, 16, v33
    v_and_b32 v12, 4294901760, v33
    v_add_f32 v10, v10, v11
    v_add_f32 v10, v10, v12
    v_lshlrev_b32 v11, 16, v34
    v_and_b32 v12, 4294901760, v34
    v_add_f32 v10, v10, v11
    v_add_f32 v10, v10, v12
    v_lshlrev_b32 v11, 16, v35
    v_and_b32 v12, 4294901760, v35
    v_add_f32 v10, v10, v11
    v_add_f32 v10, v10, v12
    s_add_u32 s23, s23, 8192
    buffer_store_dwordx4 v[36:39], v5, s[8:11], s23 offen
    v_lshlrev_b32 v11, 16, v36
    v_and_b32 v12, 4294901760, v36
    v_add_f32 v10, v10, v11
    v_add_f32 v10, v10, v12
    v_lshlrev_b32 v11, 16, v37
    v_and_b32 v12, 4294901760, v37
    v_add_f32 v10, v10, v11
    v_add_f32 v10, v10, v12
    v_lshlrev_b32 v11, 16, v38
    v_and_b32 v12, 4294901760, v38
    v_add_f32 v10, v10, v11
    v_add_f32 v10, v10, v12
    v_lshlrev_b32 v11, 16, v39
    v_and_b32 v12, 4294901760, v39
    v_add_f32 v10, v10, v11
    v_add_f32 v10, v10, v12
    s_add_u32 s23, s23, 8192
    buffer_store_dwordx4 v[40:43], v5, s[8:11], s23 offen
    v_lshlrev_b32 v11, 16, v40
    v_and_b32 v12, 4294901760, v40
    v_add_f32 v10, v10, v11
    v_add_f32 v10, v10, v12
    v_lshlrev_b32 v11, 16, v41
    v_and_b32 v12, 4294901760, v41
    v_add_f32 v10, v10, v11
    v_add_f32 v10, v10, v12
    v_lshlrev_b32 v11, 16, v42
    v_and_b32 v12, 4294901760, v42
    v_add_f32 v10, v10, v11
    v_add_f32 v10, v10, v12
    v_lshlrev_b32 v11, 16, v43
    v_and_b32 v12, 4294901760, v43
    v_add_f32 v10, v10, v11
    v_add_f32 v10, v10, v12
    s_add_u32 s23, s23, 8192
    buffer_store_dwordx4 v[44:47], v5, s[8:11], s23 offen
    v_lshlrev_b32 v11, 16, v44
    v_and_b32 v12, 4294901760, v44
    v_add_f32 v10, v10, v11
    v_add_f32 v10, v10, v12
    v_lshlrev_b32 v11, 16, v45
    v_and_b32 v12, 4294901760, v45
    v_add_f32 v10, v10, v11
    v_add_f32 v10, v10, v12
    v_lshlrev_b32 v11, 16, v46
    v_and_b32 v12, 4294901760, v46
    v_add_f32 v10, v10, v11
    v_add_f32 v10, v10, v12
    v_lshlrev_b32 v11, 16, v47
    v_and_b32 v12, 4294901760, v47
    v_add_f32 v10, v10, v11
    v_add_f32 v10, v10, v12
    s_add_u32 s23, s23, 8192
    buffer_store_dwordx4 v[48:51], v5, s[8:11], s23 offen
    v_lshlrev_b32 v11, 16, v48
    v_and_b32 v12, 4294901760, v48
    v_add_f32 v10, v10, v11
    v_add_f32 v10, v10, v12
    v_lshlrev_b32 v11, 16, v49
    v_and_b32 v12, 4294901760, v49
    v_add_f32 v10, v10, v11
    v_add_f32 v10, v10, v12
    v_lshlrev_b32 v11, 16, v50
    v_and_b32 v12, 4294901760, v50
    v_add_f32 v10, v10, v11
    v_add_f32 v10, v10, v12
    v_lshlrev_b32 v11, 16, v51
    v_and_b32 v12, 4294901760, v51
    v_add_f32 v10, v10, v11
    v_add_f32 v10, v10, v12
    s_add_u32 s23, s23, 8192
    buffer_store_dwordx4 v[52:55], v5, s[8:11], s23 offen
    v_lshlrev_b32 v11, 16, v52
    v_and_b32 v12, 4294901760, v52
    v_add_f32 v10, v10, v11
    v_add_f32 v10, v10, v12
    v_lshlrev_b32 v11, 16, v53
    v_and_b32 v12, 4294901760, v53
    v_add_f32 v10, v10, v11
    v_add_f32 v10, v10, v12
    v_lshlrev_b32 v11, 16, v54
    v_and_b32 v12, 4294901760, v54
    v_add_f32 v10, v10, v11
    v_add_f32 v10, v10, v12
    v_lshlrev_b32 v11, 16, v55
    v_and_b32 v12, 4294901760, v55
    v_add_f32 v10, v10, v11
    v_add_f32 v10, v10, v12
    s_add_u32 s23, s23, 8192
    buffer_store_dwordx4 v[56:59], v5, s[8:11], s23 offen
    v_lshlrev_b32 v11, 16, v56
    v_and_b32 v12, 4294901760, v56
    v_add_f32 v10, v10, v11
    v_add_f32 v10, v10, v12
    v_lshlrev_b32 v11, 16, v57
    v_and_b32 v12, 4294901760, v57
    v_add_f32 v10, v10, v11
    v_add_f32 v10, v10, v12
    v_lshlrev_b32 v11, 16, v58
    v_and_b32 v12, 4294901760, v58
    v_add_f32 v10, v10, v11
    v_add_f32 v10, v10, v12
    v_lshlrev_b32 v11, 16, v59
    v_and_b32 v12, 4294901760, v59
    v_add_f32 v10, v10, v11
    v_add_f32 v10, v10, v12
    s_add_u32 s23, s23, 8192
    buffer_store_dwordx4 v[60:63], v5, s[8:11], s23 offen
    v_lshlrev_b32 v11, 16, v60
    v_and_b32 v12, 4294901760, v60
    v_add_f32 v10, v10, v11
    v_add_f32 v10, v10, v12
    v_lshlrev_b32 v11, 16, v61
    v_and_b32 v12, 4294901760, v61
    v_add_f32 v10, v10, v11
    v_add_f32 v10, v10, v12
    v_lshlrev_b32 v11, 16, v62
    v_and_b32 v12, 4294901760, v62
    v_add_f32 v10, v10, v11
    v_add_f32 v10, v10, v12
    v_lshlrev_b32 v11, 16, v63
    v_and_b32 v12, 4294901760, v63
    v_add_f32 v10, v10, v11
    v_add_f32 v10, v10, v12
    s_add_u32 s23, s23, 8192
    buffer_store_dwordx4 v[64:67], v5, s[8:11], s23 offen
    v_lshlrev_b32 v11, 16, v64
    v_and_b32 v12, 4294901760, v64
    v_add_f32 v10, v10, v11
    v_add_f32 v10, v10, v12
    v_lshlrev_b32 v11, 16, v65
    v_and_b32 v12, 4294901760, v65
    v_add_f32 v10, v10, v11
    v_add_f32 v10, v10, v12
    v_lshlrev_b32 v11, 16, v66
    v_and_b32 v12, 4294901760, v66
    v_add_f32 v10, v10, v11
    v_add_f32 v10, v10, v12
    v_lshlrev_b32 v11, 16, v67
    v_and_b32 v12, 4294901760, v67
    v_add_f32 v10, v10, v11
    v_add_f32 v10, v10, v12
    s_add_u32 s23, s23, 8192
    buffer_store_dwordx4 v[68:71], v5, s[8:11], s23 offen
    v_lshlrev_b32 v11, 16, v68
    v_and_b32 v12, 4294901760, v68
    v_add_f32 v10, v10, v11
    v_add_f32 v10, v10, v12
    v_lshlrev_b32 v11, 16, v69
    v_and_b32 v12, 4294901760, v69
    v_add_f32 v10, v10, v11
    v_add_f32 v10, v10, v12
    v_lshlrev_b32 v11, 16, v70
    v_and_b32 v12, 4294901760, v70
    v_add_f32 v10, v10, v11
    v_add_f32 v10, v10, v12
    v_lshlrev_b32 v11, 16, v71
    v_and_b32 v12, 4294901760, v71
    v_add_f32 v10, v10, v11
    v_add_f32 v10, v10, v12
    v_mov_b32 v11, v10
    s_nop 1
    v_permlane16_swap_b32 v10, v11
    v_add_f32 v10, v10, v11
    v_mov_b32 v11, v10
    s_nop 1
    v_permlane32_swap_b32 v10, v11
    v_add_f32 v10, v10, v11
    v_lshlrev_b32 v11, 2, v3
    s_lshl_b32 s23, s40, 6
    s_add_u32 s23, s23, 29368320
    buffer_store_dword v10, v11, s[8:11], s23 offen
    s_branch L_end_k2a_kernel
    s_nop 4
L_p_w2_k2a_kernel:
    s_sub_u32 s40, s21, 112
    s_lshr_b32 s41, s40, 2
    s_and_b32 s42, s40, 3
    s_lshl_b32 s22, s41, 5
    s_mul_i32 s43, s42, 401408
    s_add_u32 s22, s22, s43
    s_mov_b32 s46, 3584
    v_mul_lo_u32 v8, s46, v4
    v_lshl_add_u32 v8, v3, 1, v8
    v_add_u32 v9, 14336, v8
    s_add_u32 s23, s22, 0
    buffer_load_ushort v96, v8, s[36:39], s23 offen
    s_add_u32 s23, s22, 896
    buffer_load_ushort v97, v8, s[36:39], s23 offen
    s_add_u32 s23, s22, 1792
    buffer_load_ushort v98, v8, s[36:39], s23 offen
    s_add_u32 s23, s22, 2688
    buffer_load_ushort v99, v8, s[36:39], s23 offen
    s_add_u32 s23, s22, 0
    buffer_load_ushort v100, v9, s[36:39], s23 offen
    s_add_u32 s23, s22, 896
    buffer_load_ushort v101, v9, s[36:39], s23 offen
    s_add_u32 s23, s22, 1792
    buffer_load_ushort v102, v9, s[36:39], s23 offen
    s_add_u32 s23, s22, 2688
    buffer_load_ushort v103, v9, s[36:39], s23 offen
    s_add_u32 s23, s22, 28672
    buffer_load_ushort v104, v8, s[36:39], s23 offen
    s_add_u32 s23, s22, 29568
    buffer_load_ushort v105, v8, s[36:39], s23 offen
    s_add_u32 s23, s22, 30464
    buffer_load_ushort v106, v8, s[36:39], s23 offen
    s_add_u32 s23, s22, 31360
    buffer_load_ushort v107, v8, s[36:39], s23 offen
    s_add_u32 s23, s22, 28672
    buffer_load_ushort v108, v9, s[36:39], s23 offen
    s_add_u32 s23, s22, 29568
    buffer_load_ushort v109, v9, s[36:39], s23 offen
    s_add_u32 s23, s22, 30464
    buffer_load_ushort v110, v9, s[36:39], s23 offen
    s_add_u32 s23, s22, 31360
    buffer_load_ushort v111, v9, s[36:39], s23 offen
    s_add_u32 s23, s22, 57344
    buffer_load_ushort v112, v8, s[36:39], s23 offen
    s_add_u32 s23, s22, 58240
    buffer_load_ushort v113, v8, s[36:39], s23 offen
    s_add_u32 s23, s22, 59136
    buffer_load_ushort v114, v8, s[36:39], s23 offen
    s_add_u32 s23, s22, 60032
    buffer_load_ushort v115, v8, s[36:39], s23 offen
    s_add_u32 s23, s22, 57344
    buffer_load_ushort v116, v9, s[36:39], s23 offen
    s_add_u32 s23, s22, 58240
    buffer_load_ushort v117, v9, s[36:39], s23 offen
    s_add_u32 s23, s22, 59136
    buffer_load_ushort v118, v9, s[36:39], s23 offen
    s_add_u32 s23, s22, 60032
    buffer_load_ushort v119, v9, s[36:39], s23 offen
    s_add_u32 s23, s22, 86016
    buffer_load_ushort v120, v8, s[36:39], s23 offen
    s_add_u32 s23, s22, 86912
    buffer_load_ushort v121, v8, s[36:39], s23 offen
    s_add_u32 s23, s22, 87808
    buffer_load_ushort v122, v8, s[36:39], s23 offen
    s_add_u32 s23, s22, 88704
    buffer_load_ushort v123, v8, s[36:39], s23 offen
    s_add_u32 s23, s22, 86016
    buffer_load_ushort v124, v9, s[36:39], s23 offen
    s_add_u32 s23, s22, 86912
    buffer_load_ushort v125, v9, s[36:39], s23 offen
    s_add_u32 s23, s22, 87808
    buffer_load_ushort v126, v9, s[36:39], s23 offen
    s_add_u32 s23, s22, 88704
    buffer_load_ushort v127, v9, s[36:39], s23 offen
    s_add_u32 s23, s22, 114688
    buffer_load_ushort v128, v8, s[36:39], s23 offen
    s_add_u32 s23, s22, 115584
    buffer_load_ushort v129, v8, s[36:39], s23 offen
    s_add_u32 s23, s22, 116480
    buffer_load_ushort v130, v8, s[36:39], s23 offen
    s_add_u32 s23, s22, 117376
    buffer_load_ushort v131, v8, s[36:39], s23 offen
    s_add_u32 s23, s22, 114688
    buffer_load_ushort v132, v9, s[36:39], s23 offen
    s_add_u32 s23, s22, 115584
    buffer_load_ushort v133, v9, s[36:39], s23 offen
    s_add_u32 s23, s22, 116480
    buffer_load_ushort v134, v9, s[36:39], s23 offen
    s_add_u32 s23, s22, 117376
    buffer_load_ushort v135, v9, s[36:39], s23 offen
    s_add_u32 s23, s22, 143360
    buffer_load_ushort v136, v8, s[36:39], s23 offen
    s_add_u32 s23, s22, 144256
    buffer_load_ushort v137, v8, s[36:39], s23 offen
    s_add_u32 s23, s22, 145152
    buffer_load_ushort v138, v8, s[36:39], s23 offen
    s_add_u32 s23, s22, 146048
    buffer_load_ushort v139, v8, s[36:39], s23 offen
    s_add_u32 s23, s22, 143360
    buffer_load_ushort v140, v9, s[36:39], s23 offen
    s_add_u32 s23, s22, 144256
    buffer_load_ushort v141, v9, s[36:39], s23 offen
    s_add_u32 s23, s22, 145152
    buffer_load_ushort v142, v9, s[36:39], s23 offen
    s_add_u32 s23, s22, 146048
    buffer_load_ushort v143, v9, s[36:39], s23 offen
    s_add_u32 s23, s22, 172032
    buffer_load_ushort v144, v8, s[36:39], s23 offen
    s_add_u32 s23, s22, 172928
    buffer_load_ushort v145, v8, s[36:39], s23 offen
    s_add_u32 s23, s22, 173824
    buffer_load_ushort v146, v8, s[36:39], s23 offen
    s_add_u32 s23, s22, 174720
    buffer_load_ushort v147, v8, s[36:39], s23 offen
    s_add_u32 s23, s22, 172032
    buffer_load_ushort v148, v9, s[36:39], s23 offen
    s_add_u32 s23, s22, 172928
    buffer_load_ushort v149, v9, s[36:39], s23 offen
    s_add_u32 s23, s22, 173824
    buffer_load_ushort v150, v9, s[36:39], s23 offen
    s_add_u32 s23, s22, 174720
    buffer_load_ushort v151, v9, s[36:39], s23 offen
    s_add_u32 s23, s22, 200704
    buffer_load_ushort v152, v8, s[36:39], s23 offen
    s_add_u32 s23, s22, 201600
    buffer_load_ushort v153, v8, s[36:39], s23 offen
    s_add_u32 s23, s22, 202496
    buffer_load_ushort v154, v8, s[36:39], s23 offen
    s_add_u32 s23, s22, 203392
    buffer_load_ushort v155, v8, s[36:39], s23 offen
    s_add_u32 s23, s22, 200704
    buffer_load_ushort v156, v9, s[36:39], s23 offen
    s_add_u32 s23, s22, 201600
    buffer_load_ushort v157, v9, s[36:39], s23 offen
    s_add_u32 s23, s22, 202496
    buffer_load_ushort v158, v9, s[36:39], s23 offen
    s_add_u32 s23, s22, 203392
    buffer_load_ushort v159, v9, s[36:39], s23 offen
    s_add_u32 s23, s22, 229376
    buffer_load_ushort v160, v8, s[36:39], s23 offen
    s_add_u32 s23, s22, 230272
    buffer_load_ushort v161, v8, s[36:39], s23 offen
    s_add_u32 s23, s22, 231168
    buffer_load_ushort v162, v8, s[36:39], s23 offen
    s_add_u32 s23, s22, 232064
    buffer_load_ushort v163, v8, s[36:39], s23 offen
    s_add_u32 s23, s22, 229376
    buffer_load_ushort v164, v9, s[36:39], s23 offen
    s_add_u32 s23, s22, 230272
    buffer_load_ushort v165, v9, s[36:39], s23 offen
    s_add_u32 s23, s22, 231168
    buffer_load_ushort v166, v9, s[36:39], s23 offen
    s_add_u32 s23, s22, 232064
    buffer_load_ushort v167, v9, s[36:39], s23 offen
    s_add_u32 s23, s22, 258048
    buffer_load_ushort v168, v8, s[36:39], s23 offen
    s_add_u32 s23, s22, 258944
    buffer_load_ushort v169, v8, s[36:39], s23 offen
    s_add_u32 s23, s22, 259840
    buffer_load_ushort v170, v8, s[36:39], s23 offen
    s_add_u32 s23, s22, 260736
    buffer_load_ushort v171, v8, s[36:39], s23 offen
    s_add_u32 s23, s22, 258048
    buffer_load_ushort v172, v9, s[36:39], s23 offen
    s_add_u32 s23, s22, 258944
    buffer_load_ushort v173, v9, s[36:39], s23 offen
    s_add_u32 s23, s22, 259840
    buffer_load_ushort v174, v9, s[36:39], s23 offen
    s_add_u32 s23, s22, 260736
    buffer_load_ushort v175, v9, s[36:39], s23 offen
    s_add_u32 s23, s22, 286720
    buffer_load_ushort v176, v8, s[36:39], s23 offen
    s_add_u32 s23, s22, 287616
    buffer_load_ushort v177, v8, s[36:39], s23 offen
    s_add_u32 s23, s22, 288512
    buffer_load_ushort v178, v8, s[36:39], s23 offen
    s_add_u32 s23, s22, 289408
    buffer_load_ushort v179, v8, s[36:39], s23 offen
    s_add_u32 s23, s22, 286720
    buffer_load_ushort v180, v9, s[36:39], s23 offen
    s_add_u32 s23, s22, 287616
    buffer_load_ushort v181, v9, s[36:39], s23 offen
    s_add_u32 s23, s22, 288512
    buffer_load_ushort v182, v9, s[36:39], s23 offen
    s_add_u32 s23, s22, 289408
    buffer_load_ushort v183, v9, s[36:39], s23 offen
    s_add_u32 s23, s22, 315392
    buffer_load_ushort v184, v8, s[36:39], s23 offen
    s_add_u32 s23, s22, 316288
    buffer_load_ushort v185, v8, s[36:39], s23 offen
    s_add_u32 s23, s22, 317184
    buffer_load_ushort v186, v8, s[36:39], s23 offen
    s_add_u32 s23, s22, 318080
    buffer_load_ushort v187, v8, s[36:39], s23 offen
    s_add_u32 s23, s22, 315392
    buffer_load_ushort v188, v9, s[36:39], s23 offen
    s_add_u32 s23, s22, 316288
    buffer_load_ushort v189, v9, s[36:39], s23 offen
    s_add_u32 s23, s22, 317184
    buffer_load_ushort v190, v9, s[36:39], s23 offen
    s_add_u32 s23, s22, 318080
    buffer_load_ushort v191, v9, s[36:39], s23 offen
    s_add_u32 s23, s22, 344064
    buffer_load_ushort v192, v8, s[36:39], s23 offen
    s_add_u32 s23, s22, 344960
    buffer_load_ushort v193, v8, s[36:39], s23 offen
    s_add_u32 s23, s22, 345856
    buffer_load_ushort v194, v8, s[36:39], s23 offen
    s_add_u32 s23, s22, 346752
    buffer_load_ushort v195, v8, s[36:39], s23 offen
    s_add_u32 s23, s22, 344064
    buffer_load_ushort v196, v9, s[36:39], s23 offen
    s_add_u32 s23, s22, 344960
    buffer_load_ushort v197, v9, s[36:39], s23 offen
    s_add_u32 s23, s22, 345856
    buffer_load_ushort v198, v9, s[36:39], s23 offen
    s_add_u32 s23, s22, 346752
    buffer_load_ushort v199, v9, s[36:39], s23 offen
    s_add_u32 s23, s22, 372736
    buffer_load_ushort v200, v8, s[36:39], s23 offen
    s_add_u32 s23, s22, 373632
    buffer_load_ushort v201, v8, s[36:39], s23 offen
    s_add_u32 s23, s22, 374528
    buffer_load_ushort v202, v8, s[36:39], s23 offen
    s_add_u32 s23, s22, 375424
    buffer_load_ushort v203, v8, s[36:39], s23 offen
    s_add_u32 s23, s22, 372736
    buffer_load_ushort v204, v9, s[36:39], s23 offen
    s_add_u32 s23, s22, 373632
    buffer_load_ushort v205, v9, s[36:39], s23 offen
    s_add_u32 s23, s22, 374528
    buffer_load_ushort v206, v9, s[36:39], s23 offen
    s_add_u32 s23, s22, 375424
    buffer_load_ushort v207, v9, s[36:39], s23 offen
    s_waitcnt vmcnt(63)
    v_lshl_or_b32 v16, v97, 16, v96
    v_lshl_or_b32 v17, v99, 16, v98
    v_lshl_or_b32 v18, v101, 16, v100
    v_lshl_or_b32 v19, v103, 16, v102
    v_lshl_or_b32 v20, v105, 16, v104
    v_lshl_or_b32 v21, v107, 16, v106
    v_lshl_or_b32 v22, v109, 16, v108
    v_lshl_or_b32 v23, v111, 16, v110
    v_lshl_or_b32 v24, v113, 16, v112
    v_lshl_or_b32 v25, v115, 16, v114
    v_lshl_or_b32 v26, v117, 16, v116
    v_lshl_or_b32 v27, v119, 16, v118
    v_lshl_or_b32 v28, v121, 16, v120
    v_lshl_or_b32 v29, v123, 16, v122
    v_lshl_or_b32 v30, v125, 16, v124
    v_lshl_or_b32 v31, v127, 16, v126
    v_lshl_or_b32 v32, v129, 16, v128
    v_lshl_or_b32 v33, v131, 16, v130
    v_lshl_or_b32 v34, v133, 16, v132
    v_lshl_or_b32 v35, v135, 16, v134
    v_lshl_or_b32 v36, v137, 16, v136
    v_lshl_or_b32 v37, v139, 16, v138
    v_lshl_or_b32 v38, v141, 16, v140
    v_lshl_or_b32 v39, v143, 16, v142
    s_waitcnt vmcnt(62)
    v_lshl_or_b32 v40, v145, 16, v144
    s_waitcnt vmcnt(60)
    v_lshl_or_b32 v41, v147, 16, v146
    s_waitcnt vmcnt(58)
    v_lshl_or_b32 v42, v149, 16, v148
    s_waitcnt vmcnt(56)
    v_lshl_or_b32 v43, v151, 16, v150
    s_waitcnt vmcnt(54)
    v_lshl_or_b32 v44, v153, 16, v152
    s_waitcnt vmcnt(52)
    v_lshl_or_b32 v45, v155, 16, v154
    s_waitcnt vmcnt(50)
    v_lshl_or_b32 v46, v157, 16, v156
    s_waitcnt vmcnt(48)
    v_lshl_or_b32 v47, v159, 16, v158
    s_waitcnt vmcnt(46)
    v_lshl_or_b32 v48, v161, 16, v160
    s_waitcnt vmcnt(44)
    v_lshl_or_b32 v49, v163, 16, v162
    s_waitcnt vmcnt(42)
    v_lshl_or_b32 v50, v165, 16, v164
    s_waitcnt vmcnt(40)
    v_lshl_or_b32 v51, v167, 16, v166
    s_waitcnt vmcnt(38)
    v_lshl_or_b32 v52, v169, 16, v168
    s_waitcnt vmcnt(36)
    v_lshl_or_b32 v53, v171, 16, v170
    s_waitcnt vmcnt(34)
    v_lshl_or_b32 v54, v173, 16, v172
    s_waitcnt vmcnt(32)
    v_lshl_or_b32 v55, v175, 16, v174
    s_waitcnt vmcnt(30)
    v_lshl_or_b32 v56, v177, 16, v176
    s_waitcnt vmcnt(28)
    v_lshl_or_b32 v57, v179, 16, v178
    s_waitcnt vmcnt(26)
    v_lshl_or_b32 v58, v181, 16, v180
    s_waitcnt vmcnt(24)
    v_lshl_or_b32 v59, v183, 16, v182
    s_waitcnt vmcnt(22)
    v_lshl_or_b32 v60, v185, 16, v184
    s_waitcnt vmcnt(20)
    v_lshl_or_b32 v61, v187, 16, v186
    s_waitcnt vmcnt(18)
    v_lshl_or_b32 v62, v189, 16, v188
    s_waitcnt vmcnt(16)
    v_lshl_or_b32 v63, v191, 16, v190
    s_waitcnt vmcnt(14)
    v_lshl_or_b32 v64, v193, 16, v192
    s_waitcnt vmcnt(12)
    v_lshl_or_b32 v65, v195, 16, v194
    s_waitcnt vmcnt(10)
    v_lshl_or_b32 v66, v197, 16, v196
    s_waitcnt vmcnt(8)
    v_lshl_or_b32 v67, v199, 16, v198
    s_waitcnt vmcnt(6)
    v_lshl_or_b32 v68, v201, 16, v200
    s_waitcnt vmcnt(4)
    v_lshl_or_b32 v69, v203, 16, v202
    s_waitcnt vmcnt(2)
    v_lshl_or_b32 v70, v205, 16, v204
    s_waitcnt vmcnt(0)
    v_lshl_or_b32 v71, v207, 16, v206
    s_mul_i32 s23, s40, 14336
    s_add_u32 s23, s23, 27262976
    buffer_store_dwordx4 v[16:19], v5, s[8:11], s23 offen
    s_add_u32 s23, s23, 1024
    buffer_store_dwordx4 v[20:23], v5, s[8:11], s23 offen
    s_add_u32 s23, s23, 1024
    buffer_store_dwordx4 v[24:27], v5, s[8:11], s23 offen
    s_add_u32 s23, s23, 1024
    buffer_store_dwordx4 v[28:31], v5, s[8:11], s23 offen
    s_add_u32 s23, s23, 1024
    buffer_store_dwordx4 v[32:35], v5, s[8:11], s23 offen
    s_add_u32 s23, s23, 1024
    buffer_store_dwordx4 v[36:39], v5, s[8:11], s23 offen
    s_add_u32 s23, s23, 1024
    buffer_store_dwordx4 v[40:43], v5, s[8:11], s23 offen
    s_add_u32 s23, s23, 1024
    buffer_store_dwordx4 v[44:47], v5, s[8:11], s23 offen
    s_add_u32 s23, s23, 1024
    buffer_store_dwordx4 v[48:51], v5, s[8:11], s23 offen
    s_add_u32 s23, s23, 1024
    buffer_store_dwordx4 v[52:55], v5, s[8:11], s23 offen
    s_add_u32 s23, s23, 1024
    buffer_store_dwordx4 v[56:59], v5, s[8:11], s23 offen
    s_add_u32 s23, s23, 1024
    buffer_store_dwordx4 v[60:63], v5, s[8:11], s23 offen
    s_add_u32 s23, s23, 1024
    buffer_store_dwordx4 v[64:67], v5, s[8:11], s23 offen
    s_add_u32 s23, s23, 1024
    buffer_store_dwordx4 v[68:71], v5, s[8:11], s23 offen
    s_branch L_end_k2a_kernel
    s_nop 4
L_end_k2a_kernel:
    s_endpgm

.globl k3a_kernel
.p2align 8
.type k3a_kernel,@function
k3a_kernel:
    s_cmp_ge_u32 s2, 224
    s_cbranch_scc1 L_end_k3a_kernel
    s_load_dwordx2 s[4:5], s[0:1], 88
    s_load_dwordx2 s[12:13], s[0:1], 48
    v_and_b32 v1, 63, v0
    v_lshrrev_b32 v2, 6, v0
    s_nop 0
    v_readfirstlane_b32 s20, v2
    v_and_b32 v3, 15, v1
    v_lshrrev_b32 v4, 4, v1
    v_lshlrev_b32 v5, 4, v1
    s_waitcnt lgkmcnt(0)
    s_mov_b32 s8, s4
    s_and_b32 s9, s5, 65535
    s_mov_b32 s10, 268435456
    s_mov_b32 s11, 131072
    s_and_b32 s13, s13, 65535
    s_mov_b32 s14, 3584
    s_mov_b32 s15, 131072
    s_and_b32 s26, s2, 7
    s_lshr_b32 s27, s2, 3
    s_mul_i32 s28, s27, 37
    s_lshr_b32 s28, s28, 8
    s_mul_i32 s29, s28, 7
    s_sub_u32 s29, s27, s29
    s_lshr_b32 s21, s26, 1
    s_lshl_b32 s21, s21, 2
    s_add_u32 s21, s21, s28
    s_and_b32 s22, s26, 1
    s_mul_i32 s22, s22, 7
    s_add_u32 s22, s22, s29
    s_lshl_b32 s23, s21, 3
    s_add_u32 s23, s23, s20
    s_mul_i32 s24, s22, 114688
    s_lshl_b32 s25, s20, 10
    s_add_u32 s24, s24, s25
    s_add_u32 s24, s24, 25165824
    s_mul_i32 s26, s23, 14336
    s_add_u32 s26, s26, 2097152
    s_add_u32 s28, s25, 0
    s_mov_b32 m0, s28
    s_add_u32 s27, s24, 0
    buffer_load_dwordx4 v5, s[8:11], s27 offen lds
    s_add_u32 s29, s26, 0
    buffer_load_dwordx4 v[16:19], v5, s[8:11], s29 offen offset:0
    s_add_u32 s28, s25, 8192
    s_mov_b32 m0, s28
    s_add_u32 s27, s24, 8192
    buffer_load_dwordx4 v5, s[8:11], s27 offen lds
    s_add_u32 s29, s26, 0
    buffer_load_dwordx4 v[20:23], v5, s[8:11], s29 offen offset:1024
    s_add_u32 s28, s25, 16384
    s_mov_b32 m0, s28
    s_add_u32 s27, s24, 16384
    buffer_load_dwordx4 v5, s[8:11], s27 offen lds
    s_add_u32 s29, s26, 0
    buffer_load_dwordx4 v[24:27], v5, s[8:11], s29 offen offset:2048
    s_add_u32 s28, s25, 24576
    s_mov_b32 m0, s28
    s_add_u32 s27, s24, 24576
    buffer_load_dwordx4 v5, s[8:11], s27 offen lds
    s_add_u32 s29, s26, 0
    buffer_load_dwordx4 v[28:31], v5, s[8:11], s29 offen offset:3072
    s_add_u32 s28, s25, 32768
    s_mov_b32 m0, s28
    s_add_u32 s27, s24, 32768
    buffer_load_dwordx4 v5, s[8:11], s27 offen lds
    s_add_u32 s29, s26, 4096
    buffer_load_dwordx4 v[32:35], v5, s[8:11], s29 offen offset:0
    s_add_u32 s28, s25, 40960
    s_mov_b32 m0, s28
    s_add_u32 s27, s24, 40960
    buffer_load_dwordx4 v5, s[8:11], s27 offen lds
    s_add_u32 s29, s26, 4096
    buffer_load_dwordx4 v[36:39], v5, s[8:11], s29 offen offset:1024
    v_lshlrev_b32 v6, 4, v4
    v_lshlrev_b32 v7, 3, v4
    s_lshl_b32 s30, s22, 9
    s_add_u32 s30, s30, 29368320
    s_lshl_b32 s31, s22, 8
    v_mov_b32 v176, 1065369472
    v_mov_b32 v177, 1065369472
    v_mov_b32 v178, 1065369472
    v_mov_b32 v179, 1065369472
    v_and_b32 v12, 3, v3
    v_lshrrev_b32 v13, 2, v3
    v_cmp_eq_u32 s[40:41], 1, v12
    v_cmp_eq_u32 s[42:43], 2, v12
    v_cmp_eq_u32 s[44:45], 3, v12
    v_cmp_eq_u32 s[46:47], v4, v13
    v_add_u32 v8, 65536, v5
    s_waitcnt vmcnt(8)
    s_barrier
    ds_read_b128 v[72:75], v5 offset:0
    ds_read_b128 v[76:79], v5 offset:1024
    ds_read_b128 v[80:83], v5 offset:2048
    ds_read_b128 v[84:87], v5 offset:3072
    ds_read_b128 v[88:91], v5 offset:4096
    ds_read_b128 v[92:95], v5 offset:5120
    ds_read_b128 v[96:99], v5 offset:6144
    ds_read_b128 v[100:103], v5 offset:7168
    ds_read_b128 v[104:107], v5 offset:8192
    ds_read_b128 v[108:111], v5 offset:9216
    ds_read_b128 v[112:115], v5 offset:10240
    ds_read_b128 v[116:119], v5 offset:11264
    ds_read_b128 v[120:123], v5 offset:12288
    ds_read_b128 v[124:127], v5 offset:13312
    ds_read_b128 v[128:131], v5 offset:14336
    ds_read_b128 v[132:135], v5 offset:15360
    v_mfma_f32_16x16x32_bf16 v[168:171], v[176:179], v[16:19], 0
    v_mfma_f32_16x16x32_bf16 v[172:175], v[16:19], v[16:19], 0
    s_add_u32 s28, s25, 49152
    s_mov_b32 m0, s28
    s_add_u32 s27, s24, 49152
    buffer_load_dwordx4 v5, s[8:11], s27 offen lds
    s_waitcnt lgkmcnt(15)
    v_mfma_f32_16x16x32_bf16 v[136:139], v[72:75], v[16:19], 0
    s_waitcnt lgkmcnt(14)
    v_mfma_f32_16x16x32_bf16 v[140:143], v[76:79], v[16:19], 0
    s_waitcnt lgkmcnt(13)
    v_mfma_f32_16x16x32_bf16 v[144:147], v[80:83], v[16:19], 0
    s_waitcnt lgkmcnt(12)
    v_mfma_f32_16x16x32_bf16 v[148:151], v[84:87], v[16:19], 0
    s_add_u32 s29, s26, 4096
    buffer_load_dwordx4 v[40:43], v5, s[8:11], s29 offen offset:2048
    s_waitcnt lgkmcnt(11)
    v_mfma_f32_16x16x32_bf16 v[152:155], v[88:91], v[16:19], 0
    s_waitcnt lgkmcnt(10)
    v_mfma_f32_16x16x32_bf16 v[156:159], v[92:95], v[16:19], 0
    s_waitcnt lgkmcnt(9)
    v_mfma_f32_16x16x32_bf16 v[160:163], v[96:99], v[16:19], 0
    s_waitcnt lgkmcnt(8)
    v_mfma_f32_16x16x32_bf16 v[164:167], v[100:103], v[16:19], 0
    v_mfma_f32_16x16x32_bf16 v[168:171], v[176:179], v[20:23], v[168:171]
    v_mfma_f32_16x16x32_bf16 v[172:175], v[20:23], v[20:23], v[172:175]
    s_add_u32 s28, s25, 57344
    s_mov_b32 m0, s28
    s_add_u32 s27, s24, 57344
    buffer_load_dwordx4 v5, s[8:11], s27 offen lds
    s_waitcnt lgkmcnt(7)
    v_mfma_f32_16x16x32_bf16 v[136:139], v[104:107], v[20:23], v[136:139]
    s_waitcnt lgkmcnt(6)
    v_mfma_f32_16x16x32_bf16 v[140:143], v[108:111], v[20:23], v[140:143]
    s_waitcnt lgkmcnt(5)
    v_mfma_f32_16x16x32_bf16 v[144:147], v[112:115], v[20:23], v[144:147]
    s_waitcnt lgkmcnt(4)
    v_mfma_f32_16x16x32_bf16 v[148:151], v[116:119], v[20:23], v[148:151]
    s_add_u32 s29, s26, 4096
    buffer_load_dwordx4 v[44:47], v5, s[8:11], s29 offen offset:3072
    s_waitcnt lgkmcnt(3)
    v_mfma_f32_16x16x32_bf16 v[152:155], v[120:123], v[20:23], v[152:155]
    s_waitcnt lgkmcnt(2)
    v_mfma_f32_16x16x32_bf16 v[156:159], v[124:127], v[20:23], v[156:159]
    s_waitcnt lgkmcnt(1)
    v_mfma_f32_16x16x32_bf16 v[160:163], v[128:131], v[20:23], v[160:163]
    s_waitcnt lgkmcnt(0)
    v_mfma_f32_16x16x32_bf16 v[164:167], v[132:135], v[20:23], v[164:167]
    s_waitcnt vmcnt(8)
    s_barrier
    ds_read_b128 v[72:75], v5 offset:16384
    ds_read_b128 v[76:79], v5 offset:17408
    ds_read_b128 v[80:83], v5 offset:18432
    ds_read_b128 v[84:87], v5 offset:19456
    ds_read_b128 v[88:91], v5 offset:20480
    ds_read_b128 v[92:95], v5 offset:21504
    ds_read_b128 v[96:99], v5 offset:22528
    ds_read_b128 v[100:103], v5 offset:23552
    ds_read_b128 v[104:107], v5 offset:24576
    ds_read_b128 v[108:111], v5 offset:25600
    ds_read_b128 v[112:115], v5 offset:26624
    ds_read_b128 v[116:119], v5 offset:27648
    ds_read_b128 v[120:123], v5 offset:28672
    ds_read_b128 v[124:127], v5 offset:29696
    ds_read_b128 v[128:131], v5 offset:30720
    ds_read_b128 v[132:135], v5 offset:31744
    v_mfma_f32_16x16x32_bf16 v[168:171], v[176:179], v[24:27], v[168:171]
    v_mfma_f32_16x16x32_bf16 v[172:175], v[24:27], v[24:27], v[172:175]
    s_add_u32 s28, s25, 65536
    s_mov_b32 m0, s28
    s_add_u32 s27, s24, 65536
    buffer_load_dwordx4 v5, s[8:11], s27 offen lds
    s_waitcnt lgkmcnt(15)
    v_mfma_f32_16x16x32_bf16 v[136:139], v[72:75], v[24:27], v[136:139]
    s_waitcnt lgkmcnt(14)
    v_mfma_f32_16x16x32_bf16 v[140:143], v[76:79], v[24:27], v[140:143]
    s_waitcnt lgkmcnt(13)
    v_mfma_f32_16x16x32_bf16 v[144:147], v[80:83], v[24:27], v[144:147]
    s_waitcnt lgkmcnt(12)
    v_mfma_f32_16x16x32_bf16 v[148:151], v[84:87], v[24:27], v[148:151]
    s_add_u32 s29, s26, 8192
    buffer_load_dwordx4 v[48:51], v5, s[8:11], s29 offen offset:0
    s_waitcnt lgkmcnt(11)
    v_mfma_f32_16x16x32_bf16 v[152:155], v[88:91], v[24:27], v[152:155]
    s_waitcnt lgkmcnt(10)
    v_mfma_f32_16x16x32_bf16 v[156:159], v[92:95], v[24:27], v[156:159]
    s_waitcnt lgkmcnt(9)
    v_mfma_f32_16x16x32_bf16 v[160:163], v[96:99], v[24:27], v[160:163]
    s_waitcnt lgkmcnt(8)
    v_mfma_f32_16x16x32_bf16 v[164:167], v[100:103], v[24:27], v[164:167]
    v_mfma_f32_16x16x32_bf16 v[168:171], v[176:179], v[28:31], v[168:171]
    v_mfma_f32_16x16x32_bf16 v[172:175], v[28:31], v[28:31], v[172:175]
    s_add_u32 s28, s25, 73728
    s_mov_b32 m0, s28
    s_add_u32 s27, s24, 73728
    buffer_load_dwordx4 v5, s[8:11], s27 offen lds
    s_waitcnt lgkmcnt(7)
    v_mfma_f32_16x16x32_bf16 v[136:139], v[104:107], v[28:31], v[136:139]
    s_waitcnt lgkmcnt(6)
    v_mfma_f32_16x16x32_bf16 v[140:143], v[108:111], v[28:31], v[140:143]
    s_waitcnt lgkmcnt(5)
    v_mfma_f32_16x16x32_bf16 v[144:147], v[112:115], v[28:31], v[144:147]
    s_waitcnt lgkmcnt(4)
    v_mfma_f32_16x16x32_bf16 v[148:151], v[116:119], v[28:31], v[148:151]
    s_add_u32 s29, s26, 8192
    buffer_load_dwordx4 v[52:55], v5, s[8:11], s29 offen offset:1024
    s_waitcnt lgkmcnt(3)
    v_mfma_f32_16x16x32_bf16 v[152:155], v[120:123], v[28:31], v[152:155]
    s_waitcnt lgkmcnt(2)
    v_mfma_f32_16x16x32_bf16 v[156:159], v[124:127], v[28:31], v[156:159]
    s_waitcnt lgkmcnt(1)
    v_mfma_f32_16x16x32_bf16 v[160:163], v[128:131], v[28:31], v[160:163]
    s_waitcnt lgkmcnt(0)
    v_mfma_f32_16x16x32_bf16 v[164:167], v[132:135], v[28:31], v[164:167]
    s_waitcnt vmcnt(8)
    s_barrier
    ds_read_b128 v[72:75], v5 offset:32768
    ds_read_b128 v[76:79], v5 offset:33792
    ds_read_b128 v[80:83], v5 offset:34816
    ds_read_b128 v[84:87], v5 offset:35840
    ds_read_b128 v[88:91], v5 offset:36864
    ds_read_b128 v[92:95], v5 offset:37888
    ds_read_b128 v[96:99], v5 offset:38912
    ds_read_b128 v[100:103], v5 offset:39936
    ds_read_b128 v[104:107], v5 offset:40960
    ds_read_b128 v[108:111], v5 offset:41984
    ds_read_b128 v[112:115], v5 offset:43008
    ds_read_b128 v[116:119], v5 offset:44032
    ds_read_b128 v[120:123], v5 offset:45056
    ds_read_b128 v[124:127], v5 offset:46080
    ds_read_b128 v[128:131], v5 offset:47104
    ds_read_b128 v[132:135], v5 offset:48128
    v_mfma_f32_16x16x32_bf16 v[168:171], v[176:179], v[32:35], v[168:171]
    v_mfma_f32_16x16x32_bf16 v[172:175], v[32:35], v[32:35], v[172:175]
    s_add_u32 s28, s25, 81920
    s_mov_b32 m0, s28
    s_add_u32 s27, s24, 81920
    buffer_load_dwordx4 v5, s[8:11], s27 offen lds
    s_waitcnt lgkmcnt(15)
    v_mfma_f32_16x16x32_bf16 v[136:139], v[72:75], v[32:35], v[136:139]
    s_waitcnt lgkmcnt(14)
    v_mfma_f32_16x16x32_bf16 v[140:143], v[76:79], v[32:35], v[140:143]
    s_waitcnt lgkmcnt(13)
    v_mfma_f32_16x16x32_bf16 v[144:147], v[80:83], v[32:35], v[144:147]
    s_waitcnt lgkmcnt(12)
    v_mfma_f32_16x16x32_bf16 v[148:151], v[84:87], v[32:35], v[148:151]
    s_add_u32 s29, s26, 8192
    buffer_load_dwordx4 v[56:59], v5, s[8:11], s29 offen offset:2048
    s_waitcnt lgkmcnt(11)
    v_mfma_f32_16x16x32_bf16 v[152:155], v[88:91], v[32:35], v[152:155]
    s_waitcnt lgkmcnt(10)
    v_mfma_f32_16x16x32_bf16 v[156:159], v[92:95], v[32:35], v[156:159]
    s_waitcnt lgkmcnt(9)
    v_mfma_f32_16x16x32_bf16 v[160:163], v[96:99], v[32:35], v[160:163]
    s_waitcnt lgkmcnt(8)
    v_mfma_f32_16x16x32_bf16 v[164:167], v[100:103], v[32:35], v[164:167]
    v_mfma_f32_16x16x32_bf16 v[168:171], v[176:179], v[36:39], v[168:171]
    v_mfma_f32_16x16x32_bf16 v[172:175], v[36:39], v[36:39], v[172:175]
    s_add_u32 s28, s25, 90112
    s_mov_b32 m0, s28
    s_add_u32 s27, s24, 90112
    buffer_load_dwordx4 v5, s[8:11], s27 offen lds
    s_waitcnt lgkmcnt(7)
    v_mfma_f32_16x16x32_bf16 v[136:139], v[104:107], v[36:39], v[136:139]
    s_waitcnt lgkmcnt(6)
    v_mfma_f32_16x16x32_bf16 v[140:143], v[108:111], v[36:39], v[140:143]
    s_waitcnt lgkmcnt(5)
    v_mfma_f32_16x16x32_bf16 v[144:147], v[112:115], v[36:39], v[144:147]
    s_waitcnt lgkmcnt(4)
    v_mfma_f32_16x16x32_bf16 v[148:151], v[116:119], v[36:39], v[148:151]
    s_add_u32 s29, s26, 8192
    buffer_load_dwordx4 v[60:63], v5, s[8:11], s29 offen offset:3072
    s_waitcnt lgkmcnt(3)
    v_mfma_f32_16x16x32_bf16 v[152:155], v[120:123], v[36:39], v[152:155]
    s_waitcnt lgkmcnt(2)
    v_mfma_f32_16x16x32_bf16 v[156:159], v[124:127], v[36:39], v[156:159]
    s_waitcnt lgkmcnt(1)
    v_mfma_f32_16x16x32_bf16 v[160:163], v[128:131], v[36:39], v[160:163]
    s_waitcnt lgkmcnt(0)
    v_mfma_f32_16x16x32_bf16 v[164:167], v[132:135], v[36:39], v[164:167]
    s_waitcnt vmcnt(8)
    s_barrier
    ds_read_b128 v[72:75], v5 offset:49152
    ds_read_b128 v[76:79], v5 offset:50176
    ds_read_b128 v[80:83], v5 offset:51200
    ds_read_b128 v[84:87], v5 offset:52224
    ds_read_b128 v[88:91], v5 offset:53248
    ds_read_b128 v[92:95], v5 offset:54272
    ds_read_b128 v[96:99], v5 offset:55296
    ds_read_b128 v[100:103], v5 offset:56320
    ds_read_b128 v[104:107], v5 offset:57344
    ds_read_b128 v[108:111], v5 offset:58368
    ds_read_b128 v[112:115], v5 offset:59392
    ds_read_b128 v[116:119], v5 offset:60416
    ds_read_b128 v[120:123], v5 offset:61440
    ds_read_b128 v[124:127], v5 offset:62464
    ds_read_b128 v[128:131], v5 offset:63488
    ds_read_b128 v[132:135], v5 offset:64512
    v_mfma_f32_16x16x32_bf16 v[168:171], v[176:179], v[40:43], v[168:171]
    v_mfma_f32_16x16x32_bf16 v[172:175], v[40:43], v[40:43], v[172:175]
    s_add_u32 s28, s25, 98304
    s_mov_b32 m0, s28
    s_add_u32 s27, s24, 98304
    buffer_load_dwordx4 v5, s[8:11], s27 offen lds
    s_waitcnt lgkmcnt(15)
    v_mfma_f32_16x16x32_bf16 v[136:139], v[72:75], v[40:43], v[136:139]
    s_waitcnt lgkmcnt(14)
    v_mfma_f32_16x16x32_bf16 v[140:143], v[76:79], v[40:43], v[140:143]
    s_waitcnt lgkmcnt(13)
    v_mfma_f32_16x16x32_bf16 v[144:147], v[80:83], v[40:43], v[144:147]
    s_waitcnt lgkmcnt(12)
    v_mfma_f32_16x16x32_bf16 v[148:151], v[84:87], v[40:43], v[148:151]
    s_add_u32 s29, s26, 12288
    buffer_load_dwordx4 v[64:67], v5, s[8:11], s29 offen offset:0
    s_waitcnt lgkmcnt(11)
    v_mfma_f32_16x16x32_bf16 v[152:155], v[88:91], v[40:43], v[152:155]
    s_waitcnt lgkmcnt(10)
    v_mfma_f32_16x16x32_bf16 v[156:159], v[92:95], v[40:43], v[156:159]
    s_waitcnt lgkmcnt(9)
    v_mfma_f32_16x16x32_bf16 v[160:163], v[96:99], v[40:43], v[160:163]
    s_waitcnt lgkmcnt(8)
    v_mfma_f32_16x16x32_bf16 v[164:167], v[100:103], v[40:43], v[164:167]
    v_mfma_f32_16x16x32_bf16 v[168:171], v[176:179], v[44:47], v[168:171]
    v_mfma_f32_16x16x32_bf16 v[172:175], v[44:47], v[44:47], v[172:175]
    s_add_u32 s28, s25, 106496
    s_mov_b32 m0, s28
    s_add_u32 s27, s24, 106496
    buffer_load_dwordx4 v5, s[8:11], s27 offen lds
    s_waitcnt lgkmcnt(7)
    v_mfma_f32_16x16x32_bf16 v[136:139], v[104:107], v[44:47], v[136:139]
    s_waitcnt lgkmcnt(6)
    v_mfma_f32_16x16x32_bf16 v[140:143], v[108:111], v[44:47], v[140:143]
    s_waitcnt lgkmcnt(5)
    v_mfma_f32_16x16x32_bf16 v[144:147], v[112:115], v[44:47], v[144:147]
    s_waitcnt lgkmcnt(4)
    v_mfma_f32_16x16x32_bf16 v[148:151], v[116:119], v[44:47], v[148:151]
    s_add_u32 s29, s26, 12288
    buffer_load_dwordx4 v[68:71], v5, s[8:11], s29 offen offset:1024
    s_waitcnt lgkmcnt(3)
    v_mfma_f32_16x16x32_bf16 v[152:155], v[120:123], v[44:47], v[152:155]
    s_waitcnt lgkmcnt(2)
    v_mfma_f32_16x16x32_bf16 v[156:159], v[124:127], v[44:47], v[156:159]
    s_waitcnt lgkmcnt(1)
    v_mfma_f32_16x16x32_bf16 v[160:163], v[128:131], v[44:47], v[160:163]
    s_waitcnt lgkmcnt(0)
    v_mfma_f32_16x16x32_bf16 v[164:167], v[132:135], v[44:47], v[164:167]
    s_waitcnt vmcnt(8)
    s_barrier
    ds_read_b128 v[72:75], v8 offset:0
    ds_read_b128 v[76:79], v8 offset:1024
    ds_read_b128 v[80:83], v8 offset:2048
    ds_read_b128 v[84:87], v8 offset:3072
    ds_read_b128 v[88:91], v8 offset:4096
    ds_read_b128 v[92:95], v8 offset:5120
    ds_read_b128 v[96:99], v8 offset:6144
    ds_read_b128 v[100:103], v8 offset:7168
    ds_read_b128 v[104:107], v8 offset:8192
    ds_read_b128 v[108:111], v8 offset:9216
    ds_read_b128 v[112:115], v8 offset:10240
    ds_read_b128 v[116:119], v8 offset:11264
    ds_read_b128 v[120:123], v8 offset:12288
    ds_read_b128 v[124:127], v8 offset:13312
    ds_read_b128 v[128:131], v8 offset:14336
    ds_read_b128 v[132:135], v8 offset:15360
    v_mfma_f32_16x16x32_bf16 v[168:171], v[176:179], v[48:51], v[168:171]
    v_mfma_f32_16x16x32_bf16 v[172:175], v[48:51], v[48:51], v[172:175]
    buffer_load_dwordx4 v[180:183], v6, s[8:11], s30 offen offset:0
    buffer_load_dwordx2 v[212:213], v7, s[12:15], s31 offen offset:0
    s_waitcnt lgkmcnt(15)
    v_mfma_f32_16x16x32_bf16 v[136:139], v[72:75], v[48:51], v[136:139]
    s_waitcnt lgkmcnt(14)
    v_mfma_f32_16x16x32_bf16 v[140:143], v[76:79], v[48:51], v[140:143]
    s_waitcnt lgkmcnt(13)
    v_mfma_f32_16x16x32_bf16 v[144:147], v[80:83], v[48:51], v[144:147]
    s_waitcnt lgkmcnt(12)
    v_mfma_f32_16x16x32_bf16 v[148:151], v[84:87], v[48:51], v[148:151]
    buffer_load_dwordx4 v[184:187], v6, s[8:11], s30 offen offset:64
    buffer_load_dwordx2 v[214:215], v7, s[12:15], s31 offen offset:32
    s_waitcnt lgkmcnt(11)
    v_mfma_f32_16x16x32_bf16 v[152:155], v[88:91], v[48:51], v[152:155]
    s_waitcnt lgkmcnt(10)
    v_mfma_f32_16x16x32_bf16 v[156:159], v[92:95], v[48:51], v[156:159]
    s_waitcnt lgkmcnt(9)
    v_mfma_f32_16x16x32_bf16 v[160:163], v[96:99], v[48:51], v[160:163]
    s_waitcnt lgkmcnt(8)
    v_mfma_f32_16x16x32_bf16 v[164:167], v[100:103], v[48:51], v[164:167]
    v_mfma_f32_16x16x32_bf16 v[168:171], v[176:179], v[52:55], v[168:171]
    v_mfma_f32_16x16x32_bf16 v[172:175], v[52:55], v[52:55], v[172:175]
    buffer_load_dwordx4 v[188:191], v6, s[8:11], s30 offen offset:128
    buffer_load_dwordx2 v[216:217], v7, s[12:15], s31 offen offset:64
    s_waitcnt lgkmcnt(7)
    v_mfma_f32_16x16x32_bf16 v[136:139], v[104:107], v[52:55], v[136:139]
    s_waitcnt lgkmcnt(6)
    v_mfma_f32_16x16x32_bf16 v[140:143], v[108:111], v[52:55], v[140:143]
    s_waitcnt lgkmcnt(5)
    v_mfma_f32_16x16x32_bf16 v[144:147], v[112:115], v[52:55], v[144:147]
    s_waitcnt lgkmcnt(4)
    v_mfma_f32_16x16x32_bf16 v[148:151], v[116:119], v[52:55], v[148:151]
    buffer_load_dwordx4 v[192:195], v6, s[8:11], s30 offen offset:192
    buffer_load_dwordx2 v[218:219], v7, s[12:15], s31 offen offset:96
    s_waitcnt lgkmcnt(3)
    v_mfma_f32_16x16x32_bf16 v[152:155], v[120:123], v[52:55], v[152:155]
    s_waitcnt lgkmcnt(2)
    v_mfma_f32_16x16x32_bf16 v[156:159], v[124:127], v[52:55], v[156:159]
    s_waitcnt lgkmcnt(1)
    v_mfma_f32_16x16x32_bf16 v[160:163], v[128:131], v[52:55], v[160:163]
    s_waitcnt lgkmcnt(0)
    v_mfma_f32_16x16x32_bf16 v[164:167], v[132:135], v[52:55], v[164:167]
    s_waitcnt vmcnt(12)
    s_barrier
    ds_read_b128 v[72:75], v8 offset:16384
    ds_read_b128 v[76:79], v8 offset:17408
    ds_read_b128 v[80:83], v8 offset:18432
    ds_read_b128 v[84:87], v8 offset:19456
    ds_read_b128 v[88:91], v8 offset:20480
    ds_read_b128 v[92:95], v8 offset:21504
    ds_read_b128 v[96:99], v8 offset:22528
    ds_read_b128 v[100:103], v8 offset:23552
    ds_read_b128 v[104:107], v8 offset:24576
    ds_read_b128 v[108:111], v8 offset:25600
    ds_read_b128 v[112:115], v8 offset:26624
    ds_read_b128 v[116:119], v8 offset:27648
    ds_read_b128 v[120:123], v8 offset:28672
    ds_read_b128 v[124:127], v8 offset:29696
    ds_read_b128 v[128:131], v8 offset:30720
    ds_read_b128 v[132:135], v8 offset:31744
    v_mfma_f32_16x16x32_bf16 v[168:171], v[176:179], v[56:59], v[168:171]
    v_mfma_f32_16x16x32_bf16 v[172:175], v[56:59], v[56:59], v[172:175]
    buffer_load_dwordx4 v[196:199], v6, s[8:11], s30 offen offset:256
    buffer_load_dwordx2 v[220:221], v7, s[12:15], s31 offen offset:128
    s_waitcnt lgkmcnt(15)
    v_mfma_f32_16x16x32_bf16 v[136:139], v[72:75], v[56:59], v[136:139]
    s_waitcnt lgkmcnt(14)
    v_mfma_f32_16x16x32_bf16 v[140:143], v[76:79], v[56:59], v[140:143]
    s_waitcnt lgkmcnt(13)
    v_mfma_f32_16x16x32_bf16 v[144:147], v[80:83], v[56:59], v[144:147]
    s_waitcnt lgkmcnt(12)
    v_mfma_f32_16x16x32_bf16 v[148:151], v[84:87], v[56:59], v[148:151]
    buffer_load_dwordx4 v[200:203], v6, s[8:11], s30 offen offset:320
    buffer_load_dwordx2 v[222:223], v7, s[12:15], s31 offen offset:160
    s_waitcnt lgkmcnt(11)
    v_mfma_f32_16x16x32_bf16 v[152:155], v[88:91], v[56:59], v[152:155]
    s_waitcnt lgkmcnt(10)
    v_mfma_f32_16x16x32_bf16 v[156:159], v[92:95], v[56:59], v[156:159]
    s_waitcnt lgkmcnt(9)
    v_mfma_f32_16x16x32_bf16 v[160:163], v[96:99], v[56:59], v[160:163]
    s_waitcnt lgkmcnt(8)
    v_mfma_f32_16x16x32_bf16 v[164:167], v[100:103], v[56:59], v[164:167]
    v_mfma_f32_16x16x32_bf16 v[168:171], v[176:179], v[60:63], v[168:171]
    v_mfma_f32_16x16x32_bf16 v[172:175], v[60:63], v[60:63], v[172:175]
    buffer_load_dwordx4 v[204:207], v6, s[8:11], s30 offen offset:384
    buffer_load_dwordx2 v[224:225], v7, s[12:15], s31 offen offset:192
    s_waitcnt lgkmcnt(7)
    v_mfma_f32_16x16x32_bf16 v[136:139], v[104:107], v[60:63], v[136:139]
    s_waitcnt lgkmcnt(6)
    v_mfma_f32_16x16x32_bf16 v[140:143], v[108:111], v[60:63], v[140:143]
    s_waitcnt lgkmcnt(5)
    v_mfma_f32_16x16x32_bf16 v[144:147], v[112:115], v[60:63], v[144:147]
    s_waitcnt lgkmcnt(4)
    v_mfma_f32_16x16x32_bf16 v[148:151], v[116:119], v[60:63], v[148:151]
    buffer_load_dwordx4 v[208:211], v6, s[8:11], s30 offen offset:448
    buffer_load_dwordx2 v[226:227], v7, s[12:15], s31 offen offset:224
    s_waitcnt lgkmcnt(3)
    v_mfma_f32_16x16x32_bf16 v[152:155], v[120:123], v[60:63], v[152:155]
    s_waitcnt lgkmcnt(2)
    v_mfma_f32_16x16x32_bf16 v[156:159], v[124:127], v[60:63], v[156:159]
    s_waitcnt lgkmcnt(1)
    v_mfma_f32_16x16x32_bf16 v[160:163], v[128:131], v[60:63], v[160:163]
    s_waitcnt lgkmcnt(0)
    v_mfma_f32_16x16x32_bf16 v[164:167], v[132:135], v[60:63], v[164:167]
    s_waitcnt vmcnt(16)
    s_barrier
    ds_read_b128 v[72:75], v8 offset:32768
    ds_read_b128 v[76:79], v8 offset:33792
    ds_read_b128 v[80:83], v8 offset:34816
    ds_read_b128 v[84:87], v8 offset:35840
    ds_read_b128 v[88:91], v8 offset:36864
    ds_read_b128 v[92:95], v8 offset:37888
    ds_read_b128 v[96:99], v8 offset:38912
    ds_read_b128 v[100:103], v8 offset:39936
    ds_read_b128 v[104:107], v8 offset:40960
    ds_read_b128 v[108:111], v8 offset:41984
    ds_read_b128 v[112:115], v8 offset:43008
    ds_read_b128 v[116:119], v8 offset:44032
    ds_read_b128 v[120:123], v8 offset:45056
    ds_read_b128 v[124:127], v8 offset:46080
    ds_read_b128 v[128:131], v8 offset:47104
    ds_read_b128 v[132:135], v8 offset:48128
    v_mfma_f32_16x16x32_bf16 v[168:171], v[176:179], v[64:67], v[168:171]
    v_mfma_f32_16x16x32_bf16 v[172:175], v[64:67], v[64:67], v[172:175]
    s_waitcnt lgkmcnt(15)
    v_mfma_f32_16x16x32_bf16 v[136:139], v[72:75], v[64:67], v[136:139]
    s_waitcnt lgkmcnt(14)
    v_mfma_f32_16x16x32_bf16 v[140:143], v[76:79], v[64:67], v[140:143]
    s_waitcnt lgkmcnt(13)
    v_mfma_f32_16x16x32_bf16 v[144:147], v[80:83], v[64:67], v[144:147]
    s_waitcnt lgkmcnt(12)
    v_mfma_f32_16x16x32_bf16 v[148:151], v[84:87], v[64:67], v[148:151]
    s_waitcnt lgkmcnt(11)
    v_mfma_f32_16x16x32_bf16 v[152:155], v[88:91], v[64:67], v[152:155]
    s_waitcnt lgkmcnt(10)
    v_mfma_f32_16x16x32_bf16 v[156:159], v[92:95], v[64:67], v[156:159]
    s_waitcnt lgkmcnt(9)
    v_mfma_f32_16x16x32_bf16 v[160:163], v[96:99], v[64:67], v[160:163]
    s_waitcnt lgkmcnt(8)
    v_mfma_f32_16x16x32_bf16 v[164:167], v[100:103], v[64:67], v[164:167]
    v_mfma_f32_16x16x32_bf16 v[168:171], v[176:179], v[68:71], v[168:171]
    v_mfma_f32_16x16x32_bf16 v[172:175], v[68:71], v[68:71], v[172:175]
    s_waitcnt lgkmcnt(7)
    v_mfma_f32_16x16x32_bf16 v[136:139], v[104:107], v[68:71], v[136:139]
    s_waitcnt lgkmcnt(6)
    v_mfma_f32_16x16x32_bf16 v[140:143], v[108:111], v[68:71], v[140:143]
    s_waitcnt lgkmcnt(5)
    v_mfma_f32_16x16x32_bf16 v[144:147], v[112:115], v[68:71], v[144:147]
    s_waitcnt lgkmcnt(4)
    v_mfma_f32_16x16x32_bf16 v[148:151], v[116:119], v[68:71], v[148:151]
    s_waitcnt lgkmcnt(3)
    v_mfma_f32_16x16x32_bf16 v[152:155], v[120:123], v[68:71], v[152:155]
    s_waitcnt lgkmcnt(2)
    v_mfma_f32_16x16x32_bf16 v[156:159], v[124:127], v[68:71], v[156:159]
    s_waitcnt lgkmcnt(1)
    v_mfma_f32_16x16x32_bf16 v[160:163], v[128:131], v[68:71], v[160:163]
    s_waitcnt lgkmcnt(0)
    v_mfma_f32_16x16x32_bf16 v[164:167], v[132:135], v[68:71], v[164:167]
    v_cndmask_b32 v230, v172, v173, s[40:41]
    v_cndmask_b32 v230, v230, v174, s[42:43]
    v_cndmask_b32 v230, v230, v175, s[44:45]
    v_cndmask_b32 v230, 0, v230, s[46:47]
    v_mov_b32 v231, v230
    s_nop 1
    v_permlane16_swap_b32 v230, v231
    v_add_f32 v230, v230, v231
    v_mov_b32 v231, v230
    s_nop 1
    v_permlane32_swap_b32 v230, v231
    v_add_f32 v230, v230, v231
    v_mul_f32 v231, 991054117, v168
    v_mul_f32 v230, 991054117, v230
    v_fma_f32 v230, -v231, v231, v230
    v_max_f32 v230, 0, v230
    v_add_f32 v230, 925353388, v230
    v_rsq_f32 v229, v230
    s_nop 0
    v_mul_f32 v228, v231, v229
    v_sub_f32 v228, 0, v228
    s_mul_i32 s26, s23, 57344
    s_lshl_b32 s27, s22, 12
    s_add_u32 s26, s26, s27
    s_add_u32 s26, s26, 8388608
    s_mov_b32 s34, 1027024659
    s_mov_b32 s35, 3222493025
    s_waitcnt vmcnt(15)
    v_mul_f32 v16, v228, v180
    v_mul_f32 v17, v228, v181
    v_mul_f32 v18, v228, v182
    v_mul_f32 v19, v228, v183
    s_waitcnt vmcnt(13)
    v_mul_f32 v20, v228, v184
    v_mul_f32 v21, v228, v185
    v_mul_f32 v22, v228, v186
    v_mul_f32 v23, v228, v187
    v_fmac_f32 v16, v136, v229
    v_fmac_f32 v17, v137, v229
    v_fmac_f32 v18, v138, v229
    v_fmac_f32 v19, v139, v229
    v_fmac_f32 v20, v140, v229
    v_fmac_f32 v21, v141, v229
    v_fmac_f32 v22, v142, v229
    v_fmac_f32 v23, v143, v229
    v_cvt_pk_bf16_f32 v232, v16, v17
    v_cvt_pk_bf16_f32 v233, v18, v19
    v_cvt_pk_bf16_f32 v234, v20, v21
    v_cvt_pk_bf16_f32 v235, v22, v23
    v_lshlrev_b32 v16, 16, v232
    v_and_b32 v17, 4294901760, v232
    v_lshlrev_b32 v18, 16, v233
    v_and_b32 v19, 4294901760, v233
    v_lshlrev_b32 v20, 16, v234
    v_and_b32 v21, 4294901760, v234
    v_lshlrev_b32 v22, 16, v235
    v_and_b32 v23, 4294901760, v235
    v_lshlrev_b32 v24, 16, v212
    v_and_b32 v25, 4294901760, v212
    v_lshlrev_b32 v26, 16, v213
    v_and_b32 v27, 4294901760, v213
    s_waitcnt vmcnt(12)
    v_lshlrev_b32 v28, 16, v214
    v_and_b32 v29, 4294901760, v214
    v_lshlrev_b32 v30, 16, v215
    v_and_b32 v31, 4294901760, v215
    v_add_f32 v16, v16, v24
    v_add_f32 v17, v17, v25
    v_add_f32 v18, v18, v26
    v_add_f32 v19, v19, v27
    v_add_f32 v20, v20, v28
    v_add_f32 v21, v21, v29
    v_add_f32 v22, v22, v30
    v_add_f32 v23, v23, v31
    v_cvt_pk_bf16_f32 v232, v16, v17
    v_cvt_pk_bf16_f32 v233, v18, v19
    v_cvt_pk_bf16_f32 v234, v20, v21
    v_cvt_pk_bf16_f32 v235, v22, v23
    v_lshlrev_b32 v16, 16, v232
    v_and_b32 v17, 4294901760, v232
    v_lshlrev_b32 v18, 16, v233
    v_and_b32 v19, 4294901760, v233
    v_lshlrev_b32 v20, 16, v234
    v_and_b32 v21, 4294901760, v234
    v_lshlrev_b32 v22, 16, v235
    v_and_b32 v23, 4294901760, v235
    v_mul_f32 v24, v16, v16
    v_mul_f32 v25, v17, v17
    v_mul_f32 v26, v18, v18
    v_mul_f32 v27, v19, v19
    v_mul_f32 v28, v20, v20
    v_mul_f32 v29, v21, v21
    v_mul_f32 v30, v22, v22
    v_mul_f32 v31, v23, v23
    v_fma_f32 v24, v24, s34, 1.0
    v_fma_f32 v25, v25, s34, 1.0
    v_fma_f32 v26, v26, s34, 1.0
    v_fma_f32 v27, v27, s34, 1.0
    v_fma_f32 v28, v28, s34, 1.0
    v_fma_f32 v29, v29, s34, 1.0
    v_fma_f32 v30, v30, s34, 1.0
    v_fma_f32 v31, v31, s34, 1.0
    v_mul_f32 v24, v24, v16
    v_mul_f32 v25, v25, v17
    v_mul_f32 v26, v26, v18
    v_mul_f32 v27, v27, v19
    v_mul_f32 v28, v28, v20
    v_mul_f32 v29, v29, v21
    v_mul_f32 v30, v30, v22
    v_mul_f32 v31, v31, v23
    v_mul_f32 v24, s35, v24
    v_mul_f32 v25, s35, v25
    v_mul_f32 v26, s35, v26
    v_mul_f32 v27, s35, v27
    v_mul_f32 v28, s35, v28
    v_mul_f32 v29, s35, v29
    v_mul_f32 v30, s35, v30
    v_mul_f32 v31, s35, v31
    v_exp_f32 v24, v24
    v_exp_f32 v25, v25
    v_exp_f32 v26, v26
    v_exp_f32 v27, v27
    v_exp_f32 v28, v28
    v_exp_f32 v29, v29
    v_exp_f32 v30, v30
    v_exp_f32 v31, v31
    v_add_f32 v24, 1.0, v24
    v_add_f32 v25, 1.0, v25
    v_add_f32 v26, 1.0, v26
    v_add_f32 v27, 1.0, v27
    v_add_f32 v28, 1.0, v28
    v_add_f32 v29, 1.0, v29
    v_add_f32 v30, 1.0, v30
    v_add_f32 v31, 1.0, v31
    v_rcp_f32 v24, v24
    v_rcp_f32 v25, v25
    v_rcp_f32 v26, v26
    v_rcp_f32 v27, v27
    v_rcp_f32 v28, v28
    v_rcp_f32 v29, v29
    v_rcp_f32 v30, v30
    v_rcp_f32 v31, v31
    v_mul_f32 v16, v16, v24
    v_mul_f32 v17, v17, v25
    v_mul_f32 v18, v18, v26
    v_mul_f32 v19, v19, v27
    v_mul_f32 v20, v20, v28
    v_mul_f32 v21, v21, v29
    v_mul_f32 v22, v22, v30
    v_mul_f32 v23, v23, v31
    v_cvt_pk_bf16_f32 v236, v16, v17
    v_cvt_pk_bf16_f32 v237, v18, v19
    v_cvt_pk_bf16_f32 v238, v20, v21
    v_cvt_pk_bf16_f32 v239, v22, v23
    buffer_store_dwordx4 v[236:239], v5, s[8:11], s26 offen offset:0 sc1
    s_waitcnt vmcnt(12)
    v_mul_f32 v32, v228, v188
    v_mul_f32 v33, v228, v189
    v_mul_f32 v34, v228, v190
    v_mul_f32 v35, v228, v191
    s_waitcnt vmcnt(10)
    v_mul_f32 v36, v228, v192
    v_mul_f32 v37, v228, v193
    v_mul_f32 v38, v228, v194
    v_mul_f32 v39, v228, v195
    v_fmac_f32 v32, v144, v229
    v_fmac_f32 v33, v145, v229
    v_fmac_f32 v34, v146, v229
    v_fmac_f32 v35, v147, v229
    v_fmac_f32 v36, v148, v229
    v_fmac_f32 v37, v149, v229
    v_fmac_f32 v38, v150, v229
    v_fmac_f32 v39, v151, v229
    v_cvt_pk_bf16_f32 v232, v32, v33
    v_cvt_pk_bf16_f32 v233, v34, v35
    v_cvt_pk_bf16_f32 v234, v36, v37
    v_cvt_pk_bf16_f32 v235, v38, v39
    v_lshlrev_b32 v32, 16, v232
    v_and_b32 v33, 4294901760, v232
    v_lshlrev_b32 v34, 16, v233
    v_and_b32 v35, 4294901760, v233
    v_lshlrev_b32 v36, 16, v234
    v_and_b32 v37, 4294901760, v234
    v_lshlrev_b32 v38, 16, v235
    v_and_b32 v39, 4294901760, v235
    v_lshlrev_b32 v40, 16, v216
    v_and_b32 v41, 4294901760, v216
    v_lshlrev_b32 v42, 16, v217
    v_and_b32 v43, 4294901760, v217
    s_waitcnt vmcnt(9)
    v_lshlrev_b32 v44, 16, v218
    v_and_b32 v45, 4294901760, v218
    v_lshlrev_b32 v46, 16, v219
    v_and_b32 v47, 4294901760, v219
    v_add_f32 v32, v32, v40
    v_add_f32 v33, v33, v41
    v_add_f32 v34, v34, v42
    v_add_f32 v35, v35, v43
    v_add_f32 v36, v36, v44
    v_add_f32 v37, v37, v45
    v_add_f32 v38, v38, v46
    v_add_f32 v39, v39, v47
    v_cvt_pk_bf16_f32 v232, v32, v33
    v_cvt_pk_bf16_f32 v233, v34, v35
    v_cvt_pk_bf16_f32 v234, v36, v37
    v_cvt_pk_bf16_f32 v235, v38, v39
    v_lshlrev_b32 v32, 16, v232
    v_and_b32 v33, 4294901760, v232
    v_lshlrev_b32 v34, 16, v233
    v_and_b32 v35, 4294901760, v233
    v_lshlrev_b32 v36, 16, v234
    v_and_b32 v37, 4294901760, v234
    v_lshlrev_b32 v38, 16, v235
    v_and_b32 v39, 4294901760, v235
    v_mul_f32 v40, v32, v32
    v_mul_f32 v41, v33, v33
    v_mul_f32 v42, v34, v34
    v_mul_f32 v43, v35, v35
    v_mul_f32 v44, v36, v36
    v_mul_f32 v45, v37, v37
    v_mul_f32 v46, v38, v38
    v_mul_f32 v47, v39, v39
    v_fma_f32 v40, v40, s34, 1.0
    v_fma_f32 v41, v41, s34, 1.0
    v_fma_f32 v42, v42, s34, 1.0
    v_fma_f32 v43, v43, s34, 1.0
    v_fma_f32 v44, v44, s34, 1.0
    v_fma_f32 v45, v45, s34, 1.0
    v_fma_f32 v46, v46, s34, 1.0
    v_fma_f32 v47, v47, s34, 1.0
    v_mul_f32 v40, v40, v32
    v_mul_f32 v41, v41, v33
    v_mul_f32 v42, v42, v34
    v_mul_f32 v43, v43, v35
    v_mul_f32 v44, v44, v36
    v_mul_f32 v45, v45, v37
    v_mul_f32 v46, v46, v38
    v_mul_f32 v47, v47, v39
    v_mul_f32 v40, s35, v40
    v_mul_f32 v41, s35, v41
    v_mul_f32 v42, s35, v42
    v_mul_f32 v43, s35, v43
    v_mul_f32 v44, s35, v44
    v_mul_f32 v45, s35, v45
    v_mul_f32 v46, s35, v46
    v_mul_f32 v47, s35, v47
    v_exp_f32 v40, v40
    v_exp_f32 v41, v41
    v_exp_f32 v42, v42
    v_exp_f32 v43, v43
    v_exp_f32 v44, v44
    v_exp_f32 v45, v45
    v_exp_f32 v46, v46
    v_exp_f32 v47, v47
    v_add_f32 v40, 1.0, v40
    v_add_f32 v41, 1.0, v41
    v_add_f32 v42, 1.0, v42
    v_add_f32 v43, 1.0, v43
    v_add_f32 v44, 1.0, v44
    v_add_f32 v45, 1.0, v45
    v_add_f32 v46, 1.0, v46
    v_add_f32 v47, 1.0, v47
    v_rcp_f32 v40, v40
    v_rcp_f32 v41, v41
    v_rcp_f32 v42, v42
    v_rcp_f32 v43, v43
    v_rcp_f32 v44, v44
    v_rcp_f32 v45, v45
    v_rcp_f32 v46, v46
    v_rcp_f32 v47, v47
    v_mul_f32 v32, v32, v40
    v_mul_f32 v33, v33, v41
    v_mul_f32 v34, v34, v42
    v_mul_f32 v35, v35, v43
    v_mul_f32 v36, v36, v44
    v_mul_f32 v37, v37, v45
    v_mul_f32 v38, v38, v46
    v_mul_f32 v39, v39, v47
    v_cvt_pk_bf16_f32 v240, v32, v33
    v_cvt_pk_bf16_f32 v241, v34, v35
    v_cvt_pk_bf16_f32 v242, v36, v37
    v_cvt_pk_bf16_f32 v243, v38, v39
    buffer_store_dwordx4 v[240:243], v5, s[8:11], s26 offen offset:1024 sc1
    s_waitcnt vmcnt(9)
    v_mul_f32 v16, v228, v196
    v_mul_f32 v17, v228, v197
    v_mul_f32 v18, v228, v198
    v_mul_f32 v19, v228, v199
    s_waitcnt vmcnt(7)
    v_mul_f32 v20, v228, v200
    v_mul_f32 v21, v228, v201
    v_mul_f32 v22, v228, v202
    v_mul_f32 v23, v228, v203
    v_fmac_f32 v16, v152, v229
    v_fmac_f32 v17, v153, v229
    v_fmac_f32 v18, v154, v229
    v_fmac_f32 v19, v155, v229
    v_fmac_f32 v20, v156, v229
    v_fmac_f32 v21, v157, v229
    v_fmac_f32 v22, v158, v229
    v_fmac_f32 v23, v159, v229
    v_cvt_pk_bf16_f32 v232, v16, v17
    v_cvt_pk_bf16_f32 v233, v18, v19
    v_cvt_pk_bf16_f32 v234, v20, v21
    v_cvt_pk_bf16_f32 v235, v22, v23
    v_lshlrev_b32 v16, 16, v232
    v_and_b32 v17, 4294901760, v232
    v_lshlrev_b32 v18, 16, v233
    v_and_b32 v19, 4294901760, v233
    v_lshlrev_b32 v20, 16, v234
    v_and_b32 v21, 4294901760, v234
    v_lshlrev_b32 v22, 16, v235
    v_and_b32 v23, 4294901760, v235
    v_lshlrev_b32 v24, 16, v220
    v_and_b32 v25, 4294901760, v220
    v_lshlrev_b32 v26, 16, v221
    v_and_b32 v27, 4294901760, v221
    s_waitcnt vmcnt(6)
    v_lshlrev_b32 v28, 16, v222
    v_and_b32 v29, 4294901760, v222
    v_lshlrev_b32 v30, 16, v223
    v_and_b32 v31, 4294901760, v223
    v_add_f32 v16, v16, v24
    v_add_f32 v17, v17, v25
    v_add_f32 v18, v18, v26
    v_add_f32 v19, v19, v27
    v_add_f32 v20, v20, v28
    v_add_f32 v21, v21, v29
    v_add_f32 v22, v22, v30
    v_add_f32 v23, v23, v31
    v_cvt_pk_bf16_f32 v232, v16, v17
    v_cvt_pk_bf16_f32 v233, v18, v19
    v_cvt_pk_bf16_f32 v234, v20, v21
    v_cvt_pk_bf16_f32 v235, v22, v23
    v_lshlrev_b32 v16, 16, v232
    v_and_b32 v17, 4294901760, v232
    v_lshlrev_b32 v18, 16, v233
    v_and_b32 v19, 4294901760, v233
    v_lshlrev_b32 v20, 16, v234
    v_and_b32 v21, 4294901760, v234
    v_lshlrev_b32 v22, 16, v235
    v_and_b32 v23, 4294901760, v235
    v_mul_f32 v24, v16, v16
    v_mul_f32 v25, v17, v17
    v_mul_f32 v26, v18, v18
    v_mul_f32 v27, v19, v19
    v_mul_f32 v28, v20, v20
    v_mul_f32 v29, v21, v21
    v_mul_f32 v30, v22, v22
    v_mul_f32 v31, v23, v23
    v_fma_f32 v24, v24, s34, 1.0
    v_fma_f32 v25, v25, s34, 1.0
    v_fma_f32 v26, v26, s34, 1.0
    v_fma_f32 v27, v27, s34, 1.0
    v_fma_f32 v28, v28, s34, 1.0
    v_fma_f32 v29, v29, s34, 1.0
    v_fma_f32 v30, v30, s34, 1.0
    v_fma_f32 v31, v31, s34, 1.0
    v_mul_f32 v24, v24, v16
    v_mul_f32 v25, v25, v17
    v_mul_f32 v26, v26, v18
    v_mul_f32 v27, v27, v19
    v_mul_f32 v28, v28, v20
    v_mul_f32 v29, v29, v21
    v_mul_f32 v30, v30, v22
    v_mul_f32 v31, v31, v23
    v_mul_f32 v24, s35, v24
    v_mul_f32 v25, s35, v25
    v_mul_f32 v26, s35, v26
    v_mul_f32 v27, s35, v27
    v_mul_f32 v28, s35, v28
    v_mul_f32 v29, s35, v29
    v_mul_f32 v30, s35, v30
    v_mul_f32 v31, s35, v31
    v_exp_f32 v24, v24
    v_exp_f32 v25, v25
    v_exp_f32 v26, v26
    v_exp_f32 v27, v27
    v_exp_f32 v28, v28
    v_exp_f32 v29, v29
    v_exp_f32 v30, v30
    v_exp_f32 v31, v31
    v_add_f32 v24, 1.0, v24
    v_add_f32 v25, 1.0, v25
    v_add_f32 v26, 1.0, v26
    v_add_f32 v27, 1.0, v27
    v_add_f32 v28, 1.0, v28
    v_add_f32 v29, 1.0, v29
    v_add_f32 v30, 1.0, v30
    v_add_f32 v31, 1.0, v31
    v_rcp_f32 v24, v24
    v_rcp_f32 v25, v25
    v_rcp_f32 v26, v26
    v_rcp_f32 v27, v27
    v_rcp_f32 v28, v28
    v_rcp_f32 v29, v29
    v_rcp_f32 v30, v30
    v_rcp_f32 v31, v31
    v_mul_f32 v16, v16, v24
    v_mul_f32 v17, v17, v25
    v_mul_f32 v18, v18, v26
    v_mul_f32 v19, v19, v27
    v_mul_f32 v20, v20, v28
    v_mul_f32 v21, v21, v29
    v_mul_f32 v22, v22, v30
    v_mul_f32 v23, v23, v31
    v_cvt_pk_bf16_f32 v236, v16, v17
    v_cvt_pk_bf16_f32 v237, v18, v19
    v_cvt_pk_bf16_f32 v238, v20, v21
    v_cvt_pk_bf16_f32 v239, v22, v23
    buffer_store_dwordx4 v[236:239], v5, s[8:11], s26 offen offset:2048 sc1
    s_waitcnt vmcnt(6)
    v_mul_f32 v32, v228, v204
    v_mul_f32 v33, v228, v205
    v_mul_f32 v34, v228, v206
    v_mul_f32 v35, v228, v207
    s_waitcnt vmcnt(4)
    v_mul_f32 v36, v228, v208
    v_mul_f32 v37, v228, v209
    v_mul_f32 v38, v228, v210
    v_mul_f32 v39, v228, v211
    v_fmac_f32 v32, v160, v229
    v_fmac_f32 v33, v161, v229
    v_fmac_f32 v34, v162, v229
    v_fmac_f32 v35, v163, v229
    v_fmac_f32 v36, v164, v229
    v_fmac_f32 v37, v165, v229
    v_fmac_f32 v38, v166, v229
    v_fmac_f32 v39, v167, v229
    v_cvt_pk_bf16_f32 v232, v32, v33
    v_cvt_pk_bf16_f32 v233, v34, v35
    v_cvt_pk_bf16_f32 v234, v36, v37
    v_cvt_pk_bf16_f32 v235, v38, v39
    v_lshlrev_b32 v32, 16, v232
    v_and_b32 v33, 4294901760, v232
    v_lshlrev_b32 v34, 16, v233
    v_and_b32 v35, 4294901760, v233
    v_lshlrev_b32 v36, 16, v234
    v_and_b32 v37, 4294901760, v234
    v_lshlrev_b32 v38, 16, v235
    v_and_b32 v39, 4294901760, v235
    v_lshlrev_b32 v40, 16, v224
    v_and_b32 v41, 4294901760, v224
    v_lshlrev_b32 v42, 16, v225
    v_and_b32 v43, 4294901760, v225
    s_waitcnt vmcnt(3)
    v_lshlrev_b32 v44, 16, v226
    v_and_b32 v45, 4294901760, v226
    v_lshlrev_b32 v46, 16, v227
    v_and_b32 v47, 4294901760, v227
    v_add_f32 v32, v32, v40
    v_add_f32 v33, v33, v41
    v_add_f32 v34, v34, v42
    v_add_f32 v35, v35, v43
    v_add_f32 v36, v36, v44
    v_add_f32 v37, v37, v45
    v_add_f32 v38, v38, v46
    v_add_f32 v39, v39, v47
    v_cvt_pk_bf16_f32 v232, v32, v33
    v_cvt_pk_bf16_f32 v233, v34, v35
    v_cvt_pk_bf16_f32 v234, v36, v37
    v_cvt_pk_bf16_f32 v235, v38, v39
    v_lshlrev_b32 v32, 16, v232
    v_and_b32 v33, 4294901760, v232
    v_lshlrev_b32 v34, 16, v233
    v_and_b32 v35, 4294901760, v233
    v_lshlrev_b32 v36, 16, v234
    v_and_b32 v37, 4294901760, v234
    v_lshlrev_b32 v38, 16, v235
    v_and_b32 v39, 4294901760, v235
    v_mul_f32 v40, v32, v32
    v_mul_f32 v41, v33, v33
    v_mul_f32 v42, v34, v34
    v_mul_f32 v43, v35, v35
    v_mul_f32 v44, v36, v36
    v_mul_f32 v45, v37, v37
    v_mul_f32 v46, v38, v38
    v_mul_f32 v47, v39, v39
    v_fma_f32 v40, v40, s34, 1.0
    v_fma_f32 v41, v41, s34, 1.0
    v_fma_f32 v42, v42, s34, 1.0
    v_fma_f32 v43, v43, s34, 1.0
    v_fma_f32 v44, v44, s34, 1.0
    v_fma_f32 v45, v45, s34, 1.0
    v_fma_f32 v46, v46, s34, 1.0
    v_fma_f32 v47, v47, s34, 1.0
    v_mul_f32 v40, v40, v32
    v_mul_f32 v41, v41, v33
    v_mul_f32 v42, v42, v34
    v_mul_f32 v43, v43, v35
    v_mul_f32 v44, v44, v36
    v_mul_f32 v45, v45, v37
    v_mul_f32 v46, v46, v38
    v_mul_f32 v47, v47, v39
    v_mul_f32 v40, s35, v40
    v_mul_f32 v41, s35, v41
    v_mul_f32 v42, s35, v42
    v_mul_f32 v43, s35, v43
    v_mul_f32 v44, s35, v44
    v_mul_f32 v45, s35, v45
    v_mul_f32 v46, s35, v46
    v_mul_f32 v47, s35, v47
    v_exp_f32 v40, v40
    v_exp_f32 v41, v41
    v_exp_f32 v42, v42
    v_exp_f32 v43, v43
    v_exp_f32 v44, v44
    v_exp_f32 v45, v45
    v_exp_f32 v46, v46
    v_exp_f32 v47, v47
    v_add_f32 v40, 1.0, v40
    v_add_f32 v41, 1.0, v41
    v_add_f32 v42, 1.0, v42
    v_add_f32 v43, 1.0, v43
    v_add_f32 v44, 1.0, v44
    v_add_f32 v45, 1.0, v45
    v_add_f32 v46, 1.0, v46
    v_add_f32 v47, 1.0, v47
    v_rcp_f32 v40, v40
    v_rcp_f32 v41, v41
    v_rcp_f32 v42, v42
    v_rcp_f32 v43, v43
    v_rcp_f32 v44, v44
    v_rcp_f32 v45, v45
    v_rcp_f32 v46, v46
    v_rcp_f32 v47, v47
    v_mul_f32 v32, v32, v40
    v_mul_f32 v33, v33, v41
    v_mul_f32 v34, v34, v42
    v_mul_f32 v35, v35, v43
    v_mul_f32 v36, v36, v44
    v_mul_f32 v37, v37, v45
    v_mul_f32 v38, v38, v46
    v_mul_f32 v39, v39, v47
    v_cvt_pk_bf16_f32 v240, v32, v33
    v_cvt_pk_bf16_f32 v241, v34, v35
    v_cvt_pk_bf16_f32 v242, v36, v37
    v_cvt_pk_bf16_f32 v243, v38, v39
    buffer_store_dwordx4 v[240:243], v5, s[8:11], s26 offen offset:3072 sc1
    s_nop 4
L_end_k3a_kernel:
    s_endpgm

.globl k4a_kernel
.p2align 8
.type k4a_kernel,@function
k4a_kernel:
    s_cmp_ge_u32 s2, 237
    s_cbranch_scc1 L_end_k4a_kernel
    s_load_dwordx2 s[4:5], s[0:1], 88
    s_load_dwordx2 s[12:13], s[0:1], 64
    v_and_b32 v1, 63, v0
    v_lshrrev_b32 v2, 6, v0
    s_nop 0
    v_readfirstlane_b32 s20, v2
    v_and_b32 v3, 15, v1
    v_lshrrev_b32 v4, 4, v1
    v_lshlrev_b32 v5, 4, v1
    s_waitcnt lgkmcnt(0)
    s_mov_b32 s8, s4
    s_and_b32 s9, s5, 65535
    s_mov_b32 s10, 268435456
    s_mov_b32 s11, 131072
    s_and_b32 s13, s13, 65535
    s_mov_b32 s14, 896
    s_mov_b32 s15, 131072
    s_cmp_ge_u32 s2, 224
    s_cbranch_scc1 L_prep_k4a_kernel
    s_and_b32 s26, s2, 7
    s_lshr_b32 s27, s2, 3
    s_mul_i32 s28, s27, 37
    s_lshr_b32 s28, s28, 8
    s_mul_i32 s22, s28, 7
    s_sub_u32 s22, s27, s22
    s_lshl_b32 s21, s26, 2
    s_add_u32 s21, s21, s28
    s_mul_i32 s26, s22, 229376
    s_mul_i32 s27, s20, 7168
    s_add_u32 s26, s26, s27
    s_add_u32 s26, s26, 27262976
    s_mul_i32 s28, s21, 229376
    s_add_u32 s28, s28, s27
    s_add_u32 s28, s28, 8388608
    s_add_u32 s29, s28, 0
    buffer_load_dwordx4 v[144:147], v5, s[8:11], s29 offen
    s_add_u32 s29, s26, 0
    buffer_load_dwordx4 v[80:83], v5, s[8:11], s29 offen
    s_add_u32 s29, s28, 57344
    buffer_load_dwordx4 v[148:151], v5, s[8:11], s29 offen
    s_add_u32 s29, s26, 57344
    buffer_load_dwordx4 v[84:87], v5, s[8:11], s29 offen
    s_add_u32 s29, s28, 114688
    buffer_load_dwordx4 v[152:155], v5, s[8:11], s29 offen
    s_add_u32 s29, s26, 114688
    buffer_load_dwordx4 v[88:91], v5, s[8:11], s29 offen
    s_add_u32 s29, s28, 172032
    buffer_load_dwordx4 v[156:159], v5, s[8:11], s29 offen
    s_add_u32 s29, s26, 172032
    buffer_load_dwordx4 v[92:95], v5, s[8:11], s29 offen
    s_add_u32 s29, s28, 1024
    buffer_load_dwordx4 v[160:163], v5, s[8:11], s29 offen
    s_add_u32 s29, s26, 1024
    buffer_load_dwordx4 v[96:99], v5, s[8:11], s29 offen
    s_add_u32 s29, s28, 58368
    buffer_load_dwordx4 v[164:167], v5, s[8:11], s29 offen
    s_add_u32 s29, s26, 58368
    buffer_load_dwordx4 v[100:103], v5, s[8:11], s29 offen
    s_add_u32 s29, s28, 115712
    buffer_load_dwordx4 v[168:171], v5, s[8:11], s29 offen
    s_add_u32 s29, s26, 115712
    buffer_load_dwordx4 v[104:107], v5, s[8:11], s29 offen
    s_add_u32 s29, s28, 173056
    buffer_load_dwordx4 v[172:175], v5, s[8:11], s29 offen
    s_add_u32 s29, s26, 173056
    buffer_load_dwordx4 v[108:111], v5, s[8:11], s29 offen
    s_add_u32 s29, s28, 2048
    buffer_load_dwordx4 v[176:179], v5, s[8:11], s29 offen
    s_add_u32 s29, s26, 2048
    buffer_load_dwordx4 v[112:115], v5, s[8:11], s29 offen
    s_add_u32 s29, s28, 59392
    buffer_load_dwordx4 v[180:183], v5, s[8:11], s29 offen
    s_add_u32 s29, s26, 59392
    buffer_load_dwordx4 v[116:119], v5, s[8:11], s29 offen
    s_add_u32 s29, s28, 116736
    buffer_load_dwordx4 v[184:187], v5, s[8:11], s29 offen
    s_add_u32 s29, s26, 116736
    buffer_load_dwordx4 v[120:123], v5, s[8:11], s29 offen
    s_add_u32 s29, s28, 174080
    buffer_load_dwordx4 v[188:191], v5, s[8:11], s29 offen
    s_add_u32 s29, s26, 174080
    buffer_load_dwordx4 v[124:127], v5, s[8:11], s29 offen
    s_add_u32 s29, s28, 3072
    buffer_load_dwordx4 v[192:195], v5, s[8:11], s29 offen
    s_add_u32 s29, s26, 3072
    buffer_load_dwordx4 v[128:131], v5, s[8:11], s29 offen
    s_add_u32 s29, s28, 60416
    buffer_load_dwordx4 v[196:199], v5, s[8:11], s29 offen
    s_add_u32 s29, s26, 60416
    buffer_load_dwordx4 v[132:135], v5, s[8:11], s29 offen
    s_add_u32 s29, s28, 117760
    buffer_load_dwordx4 v[200:203], v5, s[8:11], s29 offen
    s_add_u32 s29, s26, 117760
    buffer_load_dwordx4 v[136:139], v5, s[8:11], s29 offen
    s_add_u32 s29, s28, 175104
    buffer_load_dwordx4 v[204:207], v5, s[8:11], s29 offen
    s_add_u32 s29, s26, 175104
    buffer_load_dwordx4 v[140:143], v5, s[8:11], s29 offen
    s_waitcnt vmcnt(30)
    v_mfma_f32_16x16x32_bf16 v[16:19], v[80:83], v[144:147], 0
    s_waitcnt vmcnt(28)
    v_mfma_f32_16x16x32_bf16 v[20:23], v[84:87], v[144:147], 0
    s_waitcnt vmcnt(26)
    v_mfma_f32_16x16x32_bf16 v[24:27], v[88:91], v[144:147], 0
    s_waitcnt vmcnt(24)
    v_mfma_f32_16x16x32_bf16 v[28:31], v[92:95], v[144:147], 0
    v_mfma_f32_16x16x32_bf16 v[32:35], v[80:83], v[148:151], 0
    v_mfma_f32_16x16x32_bf16 v[36:39], v[84:87], v[148:151], 0
    v_mfma_f32_16x16x32_bf16 v[40:43], v[88:91], v[148:151], 0
    v_mfma_f32_16x16x32_bf16 v[44:47], v[92:95], v[148:151], 0
    v_mfma_f32_16x16x32_bf16 v[48:51], v[80:83], v[152:155], 0
    v_mfma_f32_16x16x32_bf16 v[52:55], v[84:87], v[152:155], 0
    v_mfma_f32_16x16x32_bf16 v[56:59], v[88:91], v[152:155], 0
    v_mfma_f32_16x16x32_bf16 v[60:63], v[92:95], v[152:155], 0
    v_mfma_f32_16x16x32_bf16 v[64:67], v[80:83], v[156:159], 0
    v_mfma_f32_16x16x32_bf16 v[68:71], v[84:87], v[156:159], 0
    v_mfma_f32_16x16x32_bf16 v[72:75], v[88:91], v[156:159], 0
    v_mfma_f32_16x16x32_bf16 v[76:79], v[92:95], v[156:159], 0
    s_add_u32 s29, s28, 4096
    buffer_load_dwordx4 v[144:147], v5, s[8:11], s29 offen
    s_add_u32 s29, s26, 4096
    buffer_load_dwordx4 v[80:83], v5, s[8:11], s29 offen
    s_add_u32 s29, s28, 61440
    buffer_load_dwordx4 v[148:151], v5, s[8:11], s29 offen
    s_add_u32 s29, s26, 61440
    buffer_load_dwordx4 v[84:87], v5, s[8:11], s29 offen
    s_add_u32 s29, s28, 118784
    buffer_load_dwordx4 v[152:155], v5, s[8:11], s29 offen
    s_add_u32 s29, s26, 118784
    buffer_load_dwordx4 v[88:91], v5, s[8:11], s29 offen
    s_add_u32 s29, s28, 176128
    buffer_load_dwordx4 v[156:159], v5, s[8:11], s29 offen
    s_add_u32 s29, s26, 176128
    buffer_load_dwordx4 v[92:95], v5, s[8:11], s29 offen
    s_waitcnt vmcnt(30)
    v_mfma_f32_16x16x32_bf16 v[16:19], v[96:99], v[160:163], v[16:19]
    s_waitcnt vmcnt(28)
    v_mfma_f32_16x16x32_bf16 v[20:23], v[100:103], v[160:163], v[20:23]
    s_waitcnt vmcnt(26)
    v_mfma_f32_16x16x32_bf16 v[24:27], v[104:107], v[160:163], v[24:27]
    s_waitcnt vmcnt(24)
    v_mfma_f32_16x16x32_bf16 v[28:31], v[108:111], v[160:163], v[28:31]
    v_mfma_f32_16x16x32_bf16 v[32:35], v[96:99], v[164:167], v[32:35]
    v_mfma_f32_16x16x32_bf16 v[36:39], v[100:103], v[164:167], v[36:39]
    v_mfma_f32_16x16x32_bf16 v[40:43], v[104:107], v[164:167], v[40:43]
    v_mfma_f32_16x16x32_bf16 v[44:47], v[108:111], v[164:167], v[44:47]
    v_mfma_f32_16x16x32_bf16 v[48:51], v[96:99], v[168:171], v[48:51]
    v_mfma_f32_16x16x32_bf16 v[52:55], v[100:103], v[168:171], v[52:55]
    v_mfma_f32_16x16x32_bf16 v[56:59], v[104:107], v[168:171], v[56:59]
    v_mfma_f32_16x16x32_bf16 v[60:63], v[108:111], v[168:171], v[60:63]
    v_mfma_f32_16x16x32_bf16 v[64:67], v[96:99], v[172:175], v[64:67]
    v_mfma_f32_16x16x32_bf16 v[68:71], v[100:103], v[172:175], v[68:71]
    v_mfma_f32_16x16x32_bf16 v[72:75], v[104:107], v[172:175], v[72:75]
    v_mfma_f32_16x16x32_bf16 v[76:79], v[108:111], v[172:175], v[76:79]
    s_add_u32 s29, s28, 5120
    buffer_load_dwordx4 v[160:163], v5, s[8:11], s29 offen
    s_add_u32 s29, s26, 5120
    buffer_load_dwordx4 v[96:99], v5, s[8:11], s29 offen
    s_add_u32 s29, s28, 62464
    buffer_load_dwordx4 v[164:167], v5, s[8:11], s29 offen
    s_add_u32 s29, s26, 62464
    buffer_load_dwordx4 v[100:103], v5, s[8:11], s29 offen
    s_add_u32 s29, s28, 119808
    buffer_load_dwordx4 v[168:171], v5, s[8:11], s29 offen
    s_add_u32 s29, s26, 119808
    buffer_load_dwordx4 v[104:107], v5, s[8:11], s29 offen
    s_add_u32 s29, s28, 177152
    buffer_load_dwordx4 v[172:175], v5, s[8:11], s29 offen
    s_add_u32 s29, s26, 177152
    buffer_load_dwordx4 v[108:111], v5, s[8:11], s29 offen
    s_waitcnt vmcnt(30)
    v_mfma_f32_16x16x32_bf16 v[16:19], v[112:115], v[176:179], v[16:19]
    s_waitcnt vmcnt(28)
    v_mfma_f32_16x16x32_bf16 v[20:23], v[116:119], v[176:179], v[20:23]
    s_waitcnt vmcnt(26)
    v_mfma_f32_16x16x32_bf16 v[24:27], v[120:123], v[176:179], v[24:27]
    s_waitcnt vmcnt(24)
    v_mfma_f32_16x16x32_bf16 v[28:31], v[124:127], v[176:179], v[28:31]
    v_mfma_f32_16x16x32_bf16 v[32:35], v[112:115], v[180:183], v[32:35]
    v_mfma_f32_16x16x32_bf16 v[36:39], v[116:119], v[180:183], v[36:39]
    v_mfma_f32_16x16x32_bf16 v[40:43], v[120:123], v[180:183], v[40:43]
    v_mfma_f32_16x16x32_bf16 v[44:47], v[124:127], v[180:183], v[44:47]
    v_mfma_f32_16x16x32_bf16 v[48:51], v[112:115], v[184:187], v[48:51]
    v_mfma_f32_16x16x32_bf16 v[52:55], v[116:119], v[184:187], v[52:55]
    v_mfma_f32_16x16x32_bf16 v[56:59], v[120:123], v[184:187], v[56:59]
    v_mfma_f32_16x16x32_bf16 v[60:63], v[124:127], v[184:187], v[60:63]
    v_mfma_f32_16x16x32_bf16 v[64:67], v[112:115], v[188:191], v[64:67]
    v_mfma_f32_16x16x32_bf16 v[68:71], v[116:119], v[188:191], v[68:71]
    v_mfma_f32_16x16x32_bf16 v[72:75], v[120:123], v[188:191], v[72:75]
    v_mfma_f32_16x16x32_bf16 v[76:79], v[124:127], v[188:191], v[76:79]
    s_add_u32 s29, s28, 6144
    buffer_load_dwordx4 v[176:179], v5, s[8:11], s29 offen
    s_add_u32 s29, s26, 6144
    buffer_load_dwordx4 v[112:115], v5, s[8:11], s29 offen
    s_add_u32 s29, s28, 63488
    buffer_load_dwordx4 v[180:183], v5, s[8:11], s29 offen
    s_add_u32 s29, s26, 63488
    buffer_load_dwordx4 v[116:119], v5, s[8:11], s29 offen
    s_add_u32 s29, s28, 120832
    buffer_load_dwordx4 v[184:187], v5, s[8:11], s29 offen
    s_add_u32 s29, s26, 120832
    buffer_load_dwordx4 v[120:123], v5, s[8:11], s29 offen
    s_add_u32 s29, s28, 178176
    buffer_load_dwordx4 v[188:191], v5, s[8:11], s29 offen
    s_add_u32 s29, s26, 178176
    buffer_load_dwordx4 v[124:127], v5, s[8:11], s29 offen
    s_waitcnt vmcnt(30)
    v_mfma_f32_16x16x32_bf16 v[16:19], v[128:131], v[192:195], v[16:19]
    s_waitcnt vmcnt(28)
    v_mfma_f32_16x16x32_bf16 v[20:23], v[132:135], v[192:195], v[20:23]
    s_waitcnt vmcnt(26)
    v_mfma_f32_16x16x32_bf16 v[24:27], v[136:139], v[192:195], v[24:27]
    s_waitcnt vmcnt(24)
    v_mfma_f32_16x16x32_bf16 v[28:31], v[140:143], v[192:195], v[28:31]
    v_mfma_f32_16x16x32_bf16 v[32:35], v[128:131], v[196:199], v[32:35]
    v_mfma_f32_16x16x32_bf16 v[36:39], v[132:135], v[196:199], v[36:39]
    v_mfma_f32_16x16x32_bf16 v[40:43], v[136:139], v[196:199], v[40:43]
    v_mfma_f32_16x16x32_bf16 v[44:47], v[140:143], v[196:199], v[44:47]
    v_mfma_f32_16x16x32_bf16 v[48:51], v[128:131], v[200:203], v[48:51]
    v_mfma_f32_16x16x32_bf16 v[52:55], v[132:135], v[200:203], v[52:55]
    v_mfma_f32_16x16x32_bf16 v[56:59], v[136:139], v[200:203], v[56:59]
    v_mfma_f32_16x16x32_bf16 v[60:63], v[140:143], v[200:203], v[60:63]
    v_mfma_f32_16x16x32_bf16 v[64:67], v[128:131], v[204:207], v[64:67]
    v_mfma_f32_16x16x32_bf16 v[68:71], v[132:135], v[204:207], v[68:71]
    v_mfma_f32_16x16x32_bf16 v[72:75], v[136:139], v[204:207], v[72:75]
    v_mfma_f32_16x16x32_bf16 v[76:79], v[140:143], v[204:207], v[76:79]
    s_waitcnt vmcnt(22)
    v_mfma_f32_16x16x32_bf16 v[16:19], v[80:83], v[144:147], v[16:19]
    s_waitcnt vmcnt(20)
    v_mfma_f32_16x16x32_bf16 v[20:23], v[84:87], v[144:147], v[20:23]
    s_waitcnt vmcnt(18)
    v_mfma_f32_16x16x32_bf16 v[24:27], v[88:91], v[144:147], v[24:27]
    s_waitcnt vmcnt(16)
    v_mfma_f32_16x16x32_bf16 v[28:31], v[92:95], v[144:147], v[28:31]
    v_mfma_f32_16x16x32_bf16 v[32:35], v[80:83], v[148:151], v[32:35]
    v_mfma_f32_16x16x32_bf16 v[36:39], v[84:87], v[148:151], v[36:39]
    v_mfma_f32_16x16x32_bf16 v[40:43], v[88:91], v[148:151], v[40:43]
    v_mfma_f32_16x16x32_bf16 v[44:47], v[92:95], v[148:151], v[44:47]
    v_mfma_f32_16x16x32_bf16 v[48:51], v[80:83], v[152:155], v[48:51]
    v_mfma_f32_16x16x32_bf16 v[52:55], v[84:87], v[152:155], v[52:55]
    v_mfma_f32_16x16x32_bf16 v[56:59], v[88:91], v[152:155], v[56:59]
    v_mfma_f32_16x16x32_bf16 v[60:63], v[92:95], v[152:155], v[60:63]
    v_mfma_f32_16x16x32_bf16 v[64:67], v[80:83], v[156:159], v[64:67]
    v_mfma_f32_16x16x32_bf16 v[68:71], v[84:87], v[156:159], v[68:71]
    v_mfma_f32_16x16x32_bf16 v[72:75], v[88:91], v[156:159], v[72:75]
    v_mfma_f32_16x16x32_bf16 v[76:79], v[92:95], v[156:159], v[76:79]
    s_waitcnt vmcnt(14)
    v_mfma_f32_16x16x32_bf16 v[16:19], v[96:99], v[160:163], v[16:19]
    s_waitcnt vmcnt(12)
    v_mfma_f32_16x16x32_bf16 v[20:23], v[100:103], v[160:163], v[20:23]
    s_waitcnt vmcnt(10)
    v_mfma_f32_16x16x32_bf16 v[24:27], v[104:107], v[160:163], v[24:27]
    s_waitcnt vmcnt(8)
    v_mfma_f32_16x16x32_bf16 v[28:31], v[108:111], v[160:163], v[28:31]
    v_mfma_f32_16x16x32_bf16 v[32:35], v[96:99], v[164:167], v[32:35]
    v_mfma_f32_16x16x32_bf16 v[36:39], v[100:103], v[164:167], v[36:39]
    v_mfma_f32_16x16x32_bf16 v[40:43], v[104:107], v[164:167], v[40:43]
    v_mfma_f32_16x16x32_bf16 v[44:47], v[108:111], v[164:167], v[44:47]
    v_mfma_f32_16x16x32_bf16 v[48:51], v[96:99], v[168:171], v[48:51]
    v_mfma_f32_16x16x32_bf16 v[52:55], v[100:103], v[168:171], v[52:55]
    v_mfma_f32_16x16x32_bf16 v[56:59], v[104:107], v[168:171], v[56:59]
    v_mfma_f32_16x16x32_bf16 v[60:63], v[108:111], v[168:171], v[60:63]
    v_mfma_f32_16x16x32_bf16 v[64:67], v[96:99], v[172:175], v[64:67]
    v_mfma_f32_16x16x32_bf16 v[68:71], v[100:103], v[172:175], v[68:71]
    v_mfma_f32_16x16x32_bf16 v[72:75], v[104:107], v[172:175], v[72:75]
    v_mfma_f32_16x16x32_bf16 v[76:79], v[108:111], v[172:175], v[76:79]
    s_waitcnt vmcnt(6)
    v_mfma_f32_16x16x32_bf16 v[16:19], v[112:115], v[176:179], v[16:19]
    s_waitcnt vmcnt(4)
    v_mfma_f32_16x16x32_bf16 v[20:23], v[116:119], v[176:179], v[20:23]
    s_waitcnt vmcnt(2)
    v_mfma_f32_16x16x32_bf16 v[24:27], v[120:123], v[176:179], v[24:27]
    s_waitcnt vmcnt(0)
    v_mfma_f32_16x16x32_bf16 v[28:31], v[124:127], v[176:179], v[28:31]
    v_mfma_f32_16x16x32_bf16 v[32:35], v[112:115], v[180:183], v[32:35]
    v_mfma_f32_16x16x32_bf16 v[36:39], v[116:119], v[180:183], v[36:39]
    v_mfma_f32_16x16x32_bf16 v[40:43], v[120:123], v[180:183], v[40:43]
    v_mfma_f32_16x16x32_bf16 v[44:47], v[124:127], v[180:183], v[44:47]
    v_mfma_f32_16x16x32_bf16 v[48:51], v[112:115], v[184:187], v[48:51]
    v_mfma_f32_16x16x32_bf16 v[52:55], v[116:119], v[184:187], v[52:55]
    v_mfma_f32_16x16x32_bf16 v[56:59], v[120:123], v[184:187], v[56:59]
    v_mfma_f32_16x16x32_bf16 v[60:63], v[124:127], v[184:187], v[60:63]
    v_mfma_f32_16x16x32_bf16 v[64:67], v[112:115], v[188:191], v[64:67]
    v_mfma_f32_16x16x32_bf16 v[68:71], v[116:119], v[188:191], v[68:71]
    v_mfma_f32_16x16x32_bf16 v[72:75], v[120:123], v[188:191], v[72:75]
    v_mfma_f32_16x16x32_bf16 v[76:79], v[124:127], v[188:191], v[76:79]
    s_nop 7
    s_nop 7
    s_lshr_b32 s26, s20, 1
    s_and_b32 s27, s20, 1
    s_lshl_b32 s28, s21, 2
    s_add_u32 s28, s28, s26
    s_lshl_b32 s29, s22, 1
    s_add_u32 s29, s29, s27
    s_mul_i32 s30, s28, 14336
    s_lshl_b32 s31, s29, 10
    s_add_u32 s30, s30, s31
    s_add_u32 s31, s30, 2097152
    buffer_load_dwordx4 v[200:203], v5, s[8:11], s31 offen
    v_lshlrev_b32 v6, 3, v4
    s_lshl_b32 s31, s29, 6
    buffer_load_dwordx2 v[204:205], v6, s[12:15], s31 offen
    buffer_load_dwordx2 v[206:207], v6, s[12:15], s31 offen offset:32
    s_lshl_b32 s31, s20, 14
    v_add_u32 v9, s31, v5
    ds_write_b128 v9, v[16:19] offset:0
    ds_write_b128 v9, v[20:23] offset:1024
    ds_write_b128 v9, v[24:27] offset:2048
    ds_write_b128 v9, v[28:31] offset:3072
    ds_write_b128 v9, v[32:35] offset:4096
    ds_write_b128 v9, v[36:39] offset:5120
    ds_write_b128 v9, v[40:43] offset:6144
    ds_write_b128 v9, v[44:47] offset:7168
    ds_write_b128 v9, v[48:51] offset:8192
    ds_write_b128 v9, v[52:55] offset:9216
    ds_write_b128 v9, v[56:59] offset:10240
    ds_write_b128 v9, v[60:63] offset:11264
    ds_write_b128 v9, v[64:67] offset:12288
    ds_write_b128 v9, v[68:71] offset:13312
    ds_write_b128 v9, v[72:75] offset:14336
    ds_write_b128 v9, v[76:79] offset:15360
    s_waitcnt lgkmcnt(0)
    s_barrier
    s_lshl_b32 s31, s26, 12
    s_lshl_b32 s26, s27, 11
    s_add_u32 s31, s31, s26
    v_add_u32 v9, s31, v5
    v_add_u32 v10, 65536, v9
    ds_read_b128 v[16:19], v9 offset:0
    ds_read_b128 v[20:23], v9 offset:1024
    ds_read_b128 v[24:27], v9 offset:16384
    ds_read_b128 v[28:31], v9 offset:17408
    ds_read_b128 v[32:35], v9 offset:32768
    ds_read_b128 v[36:39], v9 offset:33792
    ds_read_b128 v[40:43], v9 offset:49152
    ds_read_b128 v[44:47], v9 offset:50176
    ds_read_b128 v[48:51], v10 offset:0
    ds_read_b128 v[52:55], v10 offset:1024
    ds_read_b128 v[56:59], v10 offset:16384
    ds_read_b128 v[60:63], v10 offset:17408
    ds_read_b128 v[64:67], v10 offset:32768
    ds_read_b128 v[68:71], v10 offset:33792
    ds_read_b128 v[72:75], v10 offset:49152
    ds_read_b128 v[76:79], v10 offset:50176
    s_waitcnt lgkmcnt(13)
    v_add_f32 v16, v16, v24
    v_add_f32 v17, v17, v25
    v_add_f32 v18, v18, v26
    v_add_f32 v19, v19, v27
    s_waitcnt lgkmcnt(12)
    v_add_f32 v20, v20, v28
    v_add_f32 v21, v21, v29
    v_add_f32 v22, v22, v30
    v_add_f32 v23, v23, v31
    s_waitcnt lgkmcnt(11)
    v_add_f32 v16, v16, v32
    v_add_f32 v17, v17, v33
    v_add_f32 v18, v18, v34
    v_add_f32 v19, v19, v35
    s_waitcnt lgkmcnt(10)
    v_add_f32 v20, v20, v36
    v_add_f32 v21, v21, v37
    v_add_f32 v22, v22, v38
    v_add_f32 v23, v23, v39
    s_waitcnt lgkmcnt(9)
    v_add_f32 v16, v16, v40
    v_add_f32 v17, v17, v41
    v_add_f32 v18, v18, v42
    v_add_f32 v19, v19, v43
    s_waitcnt lgkmcnt(8)
    v_add_f32 v20, v20, v44
    v_add_f32 v21, v21, v45
    v_add_f32 v22, v22, v46
    v_add_f32 v23, v23, v47
    s_waitcnt lgkmcnt(7)
    v_add_f32 v16, v16, v48
    v_add_f32 v17, v17, v49
    v_add_f32 v18, v18, v50
    v_add_f32 v19, v19, v51
    s_waitcnt lgkmcnt(6)
    v_add_f32 v20, v20, v52
    v_add_f32 v21, v21, v53
    v_add_f32 v22, v22, v54
    v_add_f32 v23, v23, v55
    s_waitcnt lgkmcnt(5)
    v_add_f32 v16, v16, v56
    v_add_f32 v17, v17, v57
    v_add_f32 v18, v18, v58
    v_add_f32 v19, v19, v59
    s_waitcnt lgkmcnt(4)
    v_add_f32 v20, v20, v60
    v_add_f32 v21, v21, v61
    v_add_f32 v22, v22, v62
    v_add_f32 v23, v23, v63
    s_waitcnt lgkmcnt(3)
    v_add_f32 v16, v16, v64
    v_add_f32 v17, v17, v65
    v_add_f32 v18, v18, v66
    v_add_f32 v19, v19, v67
    s_waitcnt lgkmcnt(2)
    v_add_f32 v20, v20, v68
    v_add_f32 v21, v21, v69
    v_add_f32 v22, v22, v70
    v_add_f32 v23, v23, v71
    s_waitcnt lgkmcnt(1)
    v_add_f32 v16, v16, v72
    v_add_f32 v17, v17, v73
    v_add_f32 v18, v18, v74
    v_add_f32 v19, v19, v75
    s_waitcnt lgkmcnt(0)
    v_add_f32 v20, v20, v76
    v_add_f32 v21, v21, v77
    v_add_f32 v22, v22, v78
    v_add_f32 v23, v23, v79
    v_cvt_pk_bf16_f32 v24, v16, v17
    v_cvt_pk_bf16_f32 v25, v18, v19
    v_cvt_pk_bf16_f32 v26, v20, v21
    v_cvt_pk_bf16_f32 v27, v22, v23
    v_lshlrev_b32 v16, 16, v24
    v_and_b32 v17, 4294901760, v24
    v_lshlrev_b32 v18, 16, v25
    v_and_b32 v19, 4294901760, v25
    v_lshlrev_b32 v20, 16, v26
    v_and_b32 v21, 4294901760, v26
    v_lshlrev_b32 v22, 16, v27
    v_and_b32 v23, 4294901760, v27
    s_waitcnt vmcnt(1)
    v_lshlrev_b32 v24, 16, v204
    v_and_b32 v25, 4294901760, v204
    v_lshlrev_b32 v26, 16, v205
    v_and_b32 v27, 4294901760, v205
    s_waitcnt vmcnt(0)
    v_lshlrev_b32 v28, 16, v206
    v_and_b32 v29, 4294901760, v206
    v_lshlrev_b32 v30, 16, v207
    v_and_b32 v31, 4294901760, v207
    v_add_f32 v16, v16, v24
    v_add_f32 v17, v17, v25
    v_add_f32 v18, v18, v26
    v_add_f32 v19, v19, v27
    v_add_f32 v20, v20, v28
    v_add_f32 v21, v21, v29
    v_add_f32 v22, v22, v30
    v_add_f32 v23, v23, v31
    v_cvt_pk_bf16_f32 v24, v16, v17
    v_cvt_pk_bf16_f32 v25, v18, v19
    v_cvt_pk_bf16_f32 v26, v20, v21
    v_cvt_pk_bf16_f32 v27, v22, v23
    v_lshlrev_b32 v16, 16, v24
    v_and_b32 v17, 4294901760, v24
    v_lshlrev_b32 v18, 16, v25
    v_and_b32 v19, 4294901760, v25
    v_lshlrev_b32 v20, 16, v26
    v_and_b32 v21, 4294901760, v26
    v_lshlrev_b32 v22, 16, v27
    v_and_b32 v23, 4294901760, v27
    v_lshlrev_b32 v24, 16, v200
    v_and_b32 v25, 4294901760, v200
    v_lshlrev_b32 v26, 16, v201
    v_and_b32 v27, 4294901760, v201
    v_lshlrev_b32 v28, 16, v202
    v_and_b32 v29, 4294901760, v202
    v_lshlrev_b32 v30, 16, v203
    v_and_b32 v31, 4294901760, v203
    v_add_f32 v16, v16, v24
    v_add_f32 v17, v17, v25
    v_add_f32 v18, v18, v26
    v_add_f32 v19, v19, v27
    v_add_f32 v20, v20, v28
    v_add_f32 v21, v21, v29
    v_add_f32 v22, v22, v30
    v_add_f32 v23, v23, v31
    v_cvt_pk_bf16_f32 v32, v16, v17
    v_cvt_pk_bf16_f32 v33, v18, v19
    v_cvt_pk_bf16_f32 v34, v20, v21
    v_cvt_pk_bf16_f32 v35, v22, v23
    s_add_u32 s31, s30, 4194304
    buffer_store_dwordx4 v[32:35], v5, s[8:11], s31 offen
    s_branch L_end_k4a_kernel
    s_nop 4
L_prep_k4a_kernel:
    s_load_dwordx2 s[16:17], s[0:1], 8
    s_load_dwordx2 s[24:25], s[0:1], 16
    s_waitcnt lgkmcnt(0)
    s_and_b32 s17, s17, 65535
    s_mov_b32 s18, 1204224
    s_mov_b32 s19, 131072
    s_and_b32 s25, s25, 65535
    s_mov_b32 s26, 25088
    s_mov_b32 s27, 131072
    s_sub_u32 s21, s2, 224
    s_lshl_b32 s21, s21, 3
    s_add_u32 s21, s21, s20
    s_cmp_lt_u32 s21, 96
    s_cbranch_scc1 L_p_wqkv_k4a_kernel
    s_cmp_lt_u32 s21, 98
    s_cbranch_scc1 L_p_wphi_k4a_kernel
    s_branch L_end_k4a_kernel
    s_nop 4
L_p_wqkv_k4a_kernel:
    s_mul_i32 s40, s21, 43
    s_lshr_b32 s40, s40, 8
    s_mul_i32 s41, s40, 6
    s_sub_u32 s41, s21, s41
    s_lshr_b32 s42, s41, 1
    s_and_b32 s43, s41, 1
    s_mul_i32 s44, s42, 448
    s_mul_i32 s45, s40, 28
    s_add_u32 s44, s44, s45
    s_lshl_b32 s45, s43, 4
    s_add_u32 s44, s44, s45
    s_lshl_b32 s22, s44, 1
    v_add_u32 v6, s45, v3
    v_cmp_gt_u32 vcc, 28, v6
    s_mov_b32 s46, 10752
    v_mul_lo_u32 v8, s46, v4
    v_lshl_add_u32 v8, v3, 1, v8
    v_mov_b32 v7, 1073741824
    v_cndmask_b32 v8, v7, v8, vcc
    v_add_u32 v9, 43008, v8
    s_mul_i32 s47, s40, 86016
    s_lshl_b32 s46, s41, 10
    s_add_u32 s47, s47, s46
    s_add_u32 s23, s22, 0
    buffer_load_ushort v96, v8, s[16:19], s23 offen
    s_add_u32 s23, s22, 2688
    buffer_load_ushort v97, v8, s[16:19], s23 offen
    s_add_u32 s23, s22, 5376
    buffer_load_ushort v98, v8, s[16:19], s23 offen
    s_add_u32 s23, s22, 8064
    buffer_load_ushort v99, v8, s[16:19], s23 offen
    s_add_u32 s23, s22, 0
    buffer_load_ushort v100, v9, s[16:19], s23 offen
    s_add_u32 s23, s22, 2688
    buffer_load_ushort v101, v9, s[16:19], s23 offen
    s_add_u32 s23, s22, 5376
    buffer_load_ushort v102, v9, s[16:19], s23 offen
    s_add_u32 s23, s22, 8064
    buffer_load_ushort v103, v9, s[16:19], s23 offen
    s_add_u32 s23, s22, 86016
    buffer_load_ushort v104, v8, s[16:19], s23 offen
    s_add_u32 s23, s22, 88704
    buffer_load_ushort v105, v8, s[16:19], s23 offen
    s_add_u32 s23, s22, 91392
    buffer_load_ushort v106, v8, s[16:19], s23 offen
    s_add_u32 s23, s22, 94080
    buffer_load_ushort v107, v8, s[16:19], s23 offen
    s_add_u32 s23, s22, 86016
    buffer_load_ushort v108, v9, s[16:19], s23 offen
    s_add_u32 s23, s22, 88704
    buffer_load_ushort v109, v9, s[16:19], s23 offen
    s_add_u32 s23, s22, 91392
    buffer_load_ushort v110, v9, s[16:19], s23 offen
    s_add_u32 s23, s22, 94080
    buffer_load_ushort v111, v9, s[16:19], s23 offen
    s_add_u32 s23, s22, 172032
    buffer_load_ushort v112, v8, s[16:19], s23 offen
    s_add_u32 s23, s22, 174720
    buffer_load_ushort v113, v8, s[16:19], s23 offen
    s_add_u32 s23, s22, 177408
    buffer_load_ushort v114, v8, s[16:19], s23 offen
    s_add_u32 s23, s22, 180096
    buffer_load_ushort v115, v8, s[16:19], s23 offen
    s_add_u32 s23, s22, 172032
    buffer_load_ushort v116, v9, s[16:19], s23 offen
    s_add_u32 s23, s22, 174720
    buffer_load_ushort v117, v9, s[16:19], s23 offen
    s_add_u32 s23, s22, 177408
    buffer_load_ushort v118, v9, s[16:19], s23 offen
    s_add_u32 s23, s22, 180096
    buffer_load_ushort v119, v9, s[16:19], s23 offen
    s_add_u32 s23, s22, 258048
    buffer_load_ushort v120, v8, s[16:19], s23 offen
    s_add_u32 s23, s22, 260736
    buffer_load_ushort v121, v8, s[16:19], s23 offen
    s_add_u32 s23, s22, 263424
    buffer_load_ushort v122, v8, s[16:19], s23 offen
    s_add_u32 s23, s22, 266112
    buffer_load_ushort v123, v8, s[16:19], s23 offen
    s_add_u32 s23, s22, 258048
    buffer_load_ushort v124, v9, s[16:19], s23 offen
    s_add_u32 s23, s22, 260736
    buffer_load_ushort v125, v9, s[16:19], s23 offen
    s_add_u32 s23, s22, 263424
    buffer_load_ushort v126, v9, s[16:19], s23 offen
    s_add_u32 s23, s22, 266112
    buffer_load_ushort v127, v9, s[16:19], s23 offen
    s_add_u32 s23, s22, 344064
    buffer_load_ushort v128, v8, s[16:19], s23 offen
    s_add_u32 s23, s22, 346752
    buffer_load_ushort v129, v8, s[16:19], s23 offen
    s_add_u32 s23, s22, 349440
    buffer_load_ushort v130, v8, s[16:19], s23 offen
    s_add_u32 s23, s22, 352128
    buffer_load_ushort v131, v8, s[16:19], s23 offen
    s_add_u32 s23, s22, 344064
    buffer_load_ushort v132, v9, s[16:19], s23 offen
    s_add_u32 s23, s22, 346752
    buffer_load_ushort v133, v9, s[16:19], s23 offen
    s_add_u32 s23, s22, 349440
    buffer_load_ushort v134, v9, s[16:19], s23 offen
    s_add_u32 s23, s22, 352128
    buffer_load_ushort v135, v9, s[16:19], s23 offen
    s_add_u32 s23, s22, 430080
    buffer_load_ushort v136, v8, s[16:19], s23 offen
    s_add_u32 s23, s22, 432768
    buffer_load_ushort v137, v8, s[16:19], s23 offen
    s_add_u32 s23, s22, 435456
    buffer_load_ushort v138, v8, s[16:19], s23 offen
    s_add_u32 s23, s22, 438144
    buffer_load_ushort v139, v8, s[16:19], s23 offen
    s_add_u32 s23, s22, 430080
    buffer_load_ushort v140, v9, s[16:19], s23 offen
    s_add_u32 s23, s22, 432768
    buffer_load_ushort v141, v9, s[16:19], s23 offen
    s_add_u32 s23, s22, 435456
    buffer_load_ushort v142, v9, s[16:19], s23 offen
    s_add_u32 s23, s22, 438144
    buffer_load_ushort v143, v9, s[16:19], s23 offen
    s_add_u32 s23, s22, 516096
    buffer_load_ushort v144, v8, s[16:19], s23 offen
    s_add_u32 s23, s22, 518784
    buffer_load_ushort v145, v8, s[16:19], s23 offen
    s_add_u32 s23, s22, 521472
    buffer_load_ushort v146, v8, s[16:19], s23 offen
    s_add_u32 s23, s22, 524160
    buffer_load_ushort v147, v8, s[16:19], s23 offen
    s_add_u32 s23, s22, 516096
    buffer_load_ushort v148, v9, s[16:19], s23 offen
    s_add_u32 s23, s22, 518784
    buffer_load_ushort v149, v9, s[16:19], s23 offen
    s_add_u32 s23, s22, 521472
    buffer_load_ushort v150, v9, s[16:19], s23 offen
    s_add_u32 s23, s22, 524160
    buffer_load_ushort v151, v9, s[16:19], s23 offen
    s_add_u32 s23, s22, 602112
    buffer_load_ushort v152, v8, s[16:19], s23 offen
    s_add_u32 s23, s22, 604800
    buffer_load_ushort v153, v8, s[16:19], s23 offen
    s_add_u32 s23, s22, 607488
    buffer_load_ushort v154, v8, s[16:19], s23 offen
    s_add_u32 s23, s22, 610176
    buffer_load_ushort v155, v8, s[16:19], s23 offen
    s_add_u32 s23, s22, 602112
    buffer_load_ushort v156, v9, s[16:19], s23 offen
    s_add_u32 s23, s22, 604800
    buffer_load_ushort v157, v9, s[16:19], s23 offen
    s_add_u32 s23, s22, 607488
    buffer_load_ushort v158, v9, s[16:19], s23 offen
    s_add_u32 s23, s22, 610176
    buffer_load_ushort v159, v9, s[16:19], s23 offen
    s_add_u32 s23, s22, 688128
    buffer_load_ushort v160, v8, s[16:19], s23 offen
    s_add_u32 s23, s22, 690816
    buffer_load_ushort v161, v8, s[16:19], s23 offen
    s_add_u32 s23, s22, 693504
    buffer_load_ushort v162, v8, s[16:19], s23 offen
    s_add_u32 s23, s22, 696192
    buffer_load_ushort v163, v8, s[16:19], s23 offen
    s_add_u32 s23, s22, 688128
    buffer_load_ushort v164, v9, s[16:19], s23 offen
    s_add_u32 s23, s22, 690816
    buffer_load_ushort v165, v9, s[16:19], s23 offen
    s_add_u32 s23, s22, 693504
    buffer_load_ushort v166, v9, s[16:19], s23 offen
    s_add_u32 s23, s22, 696192
    buffer_load_ushort v167, v9, s[16:19], s23 offen
    s_add_u32 s23, s22, 774144
    buffer_load_ushort v168, v8, s[16:19], s23 offen
    s_add_u32 s23, s22, 776832
    buffer_load_ushort v169, v8, s[16:19], s23 offen
    s_add_u32 s23, s22, 779520
    buffer_load_ushort v170, v8, s[16:19], s23 offen
    s_add_u32 s23, s22, 782208
    buffer_load_ushort v171, v8, s[16:19], s23 offen
    s_add_u32 s23, s22, 774144
    buffer_load_ushort v172, v9, s[16:19], s23 offen
    s_add_u32 s23, s22, 776832
    buffer_load_ushort v173, v9, s[16:19], s23 offen
    s_add_u32 s23, s22, 779520
    buffer_load_ushort v174, v9, s[16:19], s23 offen
    s_add_u32 s23, s22, 782208
    buffer_load_ushort v175, v9, s[16:19], s23 offen
    s_add_u32 s23, s22, 860160
    buffer_load_ushort v176, v8, s[16:19], s23 offen
    s_add_u32 s23, s22, 862848
    buffer_load_ushort v177, v8, s[16:19], s23 offen
    s_add_u32 s23, s22, 865536
    buffer_load_ushort v178, v8, s[16:19], s23 offen
    s_add_u32 s23, s22, 868224
    buffer_load_ushort v179, v8, s[16:19], s23 offen
    s_add_u32 s23, s22, 860160
    buffer_load_ushort v180, v9, s[16:19], s23 offen
    s_add_u32 s23, s22, 862848
    buffer_load_ushort v181, v9, s[16:19], s23 offen
    s_add_u32 s23, s22, 865536
    buffer_load_ushort v182, v9, s[16:19], s23 offen
    s_add_u32 s23, s22, 868224
    buffer_load_ushort v183, v9, s[16:19], s23 offen
    s_add_u32 s23, s22, 946176
    buffer_load_ushort v184, v8, s[16:19], s23 offen
    s_add_u32 s23, s22, 948864
    buffer_load_ushort v185, v8, s[16:19], s23 offen
    s_add_u32 s23, s22, 951552
    buffer_load_ushort v186, v8, s[16:19], s23 offen
    s_add_u32 s23, s22, 954240
    buffer_load_ushort v187, v8, s[16:19], s23 offen
    s_add_u32 s23, s22, 946176
    buffer_load_ushort v188, v9, s[16:19], s23 offen
    s_add_u32 s23, s22, 948864
    buffer_load_ushort v189, v9, s[16:19], s23 offen
    s_add_u32 s23, s22, 951552
    buffer_load_ushort v190, v9, s[16:19], s23 offen
    s_add_u32 s23, s22, 954240
    buffer_load_ushort v191, v9, s[16:19], s23 offen
    s_add_u32 s23, s22, 1032192
    buffer_load_ushort v192, v8, s[16:19], s23 offen
    s_add_u32 s23, s22, 1034880
    buffer_load_ushort v193, v8, s[16:19], s23 offen
    s_add_u32 s23, s22, 1037568
    buffer_load_ushort v194, v8, s[16:19], s23 offen
    s_add_u32 s23, s22, 1040256
    buffer_load_ushort v195, v8, s[16:19], s23 offen
    s_add_u32 s23, s22, 1032192
    buffer_load_ushort v196, v9, s[16:19], s23 offen
    s_add_u32 s23, s22, 1034880
    buffer_load_ushort v197, v9, s[16:19], s23 offen
    s_add_u32 s23, s22, 1037568
    buffer_load_ushort v198, v9, s[16:19], s23 offen
    s_add_u32 s23, s22, 1040256
    buffer_load_ushort v199, v9, s[16:19], s23 offen
    s_add_u32 s23, s22, 1118208
    buffer_load_ushort v200, v8, s[16:19], s23 offen
    s_add_u32 s23, s22, 1120896
    buffer_load_ushort v201, v8, s[16:19], s23 offen
    s_add_u32 s23, s22, 1123584
    buffer_load_ushort v202, v8, s[16:19], s23 offen
    s_add_u32 s23, s22, 1126272
    buffer_load_ushort v203, v8, s[16:19], s23 offen
    s_add_u32 s23, s22, 1118208
    buffer_load_ushort v204, v9, s[16:19], s23 offen
    s_add_u32 s23, s22, 1120896
    buffer_load_ushort v205, v9, s[16:19], s23 offen
    s_add_u32 s23, s22, 1123584
    buffer_load_ushort v206, v9, s[16:19], s23 offen
    s_add_u32 s23, s22, 1126272
    buffer_load_ushort v207, v9, s[16:19], s23 offen
    s_waitcnt vmcnt(63)
    v_lshl_or_b32 v16, v97, 16, v96
    v_lshl_or_b32 v17, v99, 16, v98
    v_lshl_or_b32 v18, v101, 16, v100
    v_lshl_or_b32 v19, v103, 16, v102
    v_lshl_or_b32 v20, v105, 16, v104
    v_lshl_or_b32 v21, v107, 16, v106
    v_lshl_or_b32 v22, v109, 16, v108
    v_lshl_or_b32 v23, v111, 16, v110
    v_lshl_or_b32 v24, v113, 16, v112
    v_lshl_or_b32 v25, v115, 16, v114
    v_lshl_or_b32 v26, v117, 16, v116
    v_lshl_or_b32 v27, v119, 16, v118
    v_lshl_or_b32 v28, v121, 16, v120
    v_lshl_or_b32 v29, v123, 16, v122
    v_lshl_or_b32 v30, v125, 16, v124
    v_lshl_or_b32 v31, v127, 16, v126
    v_lshl_or_b32 v32, v129, 16, v128
    v_lshl_or_b32 v33, v131, 16, v130
    v_lshl_or_b32 v34, v133, 16, v132
    v_lshl_or_b32 v35, v135, 16, v134
    v_lshl_or_b32 v36, v137, 16, v136
    v_lshl_or_b32 v37, v139, 16, v138
    v_lshl_or_b32 v38, v141, 16, v140
    v_lshl_or_b32 v39, v143, 16, v142
    s_waitcnt vmcnt(62)
    v_lshl_or_b32 v40, v145, 16, v144
    s_waitcnt vmcnt(60)
    v_lshl_or_b32 v41, v147, 16, v146
    s_waitcnt vmcnt(58)
    v_lshl_or_b32 v42, v149, 16, v148
    s_waitcnt vmcnt(56)
    v_lshl_or_b32 v43, v151, 16, v150
    s_waitcnt vmcnt(54)
    v_lshl_or_b32 v44, v153, 16, v152
    s_waitcnt vmcnt(52)
    v_lshl_or_b32 v45, v155, 16, v154
    s_waitcnt vmcnt(50)
    v_lshl_or_b32 v46, v157, 16, v156
    s_waitcnt vmcnt(48)
    v_lshl_or_b32 v47, v159, 16, v158
    s_waitcnt vmcnt(46)
    v_lshl_or_b32 v48, v161, 16, v160
    s_waitcnt vmcnt(44)
    v_lshl_or_b32 v49, v163, 16, v162
    s_waitcnt vmcnt(42)
    v_lshl_or_b32 v50, v165, 16, v164
    s_waitcnt vmcnt(40)
    v_lshl_or_b32 v51, v167, 16, v166
    s_waitcnt vmcnt(38)
    v_lshl_or_b32 v52, v169, 16, v168
    s_waitcnt vmcnt(36)
    v_lshl_or_b32 v53, v171, 16, v170
    s_waitcnt vmcnt(34)
    v_lshl_or_b32 v54, v173, 16, v172
    s_waitcnt vmcnt(32)
    v_lshl_or_b32 v55, v175, 16, v174
    s_waitcnt vmcnt(30)
    v_lshl_or_b32 v56, v177, 16, v176
    s_waitcnt vmcnt(28)
    v_lshl_or_b32 v57, v179, 16, v178
    s_waitcnt vmcnt(26)
    v_lshl_or_b32 v58, v181, 16, v180
    s_waitcnt vmcnt(24)
    v_lshl_or_b32 v59, v183, 16, v182
    s_waitcnt vmcnt(22)
    v_lshl_or_b32 v60, v185, 16, v184
    s_waitcnt vmcnt(20)
    v_lshl_or_b32 v61, v187, 16, v186
    s_waitcnt vmcnt(18)
    v_lshl_or_b32 v62, v189, 16, v188
    s_waitcnt vmcnt(16)
    v_lshl_or_b32 v63, v191, 16, v190
    s_waitcnt vmcnt(14)
    v_lshl_or_b32 v64, v193, 16, v192
    s_waitcnt vmcnt(12)
    v_lshl_or_b32 v65, v195, 16, v194
    s_waitcnt vmcnt(10)
    v_lshl_or_b32 v66, v197, 16, v196
    s_waitcnt vmcnt(8)
    v_lshl_or_b32 v67, v199, 16, v198
    s_waitcnt vmcnt(6)
    v_lshl_or_b32 v68, v201, 16, v200
    s_waitcnt vmcnt(4)
    v_lshl_or_b32 v69, v203, 16, v202
    s_waitcnt vmcnt(2)
    v_lshl_or_b32 v70, v205, 16, v204
    s_waitcnt vmcnt(0)
    v_lshl_or_b32 v71, v207, 16, v206
    s_add_u32 s23, s47, 22020096
    v_mov_b32 v10, 0
    buffer_store_dwordx4 v[16:19], v5, s[8:11], s23 offen
    v_lshlrev_b32 v11, 16, v16
    v_and_b32 v12, 4294901760, v16
    v_add_f32 v10, v10, v11
    v_add_f32 v10, v10, v12
    v_lshlrev_b32 v11, 16, v17
    v_and_b32 v12, 4294901760, v17
    v_add_f32 v10, v10, v11
    v_add_f32 v10, v10, v12
    v_lshlrev_b32 v11, 16, v18
    v_and_b32 v12, 4294901760, v18
    v_add_f32 v10, v10, v11
    v_add_f32 v10, v10, v12
    v_lshlrev_b32 v11, 16, v19
    v_and_b32 v12, 4294901760, v19
    v_add_f32 v10, v10, v11
    v_add_f32 v10, v10, v12
    s_add_u32 s23, s23, 6144
    buffer_store_dwordx4 v[20:23], v5, s[8:11], s23 offen
    v_lshlrev_b32 v11, 16, v20
    v_and_b32 v12, 4294901760, v20
    v_add_f32 v10, v10, v11
    v_add_f32 v10, v10, v12
    v_lshlrev_b32 v11, 16, v21
    v_and_b32 v12, 4294901760, v21
    v_add_f32 v10, v10, v11
    v_add_f32 v10, v10, v12
    v_lshlrev_b32 v11, 16, v22
    v_and_b32 v12, 4294901760, v22
    v_add_f32 v10, v10, v11
    v_add_f32 v10, v10, v12
    v_lshlrev_b32 v11, 16, v23
    v_and_b32 v12, 4294901760, v23
    v_add_f32 v10, v10, v11
    v_add_f32 v10, v10, v12
    s_add_u32 s23, s23, 6144
    buffer_store_dwordx4 v[24:27], v5, s[8:11], s23 offen
    v_lshlrev_b32 v11, 16, v24
    v_and_b32 v12, 4294901760, v24
    v_add_f32 v10, v10, v11
    v_add_f32 v10, v10, v12
    v_lshlrev_b32 v11, 16, v25
    v_and_b32 v12, 4294901760, v25
    v_add_f32 v10, v10, v11
    v_add_f32 v10, v10, v12
    v_lshlrev_b32 v11, 16, v26
    v_and_b32 v12, 4294901760, v26
    v_add_f32 v10, v10, v11
    v_add_f32 v10, v10, v12
    v_lshlrev_b32 v11, 16, v27
    v_and_b32 v12, 4294901760, v27
    v_add_f32 v10, v10, v11
    v_add_f32 v10, v10, v12
    s_add_u32 s23, s23, 6144
    buffer_store_dwordx4 v[28:31], v5, s[8:11], s23 offen
    v_lshlrev_b32 v11, 16, v28
    v_and_b32 v12, 4294901760, v28
    v_add_f32 v10, v10, v11
    v_add_f32 v10, v10, v12
    v_lshlrev_b32 v11, 16, v29
    v_and_b32 v12, 4294901760, v29
    v_add_f32 v10, v10, v11
    v_add_f32 v10, v10, v12
    v_lshlrev_b32 v11, 16, v30
    v_and_b32 v12, 4294901760, v30
    v_add_f32 v10, v10, v11
    v_add_f32 v10, v10, v12
    v_lshlrev_b32 v11, 16, v31
    v_and_b32 v12, 4294901760, v31
    v_add_f32 v10, v10, v11
    v_add_f32 v10, v10, v12
    s_add_u32 s23, s23, 6144
    buffer_store_dwordx4 v[32:35], v5, s[8:11], s23 offen
    v_lshlrev_b32 v11, 16, v32
    v_and_b32 v12, 4294901760, v32
    v_add_f32 v10, v10, v11
    v_add_f32 v10, v10, v12
    v_lshlrev_b32 v11, 16, v33
    v_and_b32 v12, 4294901760, v33
    v_add_f32 v10, v10, v11
    v_add_f32 v10, v10, v12
    v_lshlrev_b32 v11, 16, v34
    v_and_b32 v12, 4294901760, v34
    v_add_f32 v10, v10, v11
    v_add_f32 v10, v10, v12
    v_lshlrev_b32 v11, 16, v35
    v_and_b32 v12, 4294901760, v35
    v_add_f32 v10, v10, v11
    v_add_f32 v10, v10, v12
    s_add_u32 s23, s23, 6144
    buffer_store_dwordx4 v[36:39], v5, s[8:11], s23 offen
    v_lshlrev_b32 v11, 16, v36
    v_and_b32 v12, 4294901760, v36
    v_add_f32 v10, v10, v11
    v_add_f32 v10, v10, v12
    v_lshlrev_b32 v11, 16, v37
    v_and_b32 v12, 4294901760, v37
    v_add_f32 v10, v10, v11
    v_add_f32 v10, v10, v12
    v_lshlrev_b32 v11, 16, v38
    v_and_b32 v12, 4294901760, v38
    v_add_f32 v10, v10, v11
    v_add_f32 v10, v10, v12
    v_lshlrev_b32 v11, 16, v39
    v_and_b32 v12, 4294901760, v39
    v_add_f32 v10, v10, v11
    v_add_f32 v10, v10, v12
    s_add_u32 s23, s23, 6144
    buffer_store_dwordx4 v[40:43], v5, s[8:11], s23 offen
    v_lshlrev_b32 v11, 16, v40
    v_and_b32 v12, 4294901760, v40
    v_add_f32 v10, v10, v11
    v_add_f32 v10, v10, v12
    v_lshlrev_b32 v11, 16, v41
    v_and_b32 v12, 4294901760, v41
    v_add_f32 v10, v10, v11
    v_add_f32 v10, v10, v12
    v_lshlrev_b32 v11, 16, v42
    v_and_b32 v12, 4294901760, v42
    v_add_f32 v10, v10, v11
    v_add_f32 v10, v10, v12
    v_lshlrev_b32 v11, 16, v43
    v_and_b32 v12, 4294901760, v43
    v_add_f32 v10, v10, v11
    v_add_f32 v10, v10, v12
    s_add_u32 s23, s23, 6144
    buffer_store_dwordx4 v[44:47], v5, s[8:11], s23 offen
    v_lshlrev_b32 v11, 16, v44
    v_and_b32 v12, 4294901760, v44
    v_add_f32 v10, v10, v11
    v_add_f32 v10, v10, v12
    v_lshlrev_b32 v11, 16, v45
    v_and_b32 v12, 4294901760, v45
    v_add_f32 v10, v10, v11
    v_add_f32 v10, v10, v12
    v_lshlrev_b32 v11, 16, v46
    v_and_b32 v12, 4294901760, v46
    v_add_f32 v10, v10, v11
    v_add_f32 v10, v10, v12
    v_lshlrev_b32 v11, 16, v47
    v_and_b32 v12, 4294901760, v47
    v_add_f32 v10, v10, v11
    v_add_f32 v10, v10, v12
    s_add_u32 s23, s23, 6144
    buffer_store_dwordx4 v[48:51], v5, s[8:11], s23 offen
    v_lshlrev_b32 v11, 16, v48
    v_and_b32 v12, 4294901760, v48
    v_add_f32 v10, v10, v11
    v_add_f32 v10, v10, v12
    v_lshlrev_b32 v11, 16, v49
    v_and_b32 v12, 4294901760, v49
    v_add_f32 v10, v10, v11
    v_add_f32 v10, v10, v12
    v_lshlrev_b32 v11, 16, v50
    v_and_b32 v12, 4294901760, v50
    v_add_f32 v10, v10, v11
    v_add_f32 v10, v10, v12
    v_lshlrev_b32 v11, 16, v51
    v_and_b32 v12, 4294901760, v51
    v_add_f32 v10, v10, v11
    v_add_f32 v10, v10, v12
    s_add_u32 s23, s23, 6144
    buffer_store_dwordx4 v[52:55], v5, s[8:11], s23 offen
    v_lshlrev_b32 v11, 16, v52
    v_and_b32 v12, 4294901760, v52
    v_add_f32 v10, v10, v11
    v_add_f32 v10, v10, v12
    v_lshlrev_b32 v11, 16, v53
    v_and_b32 v12, 4294901760, v53
    v_add_f32 v10, v10, v11
    v_add_f32 v10, v10, v12
    v_lshlrev_b32 v11, 16, v54
    v_and_b32 v12, 4294901760, v54
    v_add_f32 v10, v10, v11
    v_add_f32 v10, v10, v12
    v_lshlrev_b32 v11, 16, v55
    v_and_b32 v12, 4294901760, v55
    v_add_f32 v10, v10, v11
    v_add_f32 v10, v10, v12
    s_add_u32 s23, s23, 6144
    buffer_store_dwordx4 v[56:59], v5, s[8:11], s23 offen
    v_lshlrev_b32 v11, 16, v56
    v_and_b32 v12, 4294901760, v56
    v_add_f32 v10, v10, v11
    v_add_f32 v10, v10, v12
    v_lshlrev_b32 v11, 16, v57
    v_and_b32 v12, 4294901760, v57
    v_add_f32 v10, v10, v11
    v_add_f32 v10, v10, v12
    v_lshlrev_b32 v11, 16, v58
    v_and_b32 v12, 4294901760, v58
    v_add_f32 v10, v10, v11
    v_add_f32 v10, v10, v12
    v_lshlrev_b32 v11, 16, v59
    v_and_b32 v12, 4294901760, v59
    v_add_f32 v10, v10, v11
    v_add_f32 v10, v10, v12
    s_add_u32 s23, s23, 6144
    buffer_store_dwordx4 v[60:63], v5, s[8:11], s23 offen
    v_lshlrev_b32 v11, 16, v60
    v_and_b32 v12, 4294901760, v60
    v_add_f32 v10, v10, v11
    v_add_f32 v10, v10, v12
    v_lshlrev_b32 v11, 16, v61
    v_and_b32 v12, 4294901760, v61
    v_add_f32 v10, v10, v11
    v_add_f32 v10, v10, v12
    v_lshlrev_b32 v11, 16, v62
    v_and_b32 v12, 4294901760, v62
    v_add_f32 v10, v10, v11
    v_add_f32 v10, v10, v12
    v_lshlrev_b32 v11, 16, v63
    v_and_b32 v12, 4294901760, v63
    v_add_f32 v10, v10, v11
    v_add_f32 v10, v10, v12
    s_add_u32 s23, s23, 6144
    buffer_store_dwordx4 v[64:67], v5, s[8:11], s23 offen
    v_lshlrev_b32 v11, 16, v64
    v_and_b32 v12, 4294901760, v64
    v_add_f32 v10, v10, v11
    v_add_f32 v10, v10, v12
    v_lshlrev_b32 v11, 16, v65
    v_and_b32 v12, 4294901760, v65
    v_add_f32 v10, v10, v11
    v_add_f32 v10, v10, v12
    v_lshlrev_b32 v11, 16, v66
    v_and_b32 v12, 4294901760, v66
    v_add_f32 v10, v10, v11
    v_add_f32 v10, v10, v12
    v_lshlrev_b32 v11, 16, v67
    v_and_b32 v12, 4294901760, v67
    v_add_f32 v10, v10, v11
    v_add_f32 v10, v10, v12
    s_add_u32 s23, s23, 6144
    buffer_store_dwordx4 v[68:71], v5, s[8:11], s23 offen
    v_lshlrev_b32 v11, 16, v68
    v_and_b32 v12, 4294901760, v68
    v_add_f32 v10, v10, v11
    v_add_f32 v10, v10, v12
    v_lshlrev_b32 v11, 16, v69
    v_and_b32 v12, 4294901760, v69
    v_add_f32 v10, v10, v11
    v_add_f32 v10, v10, v12
    v_lshlrev_b32 v11, 16, v70
    v_and_b32 v12, 4294901760, v70
    v_add_f32 v10, v10, v11
    v_add_f32 v10, v10, v12
    v_lshlrev_b32 v11, 16, v71
    v_and_b32 v12, 4294901760, v71
    v_add_f32 v10, v10, v11
    v_add_f32 v10, v10, v12
    v_mov_b32 v11, v10
    s_nop 1
    v_permlane16_swap_b32 v10, v11
    v_add_f32 v10, v10, v11
    v_mov_b32 v11, v10
    s_nop 1
    v_permlane32_swap_b32 v10, v11
    v_add_f32 v10, v10, v11
    v_lshlrev_b32 v11, 2, v3
    s_lshl_b32 s23, s21, 6
    s_add_u32 s23, s23, 29360128
    buffer_store_dword v10, v11, s[8:11], s23 offen
    s_branch L_end_k4a_kernel
    s_nop 4
L_p_wphi_k4a_kernel:
    s_sub_u32 s40, s21, 96
    s_mul_i32 s22, s40, 12544
    v_mul_u32_u24 v8, 224, v4
    v_lshl_add_u32 v8, v3, 1, v8
    v_mov_b32 v7, 1073741824
    v_add_u32 v9, 896, v8
    v_cmp_gt_u32 vcc, 3, v4
    s_nop 1
    v_cndmask_b32 v9, v7, v9, vcc
    v_add_u32 v10, 32, v8
    v_add_u32 v11, 32, v9
    v_cmp_gt_u32 vcc, 12, v3
    s_nop 1
    v_cndmask_b32 v10, v7, v10, vcc
    v_cndmask_b32 v11, v7, v11, vcc
    s_add_u32 s23, s22, 0
    buffer_load_ushort v96, v8, s[24:27], s23 offen
    s_add_u32 s23, s22, 56
    buffer_load_ushort v97, v8, s[24:27], s23 offen
    s_add_u32 s23, s22, 112
    buffer_load_ushort v98, v8, s[24:27], s23 offen
    s_add_u32 s23, s22, 168
    buffer_load_ushort v99, v8, s[24:27], s23 offen
    s_add_u32 s23, s22, 0
    buffer_load_ushort v100, v9, s[24:27], s23 offen
    s_add_u32 s23, s22, 56
    buffer_load_ushort v101, v9, s[24:27], s23 offen
    s_add_u32 s23, s22, 112
    buffer_load_ushort v102, v9, s[24:27], s23 offen
    s_add_u32 s23, s22, 168
    buffer_load_ushort v103, v9, s[24:27], s23 offen
    s_add_u32 s23, s22, 0
    buffer_load_ushort v104, v10, s[24:27], s23 offen
    s_add_u32 s23, s22, 56
    buffer_load_ushort v105, v10, s[24:27], s23 offen
    s_add_u32 s23, s22, 112
    buffer_load_ushort v106, v10, s[24:27], s23 offen
    s_add_u32 s23, s22, 168
    buffer_load_ushort v107, v10, s[24:27], s23 offen
    s_add_u32 s23, s22, 0
    buffer_load_ushort v108, v11, s[24:27], s23 offen
    s_add_u32 s23, s22, 56
    buffer_load_ushort v109, v11, s[24:27], s23 offen
    s_add_u32 s23, s22, 112
    buffer_load_ushort v110, v11, s[24:27], s23 offen
    s_add_u32 s23, s22, 168
    buffer_load_ushort v111, v11, s[24:27], s23 offen
    s_add_u32 s23, s22, 1568
    buffer_load_ushort v112, v8, s[24:27], s23 offen
    s_add_u32 s23, s22, 1624
    buffer_load_ushort v113, v8, s[24:27], s23 offen
    s_add_u32 s23, s22, 1680
    buffer_load_ushort v114, v8, s[24:27], s23 offen
    s_add_u32 s23, s22, 1736
    buffer_load_ushort v115, v8, s[24:27], s23 offen
    s_add_u32 s23, s22, 1568
    buffer_load_ushort v116, v9, s[24:27], s23 offen
    s_add_u32 s23, s22, 1624
    buffer_load_ushort v117, v9, s[24:27], s23 offen
    s_add_u32 s23, s22, 1680
    buffer_load_ushort v118, v9, s[24:27], s23 offen
    s_add_u32 s23, s22, 1736
    buffer_load_ushort v119, v9, s[24:27], s23 offen
    s_add_u32 s23, s22, 1568
    buffer_load_ushort v120, v10, s[24:27], s23 offen
    s_add_u32 s23, s22, 1624
    buffer_load_ushort v121, v10, s[24:27], s23 offen
    s_add_u32 s23, s22, 1680
    buffer_load_ushort v122, v10, s[24:27], s23 offen
    s_add_u32 s23, s22, 1736
    buffer_load_ushort v123, v10, s[24:27], s23 offen
    s_add_u32 s23, s22, 1568
    buffer_load_ushort v124, v11, s[24:27], s23 offen
    s_add_u32 s23, s22, 1624
    buffer_load_ushort v125, v11, s[24:27], s23 offen
    s_add_u32 s23, s22, 1680
    buffer_load_ushort v126, v11, s[24:27], s23 offen
    s_add_u32 s23, s22, 1736
    buffer_load_ushort v127, v11, s[24:27], s23 offen
    s_add_u32 s23, s22, 3136
    buffer_load_ushort v128, v8, s[24:27], s23 offen
    s_add_u32 s23, s22, 3192
    buffer_load_ushort v129, v8, s[24:27], s23 offen
    s_add_u32 s23, s22, 3248
    buffer_load_ushort v130, v8, s[24:27], s23 offen
    s_add_u32 s23, s22, 3304
    buffer_load_ushort v131, v8, s[24:27], s23 offen
    s_add_u32 s23, s22, 3136
    buffer_load_ushort v132, v9, s[24:27], s23 offen
    s_add_u32 s23, s22, 3192
    buffer_load_ushort v133, v9, s[24:27], s23 offen
    s_add_u32 s23, s22, 3248
    buffer_load_ushort v134, v9, s[24:27], s23 offen
    s_add_u32 s23, s22, 3304
    buffer_load_ushort v135, v9, s[24:27], s23 offen
    s_add_u32 s23, s22, 3136
    buffer_load_ushort v136, v10, s[24:27], s23 offen
    s_add_u32 s23, s22, 3192
    buffer_load_ushort v137, v10, s[24:27], s23 offen
    s_add_u32 s23, s22, 3248
    buffer_load_ushort v138, v10, s[24:27], s23 offen
    s_add_u32 s23, s22, 3304
    buffer_load_ushort v139, v10, s[24:27], s23 offen
    s_add_u32 s23, s22, 3136
    buffer_load_ushort v140, v11, s[24:27], s23 offen
    s_add_u32 s23, s22, 3192
    buffer_load_ushort v141, v11, s[24:27], s23 offen
    s_add_u32 s23, s22, 3248
    buffer_load_ushort v142, v11, s[24:27], s23 offen
    s_add_u32 s23, s22, 3304
    buffer_load_ushort v143, v11, s[24:27], s23 offen
    s_add_u32 s23, s22, 4704
    buffer_load_ushort v144, v8, s[24:27], s23 offen
    s_add_u32 s23, s22, 4760
    buffer_load_ushort v145, v8, s[24:27], s23 offen
    s_add_u32 s23, s22, 4816
    buffer_load_ushort v146, v8, s[24:27], s23 offen
    s_add_u32 s23, s22, 4872
    buffer_load_ushort v147, v8, s[24:27], s23 offen
    s_add_u32 s23, s22, 4704
    buffer_load_ushort v148, v9, s[24:27], s23 offen
    s_add_u32 s23, s22, 4760
    buffer_load_ushort v149, v9, s[24:27], s23 offen
    s_add_u32 s23, s22, 4816
    buffer_load_ushort v150, v9, s[24:27], s23 offen
    s_add_u32 s23, s22, 4872
    buffer_load_ushort v151, v9, s[24:27], s23 offen
    s_add_u32 s23, s22, 4704
    buffer_load_ushort v152, v10, s[24:27], s23 offen
    s_add_u32 s23, s22, 4760
    buffer_load_ushort v153, v10, s[24:27], s23 offen
    s_add_u32 s23, s22, 4816
    buffer_load_ushort v154, v10, s[24:27], s23 offen
    s_add_u32 s23, s22, 4872
    buffer_load_ushort v155, v10, s[24:27], s23 offen
    s_add_u32 s23, s22, 4704
    buffer_load_ushort v156, v11, s[24:27], s23 offen
    s_add_u32 s23, s22, 4760
    buffer_load_ushort v157, v11, s[24:27], s23 offen
    s_add_u32 s23, s22, 4816
    buffer_load_ushort v158, v11, s[24:27], s23 offen
    s_add_u32 s23, s22, 4872
    buffer_load_ushort v159, v11, s[24:27], s23 offen
    s_add_u32 s23, s22, 6272
    buffer_load_ushort v160, v8, s[24:27], s23 offen
    s_add_u32 s23, s22, 6328
    buffer_load_ushort v161, v8, s[24:27], s23 offen
    s_add_u32 s23, s22, 6384
    buffer_load_ushort v162, v8, s[24:27], s23 offen
    s_add_u32 s23, s22, 6440
    buffer_load_ushort v163, v8, s[24:27], s23 offen
    s_add_u32 s23, s22, 6272
    buffer_load_ushort v164, v9, s[24:27], s23 offen
    s_add_u32 s23, s22, 6328
    buffer_load_ushort v165, v9, s[24:27], s23 offen
    s_add_u32 s23, s22, 6384
    buffer_load_ushort v166, v9, s[24:27], s23 offen
    s_add_u32 s23, s22, 6440
    buffer_load_ushort v167, v9, s[24:27], s23 offen
    s_add_u32 s23, s22, 6272
    buffer_load_ushort v168, v10, s[24:27], s23 offen
    s_add_u32 s23, s22, 6328
    buffer_load_ushort v169, v10, s[24:27], s23 offen
    s_add_u32 s23, s22, 6384
    buffer_load_ushort v170, v10, s[24:27], s23 offen
    s_add_u32 s23, s22, 6440
    buffer_load_ushort v171, v10, s[24:27], s23 offen
    s_add_u32 s23, s22, 6272
    buffer_load_ushort v172, v11, s[24:27], s23 offen
    s_add_u32 s23, s22, 6328
    buffer_load_ushort v173, v11, s[24:27], s23 offen
    s_add_u32 s23, s22, 6384
    buffer_load_ushort v174, v11, s[24:27], s23 offen
    s_add_u32 s23, s22, 6440
    buffer_load_ushort v175, v11, s[24:27], s23 offen
    s_add_u32 s23, s22, 7840
    buffer_load_ushort v176, v8, s[24:27], s23 offen
    s_add_u32 s23, s22, 7896
    buffer_load_ushort v177, v8, s[24:27], s23 offen
    s_add_u32 s23, s22, 7952
    buffer_load_ushort v178, v8, s[24:27], s23 offen
    s_add_u32 s23, s22, 8008
    buffer_load_ushort v179, v8, s[24:27], s23 offen
    s_add_u32 s23, s22, 7840
    buffer_load_ushort v180, v9, s[24:27], s23 offen
    s_add_u32 s23, s22, 7896
    buffer_load_ushort v181, v9, s[24:27], s23 offen
    s_add_u32 s23, s22, 7952
    buffer_load_ushort v182, v9, s[24:27], s23 offen
    s_add_u32 s23, s22, 8008
    buffer_load_ushort v183, v9, s[24:27], s23 offen
    s_add_u32 s23, s22, 7840
    buffer_load_ushort v184, v10, s[24:27], s23 offen
    s_add_u32 s23, s22, 7896
    buffer_load_ushort v185, v10, s[24:27], s23 offen
    s_add_u32 s23, s22, 7952
    buffer_load_ushort v186, v10, s[24:27], s23 offen
    s_add_u32 s23, s22, 8008
    buffer_load_ushort v187, v10, s[24:27], s23 offen
    s_add_u32 s23, s22, 7840
    buffer_load_ushort v188, v11, s[24:27], s23 offen
    s_add_u32 s23, s22, 7896
    buffer_load_ushort v189, v11, s[24:27], s23 offen
    s_add_u32 s23, s22, 7952
    buffer_load_ushort v190, v11, s[24:27], s23 offen
    s_add_u32 s23, s22, 8008
    buffer_load_ushort v191, v11, s[24:27], s23 offen
    s_add_u32 s23, s22, 9408
    buffer_load_ushort v192, v8, s[24:27], s23 offen
    s_add_u32 s23, s22, 9464
    buffer_load_ushort v193, v8, s[24:27], s23 offen
    s_add_u32 s23, s22, 9520
    buffer_load_ushort v194, v8, s[24:27], s23 offen
    s_add_u32 s23, s22, 9576
    buffer_load_ushort v195, v8, s[24:27], s23 offen
    s_add_u32 s23, s22, 9408
    buffer_load_ushort v196, v9, s[24:27], s23 offen
    s_add_u32 s23, s22, 9464
    buffer_load_ushort v197, v9, s[24:27], s23 offen
    s_add_u32 s23, s22, 9520
    buffer_load_ushort v198, v9, s[24:27], s23 offen
    s_add_u32 s23, s22, 9576
    buffer_load_ushort v199, v9, s[24:27], s23 offen
    s_add_u32 s23, s22, 9408
    buffer_load_ushort v200, v10, s[24:27], s23 offen
    s_add_u32 s23, s22, 9464
    buffer_load_ushort v201, v10, s[24:27], s23 offen
    s_add_u32 s23, s22, 9520
    buffer_load_ushort v202, v10, s[24:27], s23 offen
    s_add_u32 s23, s22, 9576
    buffer_load_ushort v203, v10, s[24:27], s23 offen
    s_add_u32 s23, s22, 9408
    buffer_load_ushort v204, v11, s[24:27], s23 offen
    s_add_u32 s23, s22, 9464
    buffer_load_ushort v205, v11, s[24:27], s23 offen
    s_add_u32 s23, s22, 9520
    buffer_load_ushort v206, v11, s[24:27], s23 offen
    s_add_u32 s23, s22, 9576
    buffer_load_ushort v207, v11, s[24:27], s23 offen
    s_add_u32 s23, s22, 10976
    buffer_load_ushort v208, v8, s[24:27], s23 offen
    s_add_u32 s23, s22, 11032
    buffer_load_ushort v209, v8, s[24:27], s23 offen
    s_add_u32 s23, s22, 11088
    buffer_load_ushort v210, v8, s[24:27], s23 offen
    s_add_u32 s23, s22, 11144
    buffer_load_ushort v211, v8, s[24:27], s23 offen
    s_add_u32 s23, s22, 10976
    buffer_load_ushort v212, v9, s[24:27], s23 offen
    s_add_u32 s23, s22, 11032
    buffer_load_ushort v213, v9, s[24:27], s23 offen
    s_add_u32 s23, s22, 11088
    buffer_load_ushort v214, v9, s[24:27], s23 offen
    s_add_u32 s23, s22, 11144
    buffer_load_ushort v215, v9, s[24:27], s23 offen
    s_add_u32 s23, s22, 10976
    buffer_load_ushort v216, v10, s[24:27], s23 offen
    s_add_u32 s23, s22, 11032
    buffer_load_ushort v217, v10, s[24:27], s23 offen
    s_add_u32 s23, s22, 11088
    buffer_load_ushort v218, v10, s[24:27], s23 offen
    s_add_u32 s23, s22, 11144
    buffer_load_ushort v219, v10, s[24:27], s23 offen
    s_add_u32 s23, s22, 10976
    buffer_load_ushort v220, v11, s[24:27], s23 offen
    s_add_u32 s23, s22, 11032
    buffer_load_ushort v221, v11, s[24:27], s23 offen
    s_add_u32 s23, s22, 11088
    buffer_load_ushort v222, v11, s[24:27], s23 offen
    s_add_u32 s23, s22, 11144
    buffer_load_ushort v223, v11, s[24:27], s23 offen
    s_waitcnt vmcnt(63)
    v_lshl_or_b32 v16, v97, 16, v96
    v_lshl_or_b32 v17, v99, 16, v98
    v_lshl_or_b32 v18, v101, 16, v100
    v_lshl_or_b32 v19, v103, 16, v102
    v_lshl_or_b32 v20, v105, 16, v104
    v_lshl_or_b32 v21, v107, 16, v106
    v_lshl_or_b32 v22, v109, 16, v108
    v_lshl_or_b32 v23, v111, 16, v110
    v_lshl_or_b32 v24, v113, 16, v112
    v_lshl_or_b32 v25, v115, 16, v114
    v_lshl_or_b32 v26, v117, 16, v116
    v_lshl_or_b32 v27, v119, 16, v118
    v_lshl_or_b32 v28, v121, 16, v120
    v_lshl_or_b32 v29, v123, 16, v122
    v_lshl_or_b32 v30, v125, 16, v124
    v_lshl_or_b32 v31, v127, 16, v126
    v_lshl_or_b32 v32, v129, 16, v128
    v_lshl_or_b32 v33, v131, 16, v130
    v_lshl_or_b32 v34, v133, 16, v132
    v_lshl_or_b32 v35, v135, 16, v134
    v_lshl_or_b32 v36, v137, 16, v136
    v_lshl_or_b32 v37, v139, 16, v138
    v_lshl_or_b32 v38, v141, 16, v140
    v_lshl_or_b32 v39, v143, 16, v142
    v_lshl_or_b32 v40, v145, 16, v144
    v_lshl_or_b32 v41, v147, 16, v146
    v_lshl_or_b32 v42, v149, 16, v148
    v_lshl_or_b32 v43, v151, 16, v150
    v_lshl_or_b32 v44, v153, 16, v152
    v_lshl_or_b32 v45, v155, 16, v154
    v_lshl_or_b32 v46, v157, 16, v156
    v_lshl_or_b32 v47, v159, 16, v158
    s_waitcnt vmcnt(62)
    v_lshl_or_b32 v48, v161, 16, v160
    s_waitcnt vmcnt(60)
    v_lshl_or_b32 v49, v163, 16, v162
    s_waitcnt vmcnt(58)
    v_lshl_or_b32 v50, v165, 16, v164
    s_waitcnt vmcnt(56)
    v_lshl_or_b32 v51, v167, 16, v166
    s_waitcnt vmcnt(54)
    v_lshl_or_b32 v52, v169, 16, v168
    s_waitcnt vmcnt(52)
    v_lshl_or_b32 v53, v171, 16, v170
    s_waitcnt vmcnt(50)
    v_lshl_or_b32 v54, v173, 16, v172
    s_waitcnt vmcnt(48)
    v_lshl_or_b32 v55, v175, 16, v174
    s_waitcnt vmcnt(46)
    v_lshl_or_b32 v56, v177, 16, v176
    s_waitcnt vmcnt(44)
    v_lshl_or_b32 v57, v179, 16, v178
    s_waitcnt vmcnt(42)
    v_lshl_or_b32 v58, v181, 16, v180
    s_waitcnt vmcnt(40)
    v_lshl_or_b32 v59, v183, 16, v182
    s_waitcnt vmcnt(38)
    v_lshl_or_b32 v60, v185, 16, v184
    s_waitcnt vmcnt(36)
    v_lshl_or_b32 v61, v187, 16, v186
    s_waitcnt vmcnt(34)
    v_lshl_or_b32 v62, v189, 16, v188
    s_waitcnt vmcnt(32)
    v_lshl_or_b32 v63, v191, 16, v190
    s_waitcnt vmcnt(30)
    v_lshl_or_b32 v64, v193, 16, v192
    s_waitcnt vmcnt(28)
    v_lshl_or_b32 v65, v195, 16, v194
    s_waitcnt vmcnt(26)
    v_lshl_or_b32 v66, v197, 16, v196
    s_waitcnt vmcnt(24)
    v_lshl_or_b32 v67, v199, 16, v198
    s_waitcnt vmcnt(22)
    v_lshl_or_b32 v68, v201, 16, v200
    s_waitcnt vmcnt(20)
    v_lshl_or_b32 v69, v203, 16, v202
    s_waitcnt vmcnt(18)
    v_lshl_or_b32 v70, v205, 16, v204
    s_waitcnt vmcnt(16)
    v_lshl_or_b32 v71, v207, 16, v206
    s_waitcnt vmcnt(14)
    v_lshl_or_b32 v72, v209, 16, v208
    s_waitcnt vmcnt(12)
    v_lshl_or_b32 v73, v211, 16, v210
    s_waitcnt vmcnt(10)
    v_lshl_or_b32 v74, v213, 16, v212
    s_waitcnt vmcnt(8)
    v_lshl_or_b32 v75, v215, 16, v214
    s_waitcnt vmcnt(6)
    v_lshl_or_b32 v76, v217, 16, v216
    s_waitcnt vmcnt(4)
    v_lshl_or_b32 v77, v219, 16, v218
    s_waitcnt vmcnt(2)
    v_lshl_or_b32 v78, v221, 16, v220
    s_waitcnt vmcnt(0)
    v_lshl_or_b32 v79, v223, 16, v222
    s_lshl_b32 s23, s40, 14
    s_add_u32 s23, s23, 24117248
    buffer_store_dwordx4 v[16:19], v5, s[8:11], s23 offen offset:0
    buffer_store_dwordx4 v[20:23], v5, s[8:11], s23 offen offset:1024
    buffer_store_dwordx4 v[24:27], v5, s[8:11], s23 offen offset:2048
    buffer_store_dwordx4 v[28:31], v5, s[8:11], s23 offen offset:3072
    s_add_u32 s23, s23, 4096
    buffer_store_dwordx4 v[32:35], v5, s[8:11], s23 offen offset:0
    buffer_store_dwordx4 v[36:39], v5, s[8:11], s23 offen offset:1024
    buffer_store_dwordx4 v[40:43], v5, s[8:11], s23 offen offset:2048
    buffer_store_dwordx4 v[44:47], v5, s[8:11], s23 offen offset:3072
    s_add_u32 s23, s23, 4096
    buffer_store_dwordx4 v[48:51], v5, s[8:11], s23 offen offset:0
    buffer_store_dwordx4 v[52:55], v5, s[8:11], s23 offen offset:1024
    buffer_store_dwordx4 v[56:59], v5, s[8:11], s23 offen offset:2048
    buffer_store_dwordx4 v[60:63], v5, s[8:11], s23 offen offset:3072
    s_add_u32 s23, s23, 4096
    buffer_store_dwordx4 v[64:67], v5, s[8:11], s23 offen offset:0
    buffer_store_dwordx4 v[68:71], v5, s[8:11], s23 offen offset:1024
    buffer_store_dwordx4 v[72:75], v5, s[8:11], s23 offen offset:2048
    buffer_store_dwordx4 v[76:79], v5, s[8:11], s23 offen offset:3072
    s_nop 4
L_end_k4a_kernel:
    s_endpgm

.globl k1b_kernel
.p2align 8
.type k1b_kernel,@function
k1b_kernel:
    s_cmp_ge_u32 s2, 256
    s_cbranch_scc1 L_end_k1b_kernel
    s_load_dwordx2 s[4:5], s[0:1], 88
    s_load_dwordx2 s[16:17], s[0:1], 80
    v_and_b32 v1, 63, v0
    v_lshrrev_b32 v2, 6, v0
    s_nop 0
    v_readfirstlane_b32 s20, v2
    v_and_b32 v3, 15, v1
    v_lshrrev_b32 v4, 4, v1
    v_lshlrev_b32 v5, 4, v1
    s_waitcnt lgkmcnt(0)
    s_mov_b32 s8, s4
    s_and_b32 s9, s5, 65535
    s_mov_b32 s10, 268435456
    s_mov_b32 s11, 131072
    s_and_b32 s17, s17, 65535
    s_mov_b32 s18, 256
    s_mov_b32 s19, 131072
    s_and_b32 s26, s2, 7
    s_lshr_b32 s27, s2, 3
    s_lshr_b32 s21, s26, 1
    s_lshl_b32 s21, s21, 2
    s_lshr_b32 s28, s27, 3
    s_add_u32 s21, s21, s28
    s_and_b32 s22, s26, 1
    s_lshl_b32 s22, s22, 3
    s_and_b32 s28, s27, 7
    s_add_u32 s22, s22, s28
    s_lshl_b32 s23, s21, 3
    s_add_u32 s23, s23, s20
    s_mul_i32 s26, s23, 14336
    s_add_u32 s26, s26, 4194304
    s_mul_i32 s24, s22, 86016
    s_lshl_b32 s25, s20, 10
    s_add_u32 s24, s24, s25
    s_add_u32 s24, s24, 22020096
    v_mov_b32 v15, 0
    s_lshl_b32 s31, s22, 2
    s_or_b32 s56, s20, s21
    s_cmp_lg_u32 s56, 0
    s_cbranch_scc1 L_noclaim_k1b_kernel
    v_mov_b32 v120, 0
    v_mov_b32 v121, 0
    v_mov_b32 v122, 0
    v_mov_b32 v123, 0
    s_lshl_b32 s27, s22, 13
    s_add_u32 s27, s27, 21102592
    buffer_store_dwordx4 v[120:123], v5, s[8:11], s27 offen offset:0 sc1
    buffer_store_dwordx4 v[120:123], v5, s[8:11], s27 offen offset:1024 sc1
    buffer_store_dwordx4 v[120:123], v5, s[8:11], s27 offen offset:2048 sc1
    buffer_store_dwordx4 v[120:123], v5, s[8:11], s27 offen offset:3072 sc1
    s_add_u32 s27, s27, 4096
    buffer_store_dwordx4 v[120:123], v5, s[8:11], s27 offen offset:0 sc1
    buffer_store_dwordx4 v[120:123], v5, s[8:11], s27 offen offset:1024 sc1
    buffer_store_dwordx4 v[120:123], v5, s[8:11], s27 offen offset:2048 sc1
    buffer_store_dwordx4 v[120:123], v5, s[8:11], s27 offen offset:3072 sc1
    s_nop 4
L_noclaim_k1b_kernel:
    s_add_u32 s28, s25, 0
    s_mov_b32 m0, s28
    s_add_u32 s27, s24, 0
    buffer_load_dwordx4 v5, s[8:11], s27 offen lds
    s_add_u32 s28, s25, 8192
    s_mov_b32 m0, s28
    s_add_u32 s27, s24, 8192
    buffer_load_dwordx4 v5, s[8:11], s27 offen lds
    s_add_u32 s28, s25, 16384
    s_mov_b32 m0, s28
    s_add_u32 s27, s24, 16384
    buffer_load_dwordx4 v5, s[8:11], s27 offen lds
    s_add_u32 s29, s26, 0
    buffer_load_dwordx4 v[16:19], v5, s[8:11], s29 offen offset:0
    s_add_u32 s29, s26, 0
    buffer_load_dwordx4 v[20:23], v5, s[8:11], s29 offen offset:1024
    s_add_u32 s29, s26, 0
    buffer_load_dwordx4 v[24:27], v5, s[8:11], s29 offen offset:2048
    s_add_u32 s29, s26, 0
    buffer_load_dwordx4 v[28:31], v5, s[8:11], s29 offen offset:3072
    s_add_u32 s28, s25, 24576
    s_mov_b32 m0, s28
    s_add_u32 s27, s24, 24576
    buffer_load_dwordx4 v5, s[8:11], s27 offen lds
    s_add_u32 s28, s25, 32768
    s_mov_b32 m0, s28
    s_add_u32 s27, s24, 32768
    buffer_load_dwordx4 v5, s[8:11], s27 offen lds
    s_add_u32 s28, s25, 40960
    s_mov_b32 m0, s28
    s_add_u32 s27, s24, 40960
    buffer_load_dwordx4 v5, s[8:11], s27 offen lds
    s_add_u32 s29, s26, 4096
    buffer_load_dwordx4 v[32:35], v5, s[8:11], s29 offen offset:0
    s_add_u32 s29, s26, 4096
    buffer_load_dwordx4 v[36:39], v5, s[8:11], s29 offen offset:1024
    s_add_u32 s29, s26, 4096
    buffer_load_dwordx4 v[40:43], v5, s[8:11], s29 offen offset:2048
    s_add_u32 s29, s26, 4096
    buffer_load_dwordx4 v[44:47], v5, s[8:11], s29 offen offset:3072
    v_lshlrev_b32 v6, 4, v4
    v_lshlrev_b32 v7, 2, v3
    v_mov_b32 v152, 1065369472
    v_mov_b32 v153, 1065369472
    v_mov_b32 v154, 1065369472
    v_mov_b32 v155, 1065369472
    v_and_b32 v12, 3, v3
    v_lshrrev_b32 v13, 2, v3
    v_cmp_eq_u32 s[40:41], 1, v12
    v_cmp_eq_u32 s[42:43], 2, v12
    v_cmp_eq_u32 s[44:45], 3, v12
    v_cmp_eq_u32 s[46:47], v4, v13
    v_cmp_eq_u32 s[48:49], 3, v4
    v_cmp_eq_u32 s[50:51], 12, v3
    v_cmp_le_u32 s[52:53], 12, v3
    v_add_u32 v8, 65536, v5
    s_waitcnt vmcnt(7)
    s_barrier
    s_cmp_lg_u32 s56, 0
    s_cbranch_scc1 L_nozero_k1b_kernel
    s_mov_b64 s[54:55], exec
    s_mov_b64 exec, 1
    v_mov_b32 v14, 1
    buffer_store_dword v14, v15, s[16:19], s31 offen offset:64 sc1
    s_mov_b64 exec, s[54:55]
    s_nop 4
L_nozero_k1b_kernel:
    ds_read_b128 v[72:75], v5 offset:0
    ds_read_b128 v[76:79], v5 offset:1024
    ds_read_b128 v[80:83], v5 offset:2048
    ds_read_b128 v[84:87], v5 offset:3072
    ds_read_b128 v[88:91], v5 offset:4096
    ds_read_b128 v[92:95], v5 offset:5120
    ds_read_b128 v[96:99], v5 offset:6144
    ds_read_b128 v[100:103], v5 offset:7168
    ds_read_b128 v[104:107], v5 offset:8192
    ds_read_b128 v[108:111], v5 offset:9216
    ds_read_b128 v[112:115], v5 offset:10240
    ds_read_b128 v[116:119], v5 offset:11264
    v_mfma_f32_16x16x32_bf16 v[144:147], v[152:155], v[16:19], 0
    v_mfma_f32_16x16x32_bf16 v[148:151], v[16:19], v[16:19], 0
    s_add_u32 s28, s25, 49152
    s_mov_b32 m0, s28
    s_add_u32 s27, s24, 49152
    buffer_load_dwordx4 v5, s[8:11], s27 offen lds
    s_waitcnt lgkmcnt(11)
    v_mfma_f32_16x16x32_bf16 v[120:123], v[72:75], v[16:19], 0
    s_waitcnt lgkmcnt(10)
    v_mfma_f32_16x16x32_bf16 v[124:127], v[76:79], v[16:19], 0
    s_add_u32 s28, s25, 57344
    s_mov_b32 m0, s28
    s_add_u32 s27, s24, 57344
    buffer_load_dwordx4 v5, s[8:11], s27 offen lds
    s_waitcnt lgkmcnt(9)
    v_mfma_f32_16x16x32_bf16 v[128:131], v[80:83], v[16:19], 0
    s_waitcnt lgkmcnt(8)
    v_mfma_f32_16x16x32_bf16 v[132:135], v[84:87], v[16:19], 0
    s_waitcnt lgkmcnt(7)
    v_mfma_f32_16x16x32_bf16 v[136:139], v[16:19], v[88:91], 0
    s_waitcnt lgkmcnt(6)
    v_mfma_f32_16x16x32_bf16 v[140:143], v[16:19], v[92:95], 0
    ds_read_b128 v[72:75], v5 offset:12288
    ds_read_b128 v[76:79], v5 offset:13312
    ds_read_b128 v[80:83], v5 offset:14336
    ds_read_b128 v[84:87], v5 offset:15360
    ds_read_b128 v[88:91], v5 offset:16384
    ds_read_b128 v[92:95], v5 offset:17408
    v_mfma_f32_16x16x32_bf16 v[144:147], v[152:155], v[20:23], v[144:147]
    v_mfma_f32_16x16x32_bf16 v[148:151], v[20:23], v[20:23], v[148:151]
    s_add_u32 s28, s25, 65536
    s_mov_b32 m0, s28
    s_add_u32 s27, s24, 65536
    buffer_load_dwordx4 v5, s[8:11], s27 offen lds
    s_waitcnt lgkmcnt(11)
    v_mfma_f32_16x16x32_bf16 v[120:123], v[96:99], v[20:23], v[120:123]
    s_waitcnt lgkmcnt(10)
    v_mfma_f32_16x16x32_bf16 v[124:127], v[100:103], v[20:23], v[124:127]
    s_add_u32 s29, s26, 8192
    buffer_load_dwordx4 v[48:51], v5, s[8:11], s29 offen offset:0
    s_waitcnt lgkmcnt(9)
    v_mfma_f32_16x16x32_bf16 v[128:131], v[104:107], v[20:23], v[128:131]
    s_waitcnt lgkmcnt(8)
    v_mfma_f32_16x16x32_bf16 v[132:135], v[108:111], v[20:23], v[132:135]
    s_waitcnt lgkmcnt(7)
    v_mfma_f32_16x16x32_bf16 v[136:139], v[20:23], v[112:115], v[136:139]
    s_waitcnt lgkmcnt(6)
    v_mfma_f32_16x16x32_bf16 v[140:143], v[20:23], v[116:119], v[140:143]
    ds_read_b128 v[96:99], v5 offset:18432
    ds_read_b128 v[100:103], v5 offset:19456
    ds_read_b128 v[104:107], v5 offset:20480
    ds_read_b128 v[108:111], v5 offset:21504
    ds_read_b128 v[112:115], v5 offset:22528
    ds_read_b128 v[116:119], v5 offset:23552
    v_mfma_f32_16x16x32_bf16 v[144:147], v[152:155], v[24:27], v[144:147]
    v_mfma_f32_16x16x32_bf16 v[148:151], v[24:27], v[24:27], v[148:151]
    s_add_u32 s29, s26, 8192
    buffer_load_dwordx4 v[52:55], v5, s[8:11], s29 offen offset:1024
    s_waitcnt lgkmcnt(11)
    v_mfma_f32_16x16x32_bf16 v[120:123], v[72:75], v[24:27], v[120:123]
    s_waitcnt lgkmcnt(10)
    v_mfma_f32_16x16x32_bf16 v[124:127], v[76:79], v[24:27], v[124:127]
    s_add_u32 s29, s26, 8192
    buffer_load_dwordx4 v[56:59], v5, s[8:11], s29 offen offset:2048
    s_waitcnt lgkmcnt(9)
    v_mfma_f32_16x16x32_bf16 v[128:131], v[80:83], v[24:27], v[128:131]
    s_waitcnt lgkmcnt(8)
    v_mfma_f32_16x16x32_bf16 v[132:135], v[84:87], v[24:27], v[132:135]
    s_waitcnt lgkmcnt(7)
    v_mfma_f32_16x16x32_bf16 v[136:139], v[24:27], v[88:91], v[136:139]
    s_waitcnt lgkmcnt(6)
    v_mfma_f32_16x16x32_bf16 v[140:143], v[24:27], v[92:95], v[140:143]
    v_mfma_f32_16x16x32_bf16 v[144:147], v[152:155], v[28:31], v[144:147]
    v_mfma_f32_16x16x32_bf16 v[148:151], v[28:31], v[28:31], v[148:151]
    s_add_u32 s29, s26, 8192
    buffer_load_dwordx4 v[60:63], v5, s[8:11], s29 offen offset:3072
    s_waitcnt lgkmcnt(5)
    v_mfma_f32_16x16x32_bf16 v[120:123], v[96:99], v[28:31], v[120:123]
    s_waitcnt lgkmcnt(4)
    v_mfma_f32_16x16x32_bf16 v[124:127], v[100:103], v[28:31], v[124:127]
    s_waitcnt lgkmcnt(3)
    v_mfma_f32_16x16x32_bf16 v[128:131], v[104:107], v[28:31], v[128:131]
    s_waitcnt lgkmcnt(2)
    v_mfma_f32_16x16x32_bf16 v[132:135], v[108:111], v[28:31], v[132:135]
    s_waitcnt lgkmcnt(1)
    v_mfma_f32_16x16x32_bf16 v[136:139], v[28:31], v[112:115], v[136:139]
    s_waitcnt lgkmcnt(0)
    v_mfma_f32_16x16x32_bf16 v[140:143], v[28:31], v[116:119], v[140:143]
    s_waitcnt vmcnt(7)
    s_barrier
    ds_read_b128 v[72:75], v5 offset:24576
    ds_read_b128 v[76:79], v5 offset:25600
    ds_read_b128 v[80:83], v5 offset:26624
    ds_read_b128 v[84:87], v5 offset:27648
    ds_read_b128 v[88:91], v5 offset:28672
    ds_read_b128 v[92:95], v5 offset:29696
    ds_read_b128 v[96:99], v5 offset:30720
    ds_read_b128 v[100:103], v5 offset:31744
    ds_read_b128 v[104:107], v5 offset:32768
    ds_read_b128 v[108:111], v5 offset:33792
    ds_read_b128 v[112:115], v5 offset:34816
    ds_read_b128 v[116:119], v5 offset:35840
    v_mfma_f32_16x16x32_bf16 v[144:147], v[152:155], v[32:35], v[144:147]
    v_mfma_f32_16x16x32_bf16 v[148:151], v[32:35], v[32:35], v[148:151]
    s_add_u32 s28, s25, 73728
    s_mov_b32 m0, s28
    s_add_u32 s27, s24, 73728
    buffer_load_dwordx4 v5, s[8:11], s27 offen lds
    s_waitcnt lgkmcnt(11)
    v_mfma_f32_16x16x32_bf16 v[120:123], v[72:75], v[32:35], v[120:123]
    s_waitcnt lgkmcnt(10)
    v_mfma_f32_16x16x32_bf16 v[124:127], v[76:79], v[32:35], v[124:127]
    s_add_u32 s28, s25, 81920
    s_mov_b32 m0, s28
    s_min_u32 s27, s20, 3
    s_lshl_b32 s27, s27, 10
    s_sub_u32 s27, s27, s25
    s_add_u32 s27, s27, s24
    s_add_u32 s27, s27, 81920
    buffer_load_dwordx4 v5, s[8:11], s27 offen lds
    s_waitcnt lgkmcnt(9)
    v_mfma_f32_16x16x32_bf16 v[128:131], v[80:83], v[32:35], v[128:131]
    s_waitcnt lgkmcnt(8)
    v_mfma_f32_16x16x32_bf16 v[132:135], v[84:87], v[32:35], v[132:135]
    s_waitcnt lgkmcnt(7)
    v_mfma_f32_16x16x32_bf16 v[136:139], v[32:35], v[88:91], v[136:139]
    s_waitcnt lgkmcnt(6)
    v_mfma_f32_16x16x32_bf16 v[140:143], v[32:35], v[92:95], v[140:143]
    ds_read_b128 v[72:75], v5 offset:36864
    ds_read_b128 v[76:79], v5 offset:37888
    ds_read_b128 v[80:83], v5 offset:38912
    ds_read_b128 v[84:87], v5 offset:39936
    ds_read_b128 v[88:91], v5 offset:40960
    ds_read_b128 v[92:95], v5 offset:41984
    v_mfma_f32_16x16x32_bf16 v[144:147], v[152:155], v[36:39], v[144:147]
    v_mfma_f32_16x16x32_bf16 v[148:151], v[36:39], v[36:39], v[148:151]
    s_add_u32 s29, s26, 12288
    buffer_load_dwordx4 v[64:67], v5, s[8:11], s29 offen offset:0
    s_waitcnt lgkmcnt(11)
    v_mfma_f32_16x16x32_bf16 v[120:123], v[96:99], v[36:39], v[120:123]
    s_waitcnt lgkmcnt(10)
    v_mfma_f32_16x16x32_bf16 v[124:127], v[100:103], v[36:39], v[124:127]
    s_add_u32 s29, s26, 12288
    buffer_load_dwordx4 v[68:71], v5, s[8:11], s29 offen offset:1024
    s_waitcnt lgkmcnt(9)
    v_mfma_f32_16x16x32_bf16 v[128:131], v[104:107], v[36:39], v[128:131]
    s_waitcnt lgkmcnt(8)
    v_mfma_f32_16x16x32_bf16 v[132:135], v[108:111], v[36:39], v[132:135]
    s_waitcnt lgkmcnt(7)
    v_mfma_f32_16x16x32_bf16 v[136:139], v[36:39], v[112:115], v[136:139]
    s_waitcnt lgkmcnt(6)
    v_mfma_f32_16x16x32_bf16 v[140:143], v[36:39], v[116:119], v[140:143]
    ds_read_b128 v[96:99], v5 offset:43008
    ds_read_b128 v[100:103], v5 offset:44032
    ds_read_b128 v[104:107], v5 offset:45056
    ds_read_b128 v[108:111], v5 offset:46080
    ds_read_b128 v[112:115], v5 offset:47104
    ds_read_b128 v[116:119], v5 offset:48128
    v_mfma_f32_16x16x32_bf16 v[144:147], v[152:155], v[40:43], v[144:147]
    v_mfma_f32_16x16x32_bf16 v[148:151], v[40:43], v[40:43], v[148:151]
    s_waitcnt lgkmcnt(11)
    v_mfma_f32_16x16x32_bf16 v[120:123], v[72:75], v[40:43], v[120:123]
    s_waitcnt lgkmcnt(10)
    v_mfma_f32_16x16x32_bf16 v[124:127], v[76:79], v[40:43], v[124:127]
    s_waitcnt lgkmcnt(9)
    v_mfma_f32_16x16x32_bf16 v[128:131], v[80:83], v[40:43], v[128:131]
    s_waitcnt lgkmcnt(8)
    v_mfma_f32_16x16x32_bf16 v[132:135], v[84:87], v[40:43], v[132:135]
    s_waitcnt lgkmcnt(7)
    v_mfma_f32_16x16x32_bf16 v[136:139], v[40:43], v[88:91], v[136:139]
    s_waitcnt lgkmcnt(6)
    v_mfma_f32_16x16x32_bf16 v[140:143], v[40:43], v[92:95], v[140:143]
    v_mfma_f32_16x16x32_bf16 v[144:147], v[152:155], v[44:47], v[144:147]
    v_mfma_f32_16x16x32_bf16 v[148:151], v[44:47], v[44:47], v[148:151]
    s_waitcnt lgkmcnt(5)
    v_mfma_f32_16x16x32_bf16 v[120:123], v[96:99], v[44:47], v[120:123]
    s_waitcnt lgkmcnt(4)
    v_mfma_f32_16x16x32_bf16 v[124:127], v[100:103], v[44:47], v[124:127]
    s_waitcnt lgkmcnt(3)
    v_mfma_f32_16x16x32_bf16 v[128:131], v[104:107], v[44:47], v[128:131]
    s_waitcnt lgkmcnt(2)
    v_mfma_f32_16x16x32_bf16 v[132:135], v[108:111], v[44:47], v[132:135]
    s_waitcnt lgkmcnt(1)
    v_mfma_f32_16x16x32_bf16 v[136:139], v[44:47], v[112:115], v[136:139]
    s_waitcnt lgkmcnt(0)
    v_mfma_f32_16x16x32_bf16 v[140:143], v[44:47], v[116:119], v[140:143]
    s_waitcnt vmcnt(4)
    s_barrier
    ds_read_b128 v[72:75], v5 offset:49152
    ds_read_b128 v[76:79], v5 offset:50176
    ds_read_b128 v[80:83], v5 offset:51200
    ds_read_b128 v[84:87], v5 offset:52224
    ds_read_b128 v[88:91], v5 offset:53248
    ds_read_b128 v[92:95], v5 offset:54272
    ds_read_b128 v[96:99], v5 offset:55296
    ds_read_b128 v[100:103], v5 offset:56320
    ds_read_b128 v[104:107], v5 offset:57344
    ds_read_b128 v[108:111], v5 offset:58368
    ds_read_b128 v[112:115], v5 offset:59392
    ds_read_b128 v[116:119], v5 offset:60416
    v_mfma_f32_16x16x32_bf16 v[144:147], v[152:155], v[48:51], v[144:147]
    v_mfma_f32_16x16x32_bf16 v[148:151], v[48:51], v[48:51], v[148:151]
    s_mul_i32 s30, s22, 384
    s_add_u32 s30, s30, 29360128
    buffer_load_dwordx4 v[156:159], v6, s[8:11], s30 offen offset:0
    buffer_load_dwordx4 v[160:163], v6, s[8:11], s30 offen offset:64
    buffer_load_dwordx4 v[164:167], v6, s[8:11], s30 offen offset:128
    buffer_load_dwordx4 v[168:171], v6, s[8:11], s30 offen offset:192
    s_waitcnt lgkmcnt(11)
    v_mfma_f32_16x16x32_bf16 v[120:123], v[72:75], v[48:51], v[120:123]
    s_waitcnt lgkmcnt(10)
    v_mfma_f32_16x16x32_bf16 v[124:127], v[76:79], v[48:51], v[124:127]
    buffer_load_dword v172, v7, s[8:11], s30 offen offset:256
    buffer_load_dword v176, v7, s[8:11], s30 offen offset:320
    s_lshl_b32 s30, s22, 11
    s_add_u32 s30, s30, 24117248
    buffer_load_dwordx4 v[216:219], v5, s[8:11], s30 offen offset:0
    buffer_load_dwordx4 v[220:223], v5, s[8:11], s30 offen offset:1024
    s_waitcnt lgkmcnt(9)
    v_mfma_f32_16x16x32_bf16 v[128:131], v[80:83], v[48:51], v[128:131]
    s_waitcnt lgkmcnt(8)
    v_mfma_f32_16x16x32_bf16 v[132:135], v[84:87], v[48:51], v[132:135]
    s_waitcnt lgkmcnt(7)
    v_mfma_f32_16x16x32_bf16 v[136:139], v[48:51], v[88:91], v[136:139]
    s_waitcnt lgkmcnt(6)
    v_mfma_f32_16x16x32_bf16 v[140:143], v[48:51], v[92:95], v[140:143]
    ds_read_b128 v[72:75], v5 offset:61440
    ds_read_b128 v[76:79], v5 offset:62464
    ds_read_b128 v[80:83], v5 offset:63488
    ds_read_b128 v[84:87], v5 offset:64512
    ds_read_b128 v[88:91], v8 offset:0
    ds_read_b128 v[92:95], v8 offset:1024
    v_mfma_f32_16x16x32_bf16 v[144:147], v[152:155], v[52:55], v[144:147]
    v_mfma_f32_16x16x32_bf16 v[148:151], v[52:55], v[52:55], v[148:151]
    s_waitcnt lgkmcnt(11)
    v_mfma_f32_16x16x32_bf16 v[120:123], v[96:99], v[52:55], v[120:123]
    s_waitcnt lgkmcnt(10)
    v_mfma_f32_16x16x32_bf16 v[124:127], v[100:103], v[52:55], v[124:127]
    s_waitcnt lgkmcnt(9)
    v_mfma_f32_16x16x32_bf16 v[128:131], v[104:107], v[52:55], v[128:131]
    s_waitcnt lgkmcnt(8)
    v_mfma_f32_16x16x32_bf16 v[132:135], v[108:111], v[52:55], v[132:135]
    s_waitcnt lgkmcnt(7)
    v_mfma_f32_16x16x32_bf16 v[136:139], v[52:55], v[112:115], v[136:139]
    s_waitcnt lgkmcnt(6)
    v_mfma_f32_16x16x32_bf16 v[140:143], v[52:55], v[116:119], v[140:143]
    ds_read_b128 v[96:99], v8 offset:2048
    ds_read_b128 v[100:103], v8 offset:3072
    ds_read_b128 v[104:107], v8 offset:4096
    ds_read_b128 v[108:111], v8 offset:5120
    ds_read_b128 v[112:115], v8 offset:6144
    ds_read_b128 v[116:119], v8 offset:7168
    v_mfma_f32_16x16x32_bf16 v[144:147], v[152:155], v[56:59], v[144:147]
    v_mfma_f32_16x16x32_bf16 v[148:151], v[56:59], v[56:59], v[148:151]
    s_waitcnt lgkmcnt(11)
    v_mfma_f32_16x16x32_bf16 v[120:123], v[72:75], v[56:59], v[120:123]
    s_waitcnt lgkmcnt(10)
    v_mfma_f32_16x16x32_bf16 v[124:127], v[76:79], v[56:59], v[124:127]
    s_waitcnt lgkmcnt(9)
    v_mfma_f32_16x16x32_bf16 v[128:131], v[80:83], v[56:59], v[128:131]
    s_waitcnt lgkmcnt(8)
    v_mfma_f32_16x16x32_bf16 v[132:135], v[84:87], v[56:59], v[132:135]
    s_waitcnt lgkmcnt(7)
    v_mfma_f32_16x16x32_bf16 v[136:139], v[56:59], v[88:91], v[136:139]
    s_waitcnt lgkmcnt(6)
    v_mfma_f32_16x16x32_bf16 v[140:143], v[56:59], v[92:95], v[140:143]
    v_mfma_f32_16x16x32_bf16 v[144:147], v[152:155], v[60:63], v[144:147]
    v_mfma_f32_16x16x32_bf16 v[148:151], v[60:63], v[60:63], v[148:151]
    s_waitcnt lgkmcnt(5)
    v_mfma_f32_16x16x32_bf16 v[120:123], v[96:99], v[60:63], v[120:123]
    s_waitcnt lgkmcnt(4)
    v_mfma_f32_16x16x32_bf16 v[124:127], v[100:103], v[60:63], v[124:127]
    s_waitcnt lgkmcnt(3)
    v_mfma_f32_16x16x32_bf16 v[128:131], v[104:107], v[60:63], v[128:131]
    s_waitcnt lgkmcnt(2)
    v_mfma_f32_16x16x32_bf16 v[132:135], v[108:111], v[60:63], v[132:135]
    s_waitcnt lgkmcnt(1)
    v_mfma_f32_16x16x32_bf16 v[136:139], v[60:63], v[112:115], v[136:139]
    s_waitcnt lgkmcnt(0)
    v_mfma_f32_16x16x32_bf16 v[140:143], v[60:63], v[116:119], v[140:143]
    s_waitcnt vmcnt(8)
    s_barrier
    ds_read_b128 v[72:75], v8 offset:8192
    ds_read_b128 v[76:79], v8 offset:9216
    ds_read_b128 v[80:83], v8 offset:10240
    ds_read_b128 v[84:87], v8 offset:11264
    ds_read_b128 v[88:91], v8 offset:12288
    ds_read_b128 v[92:95], v8 offset:13312
    ds_read_b128 v[96:99], v8 offset:14336
    ds_read_b128 v[100:103], v8 offset:15360
    ds_read_b128 v[104:107], v8 offset:16384
    ds_read_b128 v[108:111], v8 offset:17408
    ds_read_b128 v[112:115], v8 offset:18432
    ds_read_b128 v[116:119], v8 offset:19456
    v_mfma_f32_16x16x32_bf16 v[144:147], v[152:155], v[64:67], v[144:147]
    v_mfma_f32_16x16x32_bf16 v[148:151], v[64:67], v[64:67], v[148:151]
    s_waitcnt lgkmcnt(11)
    v_mfma_f32_16x16x32_bf16 v[120:123], v[72:75], v[64:67], v[120:123]
    s_waitcnt lgkmcnt(10)
    v_mfma_f32_16x16x32_bf16 v[124:127], v[76:79], v[64:67], v[124:127]
    s_waitcnt lgkmcnt(9)
    v_mfma_f32_16x16x32_bf16 v[128:131], v[80:83], v[64:67], v[128:131]
    s_waitcnt lgkmcnt(8)
    v_mfma_f32_16x16x32_bf16 v[132:135], v[84:87], v[64:67], v[132:135]
    s_waitcnt lgkmcnt(7)
    v_mfma_f32_16x16x32_bf16 v[136:139], v[64:67], v[88:91], v[136:139]
    s_waitcnt lgkmcnt(6)
    v_mfma_f32_16x16x32_bf16 v[140:143], v[64:67], v[92:95], v[140:143]
    v_mfma_f32_16x16x32_bf16 v[144:147], v[152:155], v[68:71], v[144:147]
    v_mfma_f32_16x16x32_bf16 v[148:151], v[68:71], v[68:71], v[148:151]
    s_waitcnt lgkmcnt(5)
    v_mfma_f32_16x16x32_bf16 v[120:123], v[96:99], v[68:71], v[120:123]
    s_waitcnt lgkmcnt(4)
    v_mfma_f32_16x16x32_bf16 v[124:127], v[100:103], v[68:71], v[124:127]
    s_waitcnt lgkmcnt(3)
    v_mfma_f32_16x16x32_bf16 v[128:131], v[104:107], v[68:71], v[128:131]
    s_waitcnt lgkmcnt(2)
    v_mfma_f32_16x16x32_bf16 v[132:135], v[108:111], v[68:71], v[132:135]
    s_waitcnt lgkmcnt(1)
    v_mfma_f32_16x16x32_bf16 v[136:139], v[68:71], v[112:115], v[136:139]
    s_waitcnt lgkmcnt(0)
    v_mfma_f32_16x16x32_bf16 v[140:143], v[68:71], v[116:119], v[140:143]
    buffer_load_dword v14, v15, s[16:19], s31 offen offset:64 sc1
    v_cndmask_b32 v186, v148, v149, s[40:41]
    v_cndmask_b32 v186, v186, v150, s[42:43]
    v_cndmask_b32 v186, v186, v151, s[44:45]
    v_cndmask_b32 v186, 0, v186, s[46:47]
    v_mov_b32 v187, v186
    s_nop 1
    v_permlane16_swap_b32 v186, v187
    v_add_f32 v186, v186, v187
    v_mov_b32 v187, v186
    s_nop 1
    v_permlane32_swap_b32 v186, v187
    v_add_f32 v186, v186, v187
    v_mul_f32 v187, 991054117, v144
    v_mul_f32 v186, 991054117, v186
    v_fma_f32 v186, -v187, v187, v186
    v_max_f32 v186, 0, v186
    v_add_f32 v186, 925353388, v186
    v_rsq_f32 v185, v186
    s_nop 0
    v_mul_f32 v184, v187, v185
    v_sub_f32 v184, 0, v184
    s_lshl_b32 s26, s20, 7
    s_add_u32 s26, s26, 100352
    v_lshl_add_u32 v9, v3, 3, s26
    v_lshl_add_u32 v10, v4, 5, s26
    ds_write_b64 v9, v[184:185]
    s_waitcnt lgkmcnt(0)
    ds_read_b128 v[188:191], v10
    ds_read_b128 v[192:195], v10 offset:16
    s_waitcnt vmcnt(8)
    v_mul_f32 v204, v184, v156
    v_mul_f32 v205, v184, v157
    v_mul_f32 v206, v184, v158
    v_mul_f32 v207, v184, v159
    v_fmac_f32 v204, v120, v185
    v_fmac_f32 v205, v121, v185
    v_fmac_f32 v206, v122, v185
    v_fmac_f32 v207, v123, v185
    v_cvt_pk_bf16_f32 v196, v204, v205
    v_cvt_pk_bf16_f32 v197, v206, v207
    s_waitcnt vmcnt(7)
    v_mul_f32 v208, v184, v160
    v_mul_f32 v209, v184, v161
    v_mul_f32 v210, v184, v162
    v_mul_f32 v211, v184, v163
    v_fmac_f32 v208, v124, v185
    v_fmac_f32 v209, v125, v185
    v_fmac_f32 v210, v126, v185
    v_fmac_f32 v211, v127, v185
    v_cvt_pk_bf16_f32 v198, v208, v209
    v_cvt_pk_bf16_f32 v199, v210, v211
    s_waitcnt vmcnt(6)
    v_mul_f32 v204, v184, v164
    v_mul_f32 v205, v184, v165
    v_mul_f32 v206, v184, v166
    v_mul_f32 v207, v184, v167
    v_fmac_f32 v204, v128, v185
    v_fmac_f32 v205, v129, v185
    v_fmac_f32 v206, v130, v185
    v_fmac_f32 v207, v131, v185
    v_cvt_pk_bf16_f32 v200, v204, v205
    v_cvt_pk_bf16_f32 v201, v206, v207
    s_waitcnt vmcnt(5)
    v_mul_f32 v208, v184, v168
    v_mul_f32 v209, v184, v169
    v_mul_f32 v210, v184, v170
    v_mul_f32 v211, v184, v171
    v_fmac_f32 v208, v132, v185
    v_fmac_f32 v209, v133, v185
    v_fmac_f32 v210, v134, v185
    v_fmac_f32 v211, v135, v185
    v_cvt_pk_bf16_f32 v202, v208, v209
    v_cvt_pk_bf16_f32 v203, v210, v211
    s_waitcnt vmcnt(2)
    s_nop 0
    v_mfma_f32_16x16x32_bf16 v[128:131], v[200:203], v[216:219], 0
    s_waitcnt vmcnt(1)
    v_mfma_f32_16x16x32_bf16 v[132:135], v[200:203], v[220:223], 0
    v_mfma_f32_16x16x32_bf16 v[120:123], v[216:219], v[196:199], 0
    v_mfma_f32_16x16x32_bf16 v[124:127], v[220:223], v[196:199], 0
    s_waitcnt lgkmcnt(1)
    v_mul_f32 v204, v188, v172
    v_fmac_f32 v204, v136, v189
    v_mul_f32 v205, v190, v172
    v_fmac_f32 v205, v137, v191
    s_waitcnt lgkmcnt(0)
    v_mul_f32 v206, v192, v172
    v_fmac_f32 v206, v138, v193
    v_mul_f32 v207, v194, v172
    v_fmac_f32 v207, v139, v195
    v_cvt_pk_bf16_f32 v212, v204, v205
    v_cvt_pk_bf16_f32 v213, v206, v207
    v_mul_f32 v208, v188, v176
    v_fmac_f32 v208, v140, v189
    v_cndmask_b32 v208, v208, 1.0, s[50:51]
    v_mul_f32 v209, v190, v176
    v_fmac_f32 v209, v141, v191
    v_cndmask_b32 v209, v209, 1.0, s[50:51]
    v_mul_f32 v210, v192, v176
    v_fmac_f32 v210, v142, v193
    v_cndmask_b32 v210, v210, 1.0, s[50:51]
    v_mul_f32 v211, v194, v176
    v_fmac_f32 v211, v143, v195
    v_cndmask_b32 v211, v211, 1.0, s[50:51]
    v_cvt_pk_bf16_f32 v214, v208, v209
    v_cvt_pk_bf16_f32 v215, v210, v211
    v_mov_b32 v224, 4286578687
    v_mov_b32 v225, 2139095039
    s_mov_b32 s26, 1069066811
    v_cvt_pk_bf16_f32 v248, v128, v129
    v_cvt_pk_bf16_f32 v249, v130, v131
    v_cvt_pk_bf16_f32 v250, v132, v133
    v_cvt_pk_bf16_f32 v251, v134, v135
    v_lshlrev_b32 v128, 16, v248
    v_and_b32 v129, 4294901760, v248
    v_lshlrev_b32 v130, 16, v249
    v_and_b32 v131, 4294901760, v249
    v_lshlrev_b32 v132, 16, v250
    v_and_b32 v133, 4294901760, v250
    v_lshlrev_b32 v134, 16, v251
    v_and_b32 v135, 4294901760, v251
    v_cndmask_b32 v216, v132, v224, s[52:53]
    v_cndmask_b32 v220, v132, v225, s[52:53]
    v_cndmask_b32 v217, v133, v224, s[52:53]
    v_cndmask_b32 v221, v133, v225, s[52:53]
    v_cndmask_b32 v218, v134, v224, s[52:53]
    v_cndmask_b32 v222, v134, v225, s[52:53]
    v_cndmask_b32 v219, v135, v224, s[52:53]
    v_cndmask_b32 v223, v135, v225, s[52:53]
    v_max_f32 v248, v128, v216
    v_min_f32 v252, v128, v220
    v_max_f32 v249, v129, v217
    v_min_f32 v253, v129, v221
    v_max_f32 v250, v130, v218
    v_min_f32 v254, v130, v222
    v_max_f32 v251, v131, v219
    v_min_f32 v255, v131, v223
    v_max_f32_dpp v248, v248, v248 row_ror:8 row_mask:0xf bank_mask:0xf
    v_min_f32_dpp v252, v252, v252 row_ror:8 row_mask:0xf bank_mask:0xf
    v_max_f32_dpp v249, v249, v249 row_ror:8 row_mask:0xf bank_mask:0xf
    v_min_f32_dpp v253, v253, v253 row_ror:8 row_mask:0xf bank_mask:0xf
    v_max_f32_dpp v250, v250, v250 row_ror:8 row_mask:0xf bank_mask:0xf
    v_min_f32_dpp v254, v254, v254 row_ror:8 row_mask:0xf bank_mask:0xf
    v_max_f32_dpp v251, v251, v251 row_ror:8 row_mask:0xf bank_mask:0xf
    v_min_f32_dpp v255, v255, v255 row_ror:8 row_mask:0xf bank_mask:0xf
    v_max_f32_dpp v248, v248, v248 row_ror:4 row_mask:0xf bank_mask:0xf
    v_min_f32_dpp v252, v252, v252 row_ror:4 row_mask:0xf bank_mask:0xf
    v_max_f32_dpp v249, v249, v249 row_ror:4 row_mask:0xf bank_mask:0xf
    v_min_f32_dpp v253, v253, v253 row_ror:4 row_mask:0xf bank_mask:0xf
    v_max_f32_dpp v250, v250, v250 row_ror:4 row_mask:0xf bank_mask:0xf
    v_min_f32_dpp v254, v254, v254 row_ror:4 row_mask:0xf bank_mask:0xf
    v_max_f32_dpp v251, v251, v251 row_ror:4 row_mask:0xf bank_mask:0xf
    v_min_f32_dpp v255, v255, v255 row_ror:4 row_mask:0xf bank_mask:0xf
    v_max_f32_dpp v248, v248, v248 row_ror:2 row_mask:0xf bank_mask:0xf
    v_min_f32_dpp v252, v252, v252 row_ror:2 row_mask:0xf bank_mask:0xf
    v_max_f32_dpp v249, v249, v249 row_ror:2 row_mask:0xf bank_mask:0xf
    v_min_f32_dpp v253, v253, v253 row_ror:2 row_mask:0xf bank_mask:0xf
    v_max_f32_dpp v250, v250, v250 row_ror:2 row_mask:0xf bank_mask:0xf
    v_min_f32_dpp v254, v254, v254 row_ror:2 row_mask:0xf bank_mask:0xf
    v_max_f32_dpp v251, v251, v251 row_ror:2 row_mask:0xf bank_mask:0xf
    v_min_f32_dpp v255, v255, v255 row_ror:2 row_mask:0xf bank_mask:0xf
    v_max_f32_dpp v248, v248, v248 row_ror:1 row_mask:0xf bank_mask:0xf
    v_min_f32_dpp v252, v252, v252 row_ror:1 row_mask:0xf bank_mask:0xf
    v_max_f32_dpp v249, v249, v249 row_ror:1 row_mask:0xf bank_mask:0xf
    v_min_f32_dpp v253, v253, v253 row_ror:1 row_mask:0xf bank_mask:0xf
    v_max_f32_dpp v250, v250, v250 row_ror:1 row_mask:0xf bank_mask:0xf
    v_min_f32_dpp v254, v254, v254 row_ror:1 row_mask:0xf bank_mask:0xf
    v_max_f32_dpp v251, v251, v251 row_ror:1 row_mask:0xf bank_mask:0xf
    v_min_f32_dpp v255, v255, v255 row_ror:1 row_mask:0xf bank_mask:0xf
    v_mul_f32 v248, 1069066811, v248
    v_mul_f32 v252, 1069066811, v252
    v_mul_f32 v249, 1069066811, v249
    v_mul_f32 v253, 1069066811, v253
    v_mul_f32 v250, 1069066811, v250
    v_mul_f32 v254, 1069066811, v254
    v_mul_f32 v251, 1069066811, v251
    v_mul_f32 v255, 1069066811, v255
    v_fma_f32 v232, v128, s26, -v248
    v_fma_f32 v240, -v128, s26, v252
    v_fma_f32 v233, v129, s26, -v249
    v_fma_f32 v241, -v129, s26, v253
    v_fma_f32 v234, v130, s26, -v250
    v_fma_f32 v242, -v130, s26, v254
    v_fma_f32 v235, v131, s26, -v251
    v_fma_f32 v243, -v131, s26, v255
    v_fma_f32 v236, v216, s26, -v248
    v_fma_f32 v244, -v220, s26, v252
    v_fma_f32 v237, v217, s26, -v249
    v_fma_f32 v245, -v221, s26, v253
    v_fma_f32 v238, v218, s26, -v250
    v_fma_f32 v246, -v222, s26, v254
    v_fma_f32 v239, v219, s26, -v251
    v_fma_f32 v247, -v223, s26, v255
    v_exp_f32 v232, v232
    v_exp_f32 v240, v240
    v_exp_f32 v233, v233
    v_exp_f32 v241, v241
    v_exp_f32 v234, v234
    v_exp_f32 v242, v242
    v_exp_f32 v235, v235
    v_exp_f32 v243, v243
    v_exp_f32 v236, v236
    v_exp_f32 v244, v244
    v_exp_f32 v237, v237
    v_exp_f32 v245, v245
    v_exp_f32 v238, v238
    v_exp_f32 v246, v246
    v_exp_f32 v239, v239
    v_exp_f32 v247, v247
    v_add_f32 v248, v232, v236
    v_add_f32 v252, v240, v244
    v_add_f32 v249, v233, v237
    v_add_f32 v253, v241, v245
    v_add_f32 v250, v234, v238
    v_add_f32 v254, v242, v246
    v_add_f32 v251, v235, v239
    v_add_f32 v255, v243, v247
    v_add_f32_dpp v248, v248, v248 row_ror:8 row_mask:0xf bank_mask:0xf
    v_add_f32_dpp v252, v252, v252 row_ror:8 row_mask:0xf bank_mask:0xf
    v_add_f32_dpp v249, v249, v249 row_ror:8 row_mask:0xf bank_mask:0xf
    v_add_f32_dpp v253, v253, v253 row_ror:8 row_mask:0xf bank_mask:0xf
    v_add_f32_dpp v250, v250, v250 row_ror:8 row_mask:0xf bank_mask:0xf
    v_add_f32_dpp v254, v254, v254 row_ror:8 row_mask:0xf bank_mask:0xf
    v_add_f32_dpp v251, v251, v251 row_ror:8 row_mask:0xf bank_mask:0xf
    v_add_f32_dpp v255, v255, v255 row_ror:8 row_mask:0xf bank_mask:0xf
    v_add_f32_dpp v248, v248, v248 row_ror:4 row_mask:0xf bank_mask:0xf
    v_add_f32_dpp v252, v252, v252 row_ror:4 row_mask:0xf bank_mask:0xf
    v_add_f32_dpp v249, v249, v249 row_ror:4 row_mask:0xf bank_mask:0xf
    v_add_f32_dpp v253, v253, v253 row_ror:4 row_mask:0xf bank_mask:0xf
    v_add_f32_dpp v250, v250, v250 row_ror:4 row_mask:0xf bank_mask:0xf
    v_add_f32_dpp v254, v254, v254 row_ror:4 row_mask:0xf bank_mask:0xf
    v_add_f32_dpp v251, v251, v251 row_ror:4 row_mask:0xf bank_mask:0xf
    v_add_f32_dpp v255, v255, v255 row_ror:4 row_mask:0xf bank_mask:0xf
    v_add_f32_dpp v248, v248, v248 row_ror:2 row_mask:0xf bank_mask:0xf
    v_add_f32_dpp v252, v252, v252 row_ror:2 row_mask:0xf bank_mask:0xf
    v_add_f32_dpp v249, v249, v249 row_ror:2 row_mask:0xf bank_mask:0xf
    v_add_f32_dpp v253, v253, v253 row_ror:2 row_mask:0xf bank_mask:0xf
    v_add_f32_dpp v250, v250, v250 row_ror:2 row_mask:0xf bank_mask:0xf
    v_add_f32_dpp v254, v254, v254 row_ror:2 row_mask:0xf bank_mask:0xf
    v_add_f32_dpp v251, v251, v251 row_ror:2 row_mask:0xf bank_mask:0xf
    v_add_f32_dpp v255, v255, v255 row_ror:2 row_mask:0xf bank_mask:0xf
    v_add_f32_dpp v248, v248, v248 row_ror:1 row_mask:0xf bank_mask:0xf
    v_add_f32_dpp v252, v252, v252 row_ror:1 row_mask:0xf bank_mask:0xf
    v_add_f32_dpp v249, v249, v249 row_ror:1 row_mask:0xf bank_mask:0xf
    v_add_f32_dpp v253, v253, v253 row_ror:1 row_mask:0xf bank_mask:0xf
    v_add_f32_dpp v250, v250, v250 row_ror:1 row_mask:0xf bank_mask:0xf
    v_add_f32_dpp v254, v254, v254 row_ror:1 row_mask:0xf bank_mask:0xf
    v_add_f32_dpp v251, v251, v251 row_ror:1 row_mask:0xf bank_mask:0xf
    v_add_f32_dpp v255, v255, v255 row_ror:1 row_mask:0xf bank_mask:0xf
    v_rcp_f32 v248, v248
    v_rcp_f32 v252, v252
    v_rcp_f32 v249, v249
    v_rcp_f32 v253, v253
    v_rcp_f32 v250, v250
    v_rcp_f32 v254, v254
    v_rcp_f32 v251, v251
    v_rcp_f32 v255, v255
    v_mul_f32 v232, v232, v248
    v_mul_f32 v240, v240, v252
    v_mul_f32 v233, v233, v249
    v_mul_f32 v241, v241, v253
    v_mul_f32 v234, v234, v250
    v_mul_f32 v242, v242, v254
    v_mul_f32 v235, v235, v251
    v_mul_f32 v243, v243, v255
    v_mul_f32 v236, v236, v248
    v_mul_f32 v244, v244, v252
    v_mul_f32 v237, v237, v249
    v_mul_f32 v245, v245, v253
    v_mul_f32 v238, v238, v250
    v_mul_f32 v246, v246, v254
    v_mul_f32 v239, v239, v251
    v_mul_f32 v247, v247, v255
    v_cvt_pk_bf16_f32 v72, v232, v233
    v_cvt_pk_bf16_f32 v73, v234, v235
    v_cvt_pk_bf16_f32 v76, v240, v241
    v_cvt_pk_bf16_f32 v77, v242, v243
    v_cvt_pk_bf16_f32 v74, v236, v237
    v_cvt_pk_bf16_f32 v75, v238, v239
    v_cvt_pk_bf16_f32 v78, v244, v245
    v_cvt_pk_bf16_f32 v79, v246, v247
    s_mul_i32 s27, s20, 3072
    s_add_u32 s27, s27, 101376
    v_lshl_add_u32 v9, v1, 3, s27
    ds_write_b64 v9, v[72:73] offset:0
    ds_write_b64 v9, v[74:75] offset:512
    ds_write_b64 v9, v[76:77] offset:1024
    ds_write_b64 v9, v[78:79] offset:1536
    ds_write_b64 v9, v[212:213] offset:2048
    ds_write_b64 v9, v[214:215] offset:2560
    v_cvt_pk_bf16_f32 v204, v120, v121
    v_cvt_pk_bf16_f32 v205, v122, v123
    v_cvt_pk_bf16_f32 v206, v124, v125
    v_cvt_pk_bf16_f32 v207, v126, v127
    v_lshlrev_b32 v120, 16, v204
    v_and_b32 v121, 4294901760, v204
    v_lshlrev_b32 v122, 16, v205
    v_and_b32 v123, 4294901760, v205
    v_lshlrev_b32 v124, 16, v206
    v_and_b32 v125, 4294901760, v206
    v_lshlrev_b32 v126, 16, v207
    v_and_b32 v127, 4294901760, v207
    v_cndmask_b32 v216, v124, v224, s[48:49]
    v_cndmask_b32 v220, v124, v225, s[48:49]
    v_cndmask_b32 v217, v125, v224, s[48:49]
    v_cndmask_b32 v221, v125, v225, s[48:49]
    v_cndmask_b32 v218, v126, v224, s[48:49]
    v_cndmask_b32 v222, v126, v225, s[48:49]
    v_cndmask_b32 v219, v127, v224, s[48:49]
    v_cndmask_b32 v223, v127, v225, s[48:49]
    v_max3_f32 v226, v120, v121, v122
    v_min3_f32 v227, v120, v121, v122
    v_max3_f32 v226, v226, v123, v216
    v_min3_f32 v227, v227, v123, v220
    v_max3_f32 v226, v226, v217, v218
    v_min3_f32 v227, v227, v221, v222
    v_max_f32 v226, v226, v219
    v_min_f32 v227, v227, v223
    s_waitcnt lgkmcnt(0)
    s_barrier
    s_and_b32 s27, s20, 3
    s_lshl_b32 s27, s27, 9
    s_lshr_b32 s28, s20, 2
    s_lshl_b32 s28, s28, 9
    s_add_u32 s28, s28, 2048
    s_add_u32 s27, s27, 101376
    s_add_u32 s28, s28, 101376
    v_lshl_add_u32 v9, v1, 3, s27
    v_lshl_add_u32 v10, v1, 3, s28
    ds_read_b64 v[88:89], v9 offset:0
    ds_read_b64 v[104:105], v10 offset:0
    ds_read_b64 v[90:91], v9 offset:3072
    ds_read_b64 v[106:107], v10 offset:3072
    ds_read_b64 v[92:93], v9 offset:6144
    ds_read_b64 v[108:109], v10 offset:6144
    ds_read_b64 v[94:95], v9 offset:9216
    ds_read_b64 v[110:111], v10 offset:9216
    ds_read_b64 v[96:97], v9 offset:12288
    ds_read_b64 v[112:113], v10 offset:12288
    ds_read_b64 v[98:99], v9 offset:15360
    ds_read_b64 v[114:115], v10 offset:15360
    ds_read_b64 v[100:101], v9 offset:18432
    ds_read_b64 v[116:117], v10 offset:18432
    ds_read_b64 v[102:103], v9 offset:21504
    ds_read_b64 v[118:119], v10 offset:21504
    v_mov_b32 v228, v226
    v_mov_b32 v231, v227
    s_nop 0
    v_permlane16_swap_b32 v226, v228
    v_permlane16_swap_b32 v227, v231
    v_max_f32 v226, v226, v228
    v_min_f32 v227, v227, v231
    v_mov_b32 v228, v226
    v_mov_b32 v231, v227
    s_nop 0
    v_permlane32_swap_b32 v226, v228
    v_permlane32_swap_b32 v227, v231
    v_max_f32 v226, v226, v228
    v_min_f32 v227, v227, v231
    v_mul_f32 v226, 1069066811, v226
    v_mul_f32 v227, 1069066811, v227
    v_fma_f32 v232, v120, s26, -v226
    v_fma_f32 v240, -v120, s26, v227
    v_fma_f32 v233, v121, s26, -v226
    v_fma_f32 v241, -v121, s26, v227
    v_fma_f32 v234, v122, s26, -v226
    v_fma_f32 v242, -v122, s26, v227
    v_fma_f32 v235, v123, s26, -v226
    v_fma_f32 v243, -v123, s26, v227
    v_fma_f32 v236, v216, s26, -v226
    v_fma_f32 v244, -v220, s26, v227
    v_fma_f32 v237, v217, s26, -v226
    v_fma_f32 v245, -v221, s26, v227
    v_fma_f32 v238, v218, s26, -v226
    v_fma_f32 v246, -v222, s26, v227
    v_fma_f32 v239, v219, s26, -v226
    v_fma_f32 v247, -v223, s26, v227
    s_waitcnt lgkmcnt(14)
    v_mfma_f32_16x16x16_bf16 v[72:75], v[88:89], v[104:105], 0
    s_waitcnt lgkmcnt(12)
    v_mfma_f32_16x16x16_bf16 v[72:75], v[90:91], v[106:107], v[72:75]
    s_waitcnt lgkmcnt(10)
    v_mfma_f32_16x16x16_bf16 v[72:75], v[92:93], v[108:109], v[72:75]
    s_waitcnt lgkmcnt(8)
    v_mfma_f32_16x16x16_bf16 v[72:75], v[94:95], v[110:111], v[72:75]
    s_waitcnt lgkmcnt(6)
    v_mfma_f32_16x16x16_bf16 v[72:75], v[96:97], v[112:113], v[72:75]
    s_waitcnt lgkmcnt(4)
    v_mfma_f32_16x16x16_bf16 v[72:75], v[98:99], v[114:115], v[72:75]
    s_waitcnt lgkmcnt(2)
    v_mfma_f32_16x16x16_bf16 v[72:75], v[100:101], v[116:117], v[72:75]
    s_waitcnt lgkmcnt(0)
    v_mfma_f32_16x16x16_bf16 v[72:75], v[102:103], v[118:119], v[72:75]
    v_exp_f32 v232, v232
    v_exp_f32 v240, v240
    v_exp_f32 v233, v233
    v_exp_f32 v241, v241
    v_exp_f32 v234, v234
    v_exp_f32 v242, v242
    v_exp_f32 v235, v235
    v_exp_f32 v243, v243
    v_exp_f32 v236, v236
    v_exp_f32 v244, v244
    v_exp_f32 v237, v237
    v_exp_f32 v245, v245
    v_exp_f32 v238, v238
    v_exp_f32 v246, v246
    v_exp_f32 v239, v239
    v_exp_f32 v247, v247
    v_add_f32 v229, v232, v233
    v_add_f32 v230, v240, v241
    v_add_f32 v229, v229, v234
    v_add_f32 v230, v230, v242
    v_add_f32 v229, v229, v235
    v_add_f32 v230, v230, v243
    v_add_f32 v229, v229, v236
    v_add_f32 v230, v230, v244
    v_add_f32 v229, v229, v237
    v_add_f32 v230, v230, v245
    v_add_f32 v229, v229, v238
    v_add_f32 v230, v230, v246
    v_add_f32 v229, v229, v239
    v_add_f32 v230, v230, v247
    s_lshl_b32 s27, s22, 13
    s_lshl_b32 s28, s20, 10
    s_add_u32 s27, s27, s28
    s_add_u32 s27, s27, 21102592
    v_lshlrev_b32 v9, 2, v1
    s_waitcnt vmcnt(0)
    v_readfirstlane_b32 s28, v14
    s_nop 3
    s_cmp_lg_u32 s28, 0
    s_cbranch_scc1 L_flagok_k1b_kernel
    s_nop 4
L_spin_k1b_kernel:
    s_sleep 2
    buffer_load_dword v14, v15, s[16:19], s31 offen offset:64 sc1
    s_waitcnt vmcnt(0) lgkmcnt(0)
    v_readfirstlane_b32 s28, v14
    s_nop 3
    s_cmp_eq_u32 s28, 0
    s_cbranch_scc1 L_spin_k1b_kernel
    s_nop 4
L_flagok_k1b_kernel:
    buffer_atomic_add_f32 v72, v9, s[8:11], s27 offen offset:0
    buffer_atomic_add_f32 v73, v9, s[8:11], s27 offen offset:256
    buffer_atomic_add_f32 v74, v9, s[8:11], s27 offen offset:512
    buffer_atomic_add_f32 v75, v9, s[8:11], s27 offen offset:768
    v_mov_b32 v228, v229
    v_mov_b32 v231, v230
    s_nop 0
    v_permlane16_swap_b32 v229, v228
    v_permlane16_swap_b32 v230, v231
    v_add_f32 v229, v229, v228
    v_add_f32 v230, v230, v231
    v_mov_b32 v228, v229
    v_mov_b32 v231, v230
    s_nop 0
    v_permlane32_swap_b32 v229, v228
    v_permlane32_swap_b32 v230, v231
    v_add_f32 v229, v229, v228
    v_add_f32 v230, v230, v231
    v_rcp_f32 v229, v229
    v_rcp_f32 v230, v230
    v_mul_f32 v232, v232, v229
    v_mul_f32 v240, v240, v230
    v_mul_f32 v233, v233, v229
    v_mul_f32 v241, v241, v230
    v_mul_f32 v234, v234, v229
    v_mul_f32 v242, v242, v230
    v_mul_f32 v235, v235, v229
    v_mul_f32 v243, v243, v230
    v_mul_f32 v236, v236, v229
    v_mul_f32 v244, v244, v230
    v_mul_f32 v237, v237, v229
    v_mul_f32 v245, v245, v230
    v_mul_f32 v238, v238, v229
    v_mul_f32 v246, v246, v230
    v_mul_f32 v239, v239, v229
    v_mul_f32 v247, v247, v230
    v_cvt_pk_bf16_f32 v204, v232, v233
    v_cvt_pk_bf16_f32 v208, v240, v241
    v_cvt_pk_bf16_f32 v205, v234, v235
    v_cvt_pk_bf16_f32 v209, v242, v243
    v_cvt_pk_bf16_f32 v206, v236, v237
    v_cvt_pk_bf16_f32 v210, v244, v245
    v_cvt_pk_bf16_f32 v207, v238, v239
    v_cvt_pk_bf16_f32 v211, v246, v247
    s_lshl_b32 s27, s23, 4
    s_add_u32 s27, s27, s22
    s_lshl_b32 s27, s27, 11
    s_add_u32 s27, s27, 16777216
    buffer_store_dwordx4 v[204:207], v5, s[8:11], s27 offen
    buffer_store_dwordx4 v[208:211], v5, s[8:11], s27 offen offset:1024
    s_nop 4
L_end_k1b_kernel:
    s_endpgm

.globl k2b_kernel
.p2align 8
.type k2b_kernel,@function
k2b_kernel:
    s_cmp_ge_u32 s2, 224
    s_cbranch_scc1 L_end_k2b_kernel
    s_load_dwordx2 s[4:5], s[0:1], 88
    v_and_b32 v1, 63, v0
    v_lshrrev_b32 v2, 6, v0
    s_nop 0
    v_readfirstlane_b32 s20, v2
    v_and_b32 v3, 15, v1
    v_lshrrev_b32 v4, 4, v1
    v_lshlrev_b32 v5, 4, v1
    s_waitcnt lgkmcnt(0)
    s_mov_b32 s8, s4
    s_and_b32 s9, s5, 65535
    s_mov_b32 s10, 268435456
    s_mov_b32 s11, 131072
    s_and_b32 s26, s2, 7
    s_lshr_b32 s27, s2, 3
    s_mul_i32 s28, s27, 37
    s_lshr_b32 s28, s28, 8
    s_mul_i32 s22, s28, 7
    s_sub_u32 s22, s27, s22
    s_lshl_b32 s21, s26, 2
    s_add_u32 s21, s21, s28
    v_lshlrev_b32 v7, 2, v1
    v_cmp_eq_u32 s[48:49], 3, v4
    s_lshl_b32 s26, s20, 1
    s_add_u32 s26, s26, 0
    s_lshl_b32 s27, s26, 13
    s_add_u32 s27, s27, 21102592
    buffer_load_dword v128, v7, s[8:11], s27 offen offset:0
    buffer_load_dword v129, v7, s[8:11], s27 offen offset:256
    buffer_load_dword v130, v7, s[8:11], s27 offen offset:512
    buffer_load_dword v131, v7, s[8:11], s27 offen offset:768
    buffer_load_dword v132, v7, s[8:11], s27 offen offset:1024
    buffer_load_dword v133, v7, s[8:11], s27 offen offset:1280
    buffer_load_dword v134, v7, s[8:11], s27 offen offset:1536
    buffer_load_dword v135, v7, s[8:11], s27 offen offset:1792
    buffer_load_dword v136, v7, s[8:11], s27 offen offset:2048
    buffer_load_dword v137, v7, s[8:11], s27 offen offset:2304
    buffer_load_dword v138, v7, s[8:11], s27 offen offset:2560
    buffer_load_dword v139, v7, s[8:11], s27 offen offset:2816
    buffer_load_dword v140, v7, s[8:11], s27 offen offset:3072
    buffer_load_dword v141, v7, s[8:11], s27 offen offset:3328
    buffer_load_dword v142, v7, s[8:11], s27 offen offset:3584
    buffer_load_dword v143, v7, s[8:11], s27 offen offset:3840
    s_add_u32 s27, s27, 4096
    buffer_load_dword v144, v7, s[8:11], s27 offen offset:0
    buffer_load_dword v145, v7, s[8:11], s27 offen offset:256
    buffer_load_dword v146, v7, s[8:11], s27 offen offset:512
    buffer_load_dword v147, v7, s[8:11], s27 offen offset:768
    buffer_load_dword v148, v7, s[8:11], s27 offen offset:1024
    buffer_load_dword v149, v7, s[8:11], s27 offen offset:1280
    buffer_load_dword v150, v7, s[8:11], s27 offen offset:1536
    buffer_load_dword v151, v7, s[8:11], s27 offen offset:1792
    buffer_load_dword v152, v7, s[8:11], s27 offen offset:2048
    buffer_load_dword v153, v7, s[8:11], s27 offen offset:2304
    buffer_load_dword v154, v7, s[8:11], s27 offen offset:2560
    buffer_load_dword v155, v7, s[8:11], s27 offen offset:2816
    buffer_load_dword v156, v7, s[8:11], s27 offen offset:3072
    buffer_load_dword v157, v7, s[8:11], s27 offen offset:3328
    buffer_load_dword v158, v7, s[8:11], s27 offen offset:3584
    buffer_load_dword v159, v7, s[8:11], s27 offen offset:3840
    s_lshl_b32 s27, s21, 17
    s_lshl_b32 s28, s26, 11
    s_add_u32 s27, s27, s28
    s_add_u32 s27, s27, 16777216
    buffer_load_dwordx4 v[192:195], v5, s[8:11], s27 offen offset:0
    buffer_load_dwordx4 v[196:199], v5, s[8:11], s27 offen offset:1024
    s_add_u32 s27, s27, 32768
    buffer_load_dwordx4 v[200:203], v5, s[8:11], s27 offen offset:0
    buffer_load_dwordx4 v[204:207], v5, s[8:11], s27 offen offset:1024
    s_add_u32 s27, s27, 32768
    buffer_load_dwordx4 v[208:211], v5, s[8:11], s27 offen offset:0
    buffer_load_dwordx4 v[212:215], v5, s[8:11], s27 offen offset:1024
    s_add_u32 s27, s27, 32768
    buffer_load_dwordx4 v[216:219], v5, s[8:11], s27 offen offset:0
    buffer_load_dwordx4 v[220:223], v5, s[8:11], s27 offen offset:1024
    s_lshl_b32 s27, s22, 16
    s_lshl_b32 s28, s26, 10
    s_add_u32 s27, s27, s28
    s_add_u32 s27, s27, 24182784
    buffer_load_dwordx4 v[16:19], v5, s[8:11], s27 offen
    s_add_u32 s27, s27, 16384
    buffer_load_dwordx4 v[20:23], v5, s[8:11], s27 offen
    s_add_u32 s27, s27, 16384
    buffer_load_dwordx4 v[24:27], v5, s[8:11], s27 offen
    s_add_u32 s27, s27, 16384
    buffer_load_dwordx4 v[28:31], v5, s[8:11], s27 offen
    s_lshl_b32 s26, s20, 1
    s_add_u32 s26, s26, 1
    s_lshl_b32 s27, s26, 13
    s_add_u32 s27, s27, 21102592
    buffer_load_dword v160, v7, s[8:11], s27 offen offset:0
    buffer_load_dword v161, v7, s[8:11], s27 offen offset:256
    buffer_load_dword v162, v7, s[8:11], s27 offen offset:512
    buffer_load_dword v163, v7, s[8:11], s27 offen offset:768
    buffer_load_dword v164, v7, s[8:11], s27 offen offset:1024
    buffer_load_dword v165, v7, s[8:11], s27 offen offset:1280
    buffer_load_dword v166, v7, s[8:11], s27 offen offset:1536
    buffer_load_dword v167, v7, s[8:11], s27 offen offset:1792
    buffer_load_dword v168, v7, s[8:11], s27 offen offset:2048
    buffer_load_dword v169, v7, s[8:11], s27 offen offset:2304
    buffer_load_dword v170, v7, s[8:11], s27 offen offset:2560
    buffer_load_dword v171, v7, s[8:11], s27 offen offset:2816
    buffer_load_dword v172, v7, s[8:11], s27 offen offset:3072
    buffer_load_dword v173, v7, s[8:11], s27 offen offset:3328
    buffer_load_dword v174, v7, s[8:11], s27 offen offset:3584
    buffer_load_dword v175, v7, s[8:11], s27 offen offset:3840
    s_add_u32 s27, s27, 4096
    buffer_load_dword v176, v7, s[8:11], s27 offen offset:0
    buffer_load_dword v177, v7, s[8:11], s27 offen offset:256
    buffer_load_dword v178, v7, s[8:11], s27 offen offset:512
    buffer_load_dword v179, v7, s[8:11], s27 offen offset:768
    buffer_load_dword v180, v7, s[8:11], s27 offen offset:1024
    buffer_load_dword v181, v7, s[8:11], s27 offen offset:1280
    buffer_load_dword v182, v7, s[8:11], s27 offen offset:1536
    buffer_load_dword v183, v7, s[8:11], s27 offen offset:1792
    buffer_load_dword v184, v7, s[8:11], s27 offen offset:2048
    buffer_load_dword v185, v7, s[8:11], s27 offen offset:2304
    buffer_load_dword v186, v7, s[8:11], s27 offen offset:2560
    buffer_load_dword v187, v7, s[8:11], s27 offen offset:2816
    buffer_load_dword v188, v7, s[8:11], s27 offen offset:3072
    buffer_load_dword v189, v7, s[8:11], s27 offen offset:3328
    buffer_load_dword v190, v7, s[8:11], s27 offen offset:3584
    buffer_load_dword v191, v7, s[8:11], s27 offen offset:3840
    s_lshl_b32 s27, s21, 17
    s_lshl_b32 s28, s26, 11
    s_add_u32 s27, s27, s28
    s_add_u32 s27, s27, 16777216
    buffer_load_dwordx4 v[224:227], v5, s[8:11], s27 offen offset:0
    buffer_load_dwordx4 v[228:231], v5, s[8:11], s27 offen offset:1024
    s_add_u32 s27, s27, 32768
    buffer_load_dwordx4 v[232:235], v5, s[8:11], s27 offen offset:0
    buffer_load_dwordx4 v[236:239], v5, s[8:11], s27 offen offset:1024
    s_add_u32 s27, s27, 32768
    buffer_load_dwordx4 v[240:243], v5, s[8:11], s27 offen offset:0
    buffer_load_dwordx4 v[244:247], v5, s[8:11], s27 offen offset:1024
    s_add_u32 s27, s27, 32768
    buffer_load_dwordx4 v[248:251], v5, s[8:11], s27 offen offset:0
    buffer_load_dwordx4 v[252:255], v5, s[8:11], s27 offen offset:1024
    s_lshl_b32 s27, s22, 16
    s_lshl_b32 s28, s26, 10
    s_add_u32 s27, s27, s28
    s_add_u32 s27, s27, 24182784
    buffer_load_dwordx4 v[32:35], v5, s[8:11], s27 offen
    s_add_u32 s27, s27, 16384
    buffer_load_dwordx4 v[36:39], v5, s[8:11], s27 offen
    s_add_u32 s27, s27, 16384
    buffer_load_dwordx4 v[40:43], v5, s[8:11], s27 offen
    s_add_u32 s27, s27, 16384
    buffer_load_dwordx4 v[44:47], v5, s[8:11], s27 offen
    s_waitcnt vmcnt(63)
    v_cvt_pk_bf16_f32 v128, v128, v129
    v_cvt_pk_bf16_f32 v129, v130, v131
    v_cvt_pk_bf16_f32 v130, v132, v133
    v_cvt_pk_bf16_f32 v131, v134, v135
    v_cvt_pk_bf16_f32 v132, v136, v137
    v_cvt_pk_bf16_f32 v133, v138, v139
    v_cvt_pk_bf16_f32 v134, v140, v141
    v_cvt_pk_bf16_f32 v135, v142, v143
    v_cvt_pk_bf16_f32 v136, v144, v145
    v_cvt_pk_bf16_f32 v137, v146, v147
    v_cvt_pk_bf16_f32 v138, v148, v149
    v_cvt_pk_bf16_f32 v139, v150, v151
    s_waitcnt vmcnt(62)
    v_cvt_pk_bf16_f32 v140, v152, v153
    s_waitcnt vmcnt(60)
    v_cvt_pk_bf16_f32 v141, v154, v155
    s_waitcnt vmcnt(58)
    v_cvt_pk_bf16_f32 v142, v156, v157
    s_waitcnt vmcnt(56)
    v_cvt_pk_bf16_f32 v143, v158, v159
    s_waitcnt vmcnt(55)
    v_mfma_f32_16x16x32_bf16 v[48:51], v[128:131], v[192:195], 0
    s_waitcnt vmcnt(54)
    v_mfma_f32_16x16x32_bf16 v[48:51], v[132:135], v[196:199], v[48:51]
    v_mfma_f32_16x16x32_bf16 v[52:55], v[136:139], v[192:195], 0
    v_mfma_f32_16x16x32_bf16 v[52:55], v[140:143], v[196:199], v[52:55]
    s_waitcnt vmcnt(53)
    v_mfma_f32_16x16x32_bf16 v[56:59], v[128:131], v[200:203], 0
    s_waitcnt vmcnt(52)
    v_mfma_f32_16x16x32_bf16 v[56:59], v[132:135], v[204:207], v[56:59]
    v_mfma_f32_16x16x32_bf16 v[60:63], v[136:139], v[200:203], 0
    v_mfma_f32_16x16x32_bf16 v[60:63], v[140:143], v[204:207], v[60:63]
    v_cvt_pk_bf16_f32 v152, v48, v49
    v_cvt_pk_bf16_f32 v153, v50, v51
    v_cvt_pk_bf16_f32 v154, v52, v53
    v_cvt_pk_bf16_f32 v155, v54, v55
    v_lshlrev_b32 v48, 16, v152
    v_and_b32 v49, 4294901760, v152
    v_lshlrev_b32 v50, 16, v153
    v_and_b32 v51, 4294901760, v153
    v_lshlrev_b32 v52, 16, v154
    v_and_b32 v53, 4294901760, v154
    v_lshlrev_b32 v54, 16, v155
    v_and_b32 v55, 4294901760, v155
    v_cndmask_b32 v156, 0, v52, s[48:49]
    v_mov_b32 v157, v156
    s_nop 1
    v_permlane16_swap_b32 v156, v157
    v_add_f32 v156, v156, v157
    v_mov_b32 v157, v156
    s_nop 1
    v_permlane32_swap_b32 v156, v157
    v_add_f32 v156, v156, v157
    v_add_f32 v156, 897988541, v156
    v_cvt_pk_bf16_f32 v156, v156, v156
    v_lshlrev_b32 v156, 16, v156
    v_rcp_f32 v156, v156
    s_nop 0
    v_mul_f32 v48, v48, v156
    v_mul_f32 v49, v49, v156
    v_mul_f32 v50, v50, v156
    v_mul_f32 v51, v51, v156
    v_mul_f32 v52, v52, v156
    v_mul_f32 v53, v53, v156
    v_mul_f32 v54, v54, v156
    v_mul_f32 v55, v55, v156
    v_cvt_pk_bf16_f32 v144, v48, v49
    v_cvt_pk_bf16_f32 v145, v50, v51
    v_cvt_pk_bf16_f32 v146, v52, v53
    v_cvt_pk_bf16_f32 v147, v54, v55
    v_cvt_pk_bf16_f32 v152, v56, v57
    v_cvt_pk_bf16_f32 v153, v58, v59
    v_cvt_pk_bf16_f32 v154, v60, v61
    v_cvt_pk_bf16_f32 v155, v62, v63
    v_lshlrev_b32 v56, 16, v152
    v_and_b32 v57, 4294901760, v152
    v_lshlrev_b32 v58, 16, v153
    v_and_b32 v59, 4294901760, v153
    v_lshlrev_b32 v60, 16, v154
    v_and_b32 v61, 4294901760, v154
    v_lshlrev_b32 v62, 16, v155
    v_and_b32 v63, 4294901760, v155
    v_cndmask_b32 v156, 0, v60, s[48:49]
    v_mov_b32 v157, v156
    s_nop 1
    v_permlane16_swap_b32 v156, v157
    v_add_f32 v156, v156, v157
    v_mov_b32 v157, v156
    s_nop 1
    v_permlane32_swap_b32 v156, v157
    v_add_f32 v156, v156, v157
    v_add_f32 v156, 897988541, v156
    v_cvt_pk_bf16_f32 v156, v156, v156
    v_lshlrev_b32 v156, 16, v156
    v_rcp_f32 v156, v156
    s_nop 0
    v_mul_f32 v56, v56, v156
    v_mul_f32 v57, v57, v156
    v_mul_f32 v58, v58, v156
    v_mul_f32 v59, v59, v156
    v_mul_f32 v60, v60, v156
    v_mul_f32 v61, v61, v156
    v_mul_f32 v62, v62, v156
    v_mul_f32 v63, v63, v156
    v_cvt_pk_bf16_f32 v148, v56, v57
    v_cvt_pk_bf16_f32 v149, v58, v59
    v_cvt_pk_bf16_f32 v150, v60, v61
    v_cvt_pk_bf16_f32 v151, v62, v63
    s_waitcnt vmcnt(47)
    v_mfma_f32_16x16x32_bf16 v[64:67], v[16:19], v[144:147], 0
    s_waitcnt vmcnt(46)
    v_mfma_f32_16x16x32_bf16 v[68:71], v[20:23], v[144:147], 0
    s_waitcnt vmcnt(45)
    v_mfma_f32_16x16x32_bf16 v[72:75], v[24:27], v[144:147], 0
    s_waitcnt vmcnt(44)
    v_mfma_f32_16x16x32_bf16 v[76:79], v[28:31], v[144:147], 0
    v_mfma_f32_16x16x32_bf16 v[80:83], v[16:19], v[148:151], 0
    v_mfma_f32_16x16x32_bf16 v[84:87], v[20:23], v[148:151], 0
    v_mfma_f32_16x16x32_bf16 v[88:91], v[24:27], v[148:151], 0
    v_mfma_f32_16x16x32_bf16 v[92:95], v[28:31], v[148:151], 0
    v_mfma_f32_16x16x32_bf16 v[48:51], v[128:131], v[208:211], 0
    v_mfma_f32_16x16x32_bf16 v[48:51], v[132:135], v[212:215], v[48:51]
    v_mfma_f32_16x16x32_bf16 v[52:55], v[136:139], v[208:211], 0
    v_mfma_f32_16x16x32_bf16 v[52:55], v[140:143], v[212:215], v[52:55]
    v_mfma_f32_16x16x32_bf16 v[56:59], v[128:131], v[216:219], 0
    v_mfma_f32_16x16x32_bf16 v[56:59], v[132:135], v[220:223], v[56:59]
    v_mfma_f32_16x16x32_bf16 v[60:63], v[136:139], v[216:219], 0
    v_mfma_f32_16x16x32_bf16 v[60:63], v[140:143], v[220:223], v[60:63]
    s_nop 1
    v_cvt_pk_bf16_f32 v152, v48, v49
    v_cvt_pk_bf16_f32 v153, v50, v51
    v_cvt_pk_bf16_f32 v154, v52, v53
    v_cvt_pk_bf16_f32 v155, v54, v55
    v_lshlrev_b32 v48, 16, v152
    v_and_b32 v49, 4294901760, v152
    v_lshlrev_b32 v50, 16, v153
    v_and_b32 v51, 4294901760, v153
    v_lshlrev_b32 v52, 16, v154
    v_and_b32 v53, 4294901760, v154
    v_lshlrev_b32 v54, 16, v155
    v_and_b32 v55, 4294901760, v155
    v_cndmask_b32 v156, 0, v52, s[48:49]
    v_mov_b32 v157, v156
    s_nop 1
    v_permlane16_swap_b32 v156, v157
    v_add_f32 v156, v156, v157
    v_mov_b32 v157, v156
    s_nop 1
    v_permlane32_swap_b32 v156, v157
    v_add_f32 v156, v156, v157
    v_add_f32 v156, 897988541, v156
    v_cvt_pk_bf16_f32 v156, v156, v156
    v_lshlrev_b32 v156, 16, v156
    v_rcp_f32 v156, v156
    s_nop 0
    v_mul_f32 v48, v48, v156
    v_mul_f32 v49, v49, v156
    v_mul_f32 v50, v50, v156
    v_mul_f32 v51, v51, v156
    v_mul_f32 v52, v52, v156
    v_mul_f32 v53, v53, v156
    v_mul_f32 v54, v54, v156
    v_mul_f32 v55, v55, v156
    v_cvt_pk_bf16_f32 v144, v48, v49
    v_cvt_pk_bf16_f32 v145, v50, v51
    v_cvt_pk_bf16_f32 v146, v52, v53
    v_cvt_pk_bf16_f32 v147, v54, v55
    v_cvt_pk_bf16_f32 v152, v56, v57
    v_cvt_pk_bf16_f32 v153, v58, v59
    v_cvt_pk_bf16_f32 v154, v60, v61
    v_cvt_pk_bf16_f32 v155, v62, v63
    v_lshlrev_b32 v56, 16, v152
    v_and_b32 v57, 4294901760, v152
    v_lshlrev_b32 v58, 16, v153
    v_and_b32 v59, 4294901760, v153
    v_lshlrev_b32 v60, 16, v154
    v_and_b32 v61, 4294901760, v154
    v_lshlrev_b32 v62, 16, v155
    v_and_b32 v63, 4294901760, v155
    v_cndmask_b32 v156, 0, v60, s[48:49]
    v_mov_b32 v157, v156
    s_nop 1
    v_permlane16_swap_b32 v156, v157
    v_add_f32 v156, v156, v157
    v_mov_b32 v157, v156
    s_nop 1
    v_permlane32_swap_b32 v156, v157
    v_add_f32 v156, v156, v157
    v_add_f32 v156, 897988541, v156
    v_cvt_pk_bf16_f32 v156, v156, v156
    v_lshlrev_b32 v156, 16, v156
    v_rcp_f32 v156, v156
    s_nop 0
    v_mul_f32 v56, v56, v156
    v_mul_f32 v57, v57, v156
    v_mul_f32 v58, v58, v156
    v_mul_f32 v59, v59, v156
    v_mul_f32 v60, v60, v156
    v_mul_f32 v61, v61, v156
    v_mul_f32 v62, v62, v156
    v_mul_f32 v63, v63, v156
    v_cvt_pk_bf16_f32 v148, v56, v57
    v_cvt_pk_bf16_f32 v149, v58, v59
    v_cvt_pk_bf16_f32 v150, v60, v61
    v_cvt_pk_bf16_f32 v151, v62, v63
    v_mfma_f32_16x16x32_bf16 v[96:99], v[16:19], v[144:147], 0
    v_mfma_f32_16x16x32_bf16 v[100:103], v[20:23], v[144:147], 0
    v_mfma_f32_16x16x32_bf16 v[104:107], v[24:27], v[144:147], 0
    v_mfma_f32_16x16x32_bf16 v[108:111], v[28:31], v[144:147], 0
    v_mfma_f32_16x16x32_bf16 v[112:115], v[16:19], v[148:151], 0
    v_mfma_f32_16x16x32_bf16 v[116:119], v[20:23], v[148:151], 0
    v_mfma_f32_16x16x32_bf16 v[120:123], v[24:27], v[148:151], 0
    v_mfma_f32_16x16x32_bf16 v[124:127], v[28:31], v[148:151], 0
    s_waitcnt vmcnt(42)
    v_cvt_pk_bf16_f32 v160, v160, v161
    s_waitcnt vmcnt(40)
    v_cvt_pk_bf16_f32 v161, v162, v163
    s_waitcnt vmcnt(38)
    v_cvt_pk_bf16_f32 v162, v164, v165
    s_waitcnt vmcnt(36)
    v_cvt_pk_bf16_f32 v163, v166, v167
    s_waitcnt vmcnt(34)
    v_cvt_pk_bf16_f32 v164, v168, v169
    s_waitcnt vmcnt(32)
    v_cvt_pk_bf16_f32 v165, v170, v171
    s_waitcnt vmcnt(30)
    v_cvt_pk_bf16_f32 v166, v172, v173
    s_waitcnt vmcnt(28)
    v_cvt_pk_bf16_f32 v167, v174, v175
    s_waitcnt vmcnt(26)
    v_cvt_pk_bf16_f32 v168, v176, v177
    s_waitcnt vmcnt(24)
    v_cvt_pk_bf16_f32 v169, v178, v179
    s_waitcnt vmcnt(22)
    v_cvt_pk_bf16_f32 v170, v180, v181
    s_waitcnt vmcnt(20)
    v_cvt_pk_bf16_f32 v171, v182, v183
    s_waitcnt vmcnt(18)
    v_cvt_pk_bf16_f32 v172, v184, v185
    s_waitcnt vmcnt(16)
    v_cvt_pk_bf16_f32 v173, v186, v187
    s_waitcnt vmcnt(14)
    v_cvt_pk_bf16_f32 v174, v188, v189
    s_waitcnt vmcnt(12)
    v_cvt_pk_bf16_f32 v175, v190, v191
    s_waitcnt vmcnt(11)
    v_mfma_f32_16x16x32_bf16 v[48:51], v[160:163], v[224:227], 0
    s_waitcnt vmcnt(10)
    v_mfma_f32_16x16x32_bf16 v[48:51], v[164:167], v[228:231], v[48:51]
    v_mfma_f32_16x16x32_bf16 v[52:55], v[168:171], v[224:227], 0
    v_mfma_f32_16x16x32_bf16 v[52:55], v[172:175], v[228:231], v[52:55]
    s_waitcnt vmcnt(9)
    v_mfma_f32_16x16x32_bf16 v[56:59], v[160:163], v[232:235], 0
    s_waitcnt vmcnt(8)
    v_mfma_f32_16x16x32_bf16 v[56:59], v[164:167], v[236:239], v[56:59]
    v_mfma_f32_16x16x32_bf16 v[60:63], v[168:171], v[232:235], 0
    v_mfma_f32_16x16x32_bf16 v[60:63], v[172:175], v[236:239], v[60:63]
    v_cvt_pk_bf16_f32 v184, v48, v49
    v_cvt_pk_bf16_f32 v185, v50, v51
    v_cvt_pk_bf16_f32 v186, v52, v53
    v_cvt_pk_bf16_f32 v187, v54, v55
    v_lshlrev_b32 v48, 16, v184
    v_and_b32 v49, 4294901760, v184
    v_lshlrev_b32 v50, 16, v185
    v_and_b32 v51, 4294901760, v185
    v_lshlrev_b32 v52, 16, v186
    v_and_b32 v53, 4294901760, v186
    v_lshlrev_b32 v54, 16, v187
    v_and_b32 v55, 4294901760, v187
    v_cndmask_b32 v188, 0, v52, s[48:49]
    v_mov_b32 v189, v188
    s_nop 1
    v_permlane16_swap_b32 v188, v189
    v_add_f32 v188, v188, v189
    v_mov_b32 v189, v188
    s_nop 1
    v_permlane32_swap_b32 v188, v189
    v_add_f32 v188, v188, v189
    v_add_f32 v188, 897988541, v188
    v_cvt_pk_bf16_f32 v188, v188, v188
    v_lshlrev_b32 v188, 16, v188
    v_rcp_f32 v188, v188
    s_nop 0
    v_mul_f32 v48, v48, v188
    v_mul_f32 v49, v49, v188
    v_mul_f32 v50, v50, v188
    v_mul_f32 v51, v51, v188
    v_mul_f32 v52, v52, v188
    v_mul_f32 v53, v53, v188
    v_mul_f32 v54, v54, v188
    v_mul_f32 v55, v55, v188
    v_cvt_pk_bf16_f32 v176, v48, v49
    v_cvt_pk_bf16_f32 v177, v50, v51
    v_cvt_pk_bf16_f32 v178, v52, v53
    v_cvt_pk_bf16_f32 v179, v54, v55
    v_cvt_pk_bf16_f32 v184, v56, v57
    v_cvt_pk_bf16_f32 v185, v58, v59
    v_cvt_pk_bf16_f32 v186, v60, v61
    v_cvt_pk_bf16_f32 v187, v62, v63
    v_lshlrev_b32 v56, 16, v184
    v_and_b32 v57, 4294901760, v184
    v_lshlrev_b32 v58, 16, v185
    v_and_b32 v59, 4294901760, v185
    v_lshlrev_b32 v60, 16, v186
    v_and_b32 v61, 4294901760, v186
    v_lshlrev_b32 v62, 16, v187
    v_and_b32 v63, 4294901760, v187
    v_cndmask_b32 v188, 0, v60, s[48:49]
    v_mov_b32 v189, v188
    s_nop 1
    v_permlane16_swap_b32 v188, v189
    v_add_f32 v188, v188, v189
    v_mov_b32 v189, v188
    s_nop 1
    v_permlane32_swap_b32 v188, v189
    v_add_f32 v188, v188, v189
    v_add_f32 v188, 897988541, v188
    v_cvt_pk_bf16_f32 v188, v188, v188
    v_lshlrev_b32 v188, 16, v188
    v_rcp_f32 v188, v188
    s_nop 0
    v_mul_f32 v56, v56, v188
    v_mul_f32 v57, v57, v188
    v_mul_f32 v58, v58, v188
    v_mul_f32 v59, v59, v188
    v_mul_f32 v60, v60, v188
    v_mul_f32 v61, v61, v188
    v_mul_f32 v62, v62, v188
    v_mul_f32 v63, v63, v188
    v_cvt_pk_bf16_f32 v180, v56, v57
    v_cvt_pk_bf16_f32 v181, v58, v59
    v_cvt_pk_bf16_f32 v182, v60, v61
    v_cvt_pk_bf16_f32 v183, v62, v63
    s_waitcnt vmcnt(3)
    v_mfma_f32_16x16x32_bf16 v[64:67], v[32:35], v[176:179], v[64:67]
    s_waitcnt vmcnt(2)
    v_mfma_f32_16x16x32_bf16 v[68:71], v[36:39], v[176:179], v[68:71]
    s_waitcnt vmcnt(1)
    v_mfma_f32_16x16x32_bf16 v[72:75], v[40:43], v[176:179], v[72:75]
    s_waitcnt vmcnt(0)
    v_mfma_f32_16x16x32_bf16 v[76:79], v[44:47], v[176:179], v[76:79]
    v_mfma_f32_16x16x32_bf16 v[80:83], v[32:35], v[180:183], v[80:83]
    v_mfma_f32_16x16x32_bf16 v[84:87], v[36:39], v[180:183], v[84:87]
    v_mfma_f32_16x16x32_bf16 v[88:91], v[40:43], v[180:183], v[88:91]
    v_mfma_f32_16x16x32_bf16 v[92:95], v[44:47], v[180:183], v[92:95]
    v_mfma_f32_16x16x32_bf16 v[48:51], v[160:163], v[240:243], 0
    v_mfma_f32_16x16x32_bf16 v[48:51], v[164:167], v[244:247], v[48:51]
    v_mfma_f32_16x16x32_bf16 v[52:55], v[168:171], v[240:243], 0
    v_mfma_f32_16x16x32_bf16 v[52:55], v[172:175], v[244:247], v[52:55]
    v_mfma_f32_16x16x32_bf16 v[56:59], v[160:163], v[248:251], 0
    v_mfma_f32_16x16x32_bf16 v[56:59], v[164:167], v[252:255], v[56:59]
    v_mfma_f32_16x16x32_bf16 v[60:63], v[168:171], v[248:251], 0
    v_mfma_f32_16x16x32_bf16 v[60:63], v[172:175], v[252:255], v[60:63]
    s_nop 1
    v_cvt_pk_bf16_f32 v184, v48, v49
    v_cvt_pk_bf16_f32 v185, v50, v51
    v_cvt_pk_bf16_f32 v186, v52, v53
    v_cvt_pk_bf16_f32 v187, v54, v55
    v_lshlrev_b32 v48, 16, v184
    v_and_b32 v49, 4294901760, v184
    v_lshlrev_b32 v50, 16, v185
    v_and_b32 v51, 4294901760, v185
    v_lshlrev_b32 v52, 16, v186
    v_and_b32 v53, 4294901760, v186
    v_lshlrev_b32 v54, 16, v187
    v_and_b32 v55, 4294901760, v187
    v_cndmask_b32 v188, 0, v52, s[48:49]
    v_mov_b32 v189, v188
    s_nop 1
    v_permlane16_swap_b32 v188, v189
    v_add_f32 v188, v188, v189
    v_mov_b32 v189, v188
    s_nop 1
    v_permlane32_swap_b32 v188, v189
    v_add_f32 v188, v188, v189
    v_add_f32 v188, 897988541, v188
    v_cvt_pk_bf16_f32 v188, v188, v188
    v_lshlrev_b32 v188, 16, v188
    v_rcp_f32 v188, v188
    s_nop 0
    v_mul_f32 v48, v48, v188
    v_mul_f32 v49, v49, v188
    v_mul_f32 v50, v50, v188
    v_mul_f32 v51, v51, v188
    v_mul_f32 v52, v52, v188
    v_mul_f32 v53, v53, v188
    v_mul_f32 v54, v54, v188
    v_mul_f32 v55, v55, v188
    v_cvt_pk_bf16_f32 v176, v48, v49
    v_cvt_pk_bf16_f32 v177, v50, v51
    v_cvt_pk_bf16_f32 v178, v52, v53
    v_cvt_pk_bf16_f32 v179, v54, v55
    v_cvt_pk_bf16_f32 v184, v56, v57
    v_cvt_pk_bf16_f32 v185, v58, v59
    v_cvt_pk_bf16_f32 v186, v60, v61
    v_cvt_pk_bf16_f32 v187, v62, v63
    v_lshlrev_b32 v56, 16, v184
    v_and_b32 v57, 4294901760, v184
    v_lshlrev_b32 v58, 16, v185
    v_and_b32 v59, 4294901760, v185
    v_lshlrev_b32 v60, 16, v186
    v_and_b32 v61, 4294901760, v186
    v_lshlrev_b32 v62, 16, v187
    v_and_b32 v63, 4294901760, v187
    v_cndmask_b32 v188, 0, v60, s[48:49]
    v_mov_b32 v189, v188
    s_nop 1
    v_permlane16_swap_b32 v188, v189
    v_add_f32 v188, v188, v189
    v_mov_b32 v189, v188
    s_nop 1
    v_permlane32_swap_b32 v188, v189
    v_add_f32 v188, v188, v189
    v_add_f32 v188, 897988541, v188
    v_cvt_pk_bf16_f32 v188, v188, v188
    v_lshlrev_b32 v188, 16, v188
    v_rcp_f32 v188, v188
    s_nop 0
    v_mul_f32 v56, v56, v188
    v_mul_f32 v57, v57, v188
    v_mul_f32 v58, v58, v188
    v_mul_f32 v59, v59, v188
    v_mul_f32 v60, v60, v188
    v_mul_f32 v61, v61, v188
    v_mul_f32 v62, v62, v188
    v_mul_f32 v63, v63, v188
    v_cvt_pk_bf16_f32 v180, v56, v57
    v_cvt_pk_bf16_f32 v181, v58, v59
    v_cvt_pk_bf16_f32 v182, v60, v61
    v_cvt_pk_bf16_f32 v183, v62, v63
    v_mfma_f32_16x16x32_bf16 v[96:99], v[32:35], v[176:179], v[96:99]
    v_mfma_f32_16x16x32_bf16 v[100:103], v[36:39], v[176:179], v[100:103]
    v_mfma_f32_16x16x32_bf16 v[104:107], v[40:43], v[176:179], v[104:107]
    v_mfma_f32_16x16x32_bf16 v[108:111], v[44:47], v[176:179], v[108:111]
    v_mfma_f32_16x16x32_bf16 v[112:115], v[32:35], v[180:183], v[112:115]
    v_mfma_f32_16x16x32_bf16 v[116:119], v[36:39], v[180:183], v[116:119]
    v_mfma_f32_16x16x32_bf16 v[120:123], v[40:43], v[180:183], v[120:123]
    v_mfma_f32_16x16x32_bf16 v[124:127], v[44:47], v[180:183], v[124:127]
    s_nop 7
    s_nop 7
    s_lshr_b32 s26, s20, 1
    s_and_b32 s27, s20, 1
    s_lshl_b32 s28, s21, 2
    s_add_u32 s28, s28, s26
    s_lshl_b32 s29, s22, 1
    s_add_u32 s29, s29, s27
    s_mul_i32 s30, s28, 14336
    s_lshl_b32 s31, s29, 10
    s_add_u32 s30, s30, s31
    s_add_u32 s31, s30, 4194304
    buffer_load_dwordx4 v[200:203], v5, s[8:11], s31 offen
    s_lshl_b32 s31, s20, 14
    v_add_u32 v9, s31, v5
    ds_write_b128 v9, v[64:67] offset:0
    ds_write_b128 v9, v[68:71] offset:1024
    ds_write_b128 v9, v[72:75] offset:2048
    ds_write_b128 v9, v[76:79] offset:3072
    ds_write_b128 v9, v[80:83] offset:4096
    ds_write_b128 v9, v[84:87] offset:5120
    ds_write_b128 v9, v[88:91] offset:6144
    ds_write_b128 v9, v[92:95] offset:7168
    ds_write_b128 v9, v[96:99] offset:8192
    ds_write_b128 v9, v[100:103] offset:9216
    ds_write_b128 v9, v[104:107] offset:10240
    ds_write_b128 v9, v[108:111] offset:11264
    ds_write_b128 v9, v[112:115] offset:12288
    ds_write_b128 v9, v[116:119] offset:13312
    ds_write_b128 v9, v[120:123] offset:14336
    ds_write_b128 v9, v[124:127] offset:15360
    s_waitcnt lgkmcnt(0)
    s_barrier
    s_lshl_b32 s31, s26, 12
    s_lshl_b32 s26, s27, 11
    s_add_u32 s31, s31, s26
    v_add_u32 v9, s31, v5
    v_add_u32 v10, 65536, v9
    ds_read_b128 v[16:19], v9 offset:0
    ds_read_b128 v[20:23], v9 offset:1024
    ds_read_b128 v[24:27], v9 offset:16384
    ds_read_b128 v[28:31], v9 offset:17408
    ds_read_b128 v[32:35], v9 offset:32768
    ds_read_b128 v[36:39], v9 offset:33792
    ds_read_b128 v[40:43], v9 offset:49152
    ds_read_b128 v[44:47], v9 offset:50176
    ds_read_b128 v[48:51], v10 offset:0
    ds_read_b128 v[52:55], v10 offset:1024
    ds_read_b128 v[56:59], v10 offset:16384
    ds_read_b128 v[60:63], v10 offset:17408
    ds_read_b128 v[64:67], v10 offset:32768
    ds_read_b128 v[68:71], v10 offset:33792
    ds_read_b128 v[72:75], v10 offset:49152
    ds_read_b128 v[76:79], v10 offset:50176
    s_waitcnt lgkmcnt(13)
    v_add_f32 v16, v16, v24
    v_add_f32 v17, v17, v25
    v_add_f32 v18, v18, v26
    v_add_f32 v19, v19, v27
    s_waitcnt lgkmcnt(12)
    v_add_f32 v20, v20, v28
    v_add_f32 v21, v21, v29
    v_add_f32 v22, v22, v30
    v_add_f32 v23, v23, v31
    s_waitcnt lgkmcnt(11)
    v_add_f32 v16, v16, v32
    v_add_f32 v17, v17, v33
    v_add_f32 v18, v18, v34
    v_add_f32 v19, v19, v35
    s_waitcnt lgkmcnt(10)
    v_add_f32 v20, v20, v36
    v_add_f32 v21, v21, v37
    v_add_f32 v22, v22, v38
    v_add_f32 v23, v23, v39
    s_waitcnt lgkmcnt(9)
    v_add_f32 v16, v16, v40
    v_add_f32 v17, v17, v41
    v_add_f32 v18, v18, v42
    v_add_f32 v19, v19, v43
    s_waitcnt lgkmcnt(8)
    v_add_f32 v20, v20, v44
    v_add_f32 v21, v21, v45
    v_add_f32 v22, v22, v46
    v_add_f32 v23, v23, v47
    s_waitcnt lgkmcnt(7)
    v_add_f32 v16, v16, v48
    v_add_f32 v17, v17, v49
    v_add_f32 v18, v18, v50
    v_add_f32 v19, v19, v51
    s_waitcnt lgkmcnt(6)
    v_add_f32 v20, v20, v52
    v_add_f32 v21, v21, v53
    v_add_f32 v22, v22, v54
    v_add_f32 v23, v23, v55
    s_waitcnt lgkmcnt(5)
    v_add_f32 v16, v16, v56
    v_add_f32 v17, v17, v57
    v_add_f32 v18, v18, v58
    v_add_f32 v19, v19, v59
    s_waitcnt lgkmcnt(4)
    v_add_f32 v20, v20, v60
    v_add_f32 v21, v21, v61
    v_add_f32 v22, v22, v62
    v_add_f32 v23, v23, v63
    s_waitcnt lgkmcnt(3)
    v_add_f32 v16, v16, v64
    v_add_f32 v17, v17, v65
    v_add_f32 v18, v18, v66
    v_add_f32 v19, v19, v67
    s_waitcnt lgkmcnt(2)
    v_add_f32 v20, v20, v68
    v_add_f32 v21, v21, v69
    v_add_f32 v22, v22, v70
    v_add_f32 v23, v23, v71
    s_waitcnt lgkmcnt(1)
    v_add_f32 v16, v16, v72
    v_add_f32 v17, v17, v73
    v_add_f32 v18, v18, v74
    v_add_f32 v19, v19, v75
    s_waitcnt lgkmcnt(0)
    v_add_f32 v20, v20, v76
    v_add_f32 v21, v21, v77
    v_add_f32 v22, v22, v78
    v_add_f32 v23, v23, v79
    v_cvt_pk_bf16_f32 v24, v16, v17
    v_cvt_pk_bf16_f32 v25, v18, v19
    v_cvt_pk_bf16_f32 v26, v20, v21
    v_cvt_pk_bf16_f32 v27, v22, v23
    v_lshlrev_b32 v16, 16, v24
    v_and_b32 v17, 4294901760, v24
    v_lshlrev_b32 v18, 16, v25
    v_and_b32 v19, 4294901760, v25
    v_lshlrev_b32 v20, 16, v26
    v_and_b32 v21, 4294901760, v26
    v_lshlrev_b32 v22, 16, v27
    v_and_b32 v23, 4294901760, v27
    s_waitcnt vmcnt(0)
    v_lshlrev_b32 v24, 16, v200
    v_and_b32 v25, 4294901760, v200
    v_lshlrev_b32 v26, 16, v201
    v_and_b32 v27, 4294901760, v201
    v_lshlrev_b32 v28, 16, v202
    v_and_b32 v29, 4294901760, v202
    v_lshlrev_b32 v30, 16, v203
    v_and_b32 v31, 4294901760, v203
    v_add_f32 v16, v16, v24
    v_add_f32 v17, v17, v25
    v_add_f32 v18, v18, v26
    v_add_f32 v19, v19, v27
    v_add_f32 v20, v20, v28
    v_add_f32 v21, v21, v29
    v_add_f32 v22, v22, v30
    v_add_f32 v23, v23, v31
    v_cvt_pk_bf16_f32 v32, v16, v17
    v_cvt_pk_bf16_f32 v33, v18, v19
    v_cvt_pk_bf16_f32 v34, v20, v21
    v_cvt_pk_bf16_f32 v35, v22, v23
    s_add_u32 s31, s30, 6291456
    buffer_store_dwordx4 v[32:35], v5, s[8:11], s31 offen
    s_nop 4
L_end_k2b_kernel:
    s_endpgm

.globl k3b_kernel
.p2align 8
.type k3b_kernel,@function
k3b_kernel:
    s_cmp_ge_u32 s2, 224
    s_cbranch_scc1 L_end_k3b_kernel
    s_load_dwordx2 s[4:5], s[0:1], 88
    s_load_dwordx2 s[12:13], s[0:1], 48
    v_and_b32 v1, 63, v0
    v_lshrrev_b32 v2, 6, v0
    s_nop 0
    v_readfirstlane_b32 s20, v2
    v_and_b32 v3, 15, v1
    v_lshrrev_b32 v4, 4, v1
    v_lshlrev_b32 v5, 4, v1
    s_waitcnt lgkmcnt(0)
    s_mov_b32 s8, s4
    s_and_b32 s9, s5, 65535
    s_mov_b32 s10, 268435456
    s_mov_b32 s11, 131072
    s_and_b32 s13, s13, 65535
    s_mov_b32 s14, 3584
    s_mov_b32 s15, 131072
    s_and_b32 s26, s2, 7
    s_lshr_b32 s27, s2, 3
    s_mul_i32 s28, s27, 37
    s_lshr_b32 s28, s28, 8
    s_mul_i32 s29, s28, 7
    s_sub_u32 s29, s27, s29
    s_lshr_b32 s21, s26, 1
    s_lshl_b32 s21, s21, 2
    s_add_u32 s21, s21, s28
    s_and_b32 s22, s26, 1
    s_mul_i32 s22, s22, 7
    s_add_u32 s22, s22, s29
    s_lshl_b32 s23, s21, 3
    s_add_u32 s23, s23, s20
    s_mul_i32 s24, s22, 114688
    s_lshl_b32 s25, s20, 10
    s_add_u32 s24, s24, s25
    s_add_u32 s24, s24, 25165824
    s_mul_i32 s26, s23, 14336
    s_add_u32 s26, s26, 6291456
    s_add_u32 s28, s25, 0
    s_mov_b32 m0, s28
    s_add_u32 s27, s24, 0
    buffer_load_dwordx4 v5, s[8:11], s27 offen lds
    s_add_u32 s29, s26, 0
    buffer_load_dwordx4 v[16:19], v5, s[8:11], s29 offen offset:0
    s_add_u32 s28, s25, 8192
    s_mov_b32 m0, s28
    s_add_u32 s27, s24, 8192
    buffer_load_dwordx4 v5, s[8:11], s27 offen lds
    s_add_u32 s29, s26, 0
    buffer_load_dwordx4 v[20:23], v5, s[8:11], s29 offen offset:1024
    s_add_u32 s28, s25, 16384
    s_mov_b32 m0, s28
    s_add_u32 s27, s24, 16384
    buffer_load_dwordx4 v5, s[8:11], s27 offen lds
    s_add_u32 s29, s26, 0
    buffer_load_dwordx4 v[24:27], v5, s[8:11], s29 offen offset:2048
    s_add_u32 s28, s25, 24576
    s_mov_b32 m0, s28
    s_add_u32 s27, s24, 24576
    buffer_load_dwordx4 v5, s[8:11], s27 offen lds
    s_add_u32 s29, s26, 0
    buffer_load_dwordx4 v[28:31], v5, s[8:11], s29 offen offset:3072
    s_add_u32 s28, s25, 32768
    s_mov_b32 m0, s28
    s_add_u32 s27, s24, 32768
    buffer_load_dwordx4 v5, s[8:11], s27 offen lds
    s_add_u32 s29, s26, 4096
    buffer_load_dwordx4 v[32:35], v5, s[8:11], s29 offen offset:0
    s_add_u32 s28, s25, 40960
    s_mov_b32 m0, s28
    s_add_u32 s27, s24, 40960
    buffer_load_dwordx4 v5, s[8:11], s27 offen lds
    s_add_u32 s29, s26, 4096
    buffer_load_dwordx4 v[36:39], v5, s[8:11], s29 offen offset:1024
    v_lshlrev_b32 v6, 4, v4
    v_lshlrev_b32 v7, 3, v4
    s_lshl_b32 s30, s22, 9
    s_add_u32 s30, s30, 29368320
    s_lshl_b32 s31, s22, 8
    v_mov_b32 v176, 1065369472
    v_mov_b32 v177, 1065369472
    v_mov_b32 v178, 1065369472
    v_mov_b32 v179, 1065369472
    v_and_b32 v12, 3, v3
    v_lshrrev_b32 v13, 2, v3
    v_cmp_eq_u32 s[40:41], 1, v12
    v_cmp_eq_u32 s[42:43], 2, v12
    v_cmp_eq_u32 s[44:45], 3, v12
    v_cmp_eq_u32 s[46:47], v4, v13
    v_add_u32 v8, 65536, v5
    s_waitcnt vmcnt(8)
    s_barrier
    ds_read_b128 v[72:75], v5 offset:0
    ds_read_b128 v[76:79], v5 offset:1024
    ds_read_b128 v[80:83], v5 offset:2048
    ds_read_b128 v[84:87], v5 offset:3072
    ds_read_b128 v[88:91], v5 offset:4096
    ds_read_b128 v[92:95], v5 offset:5120
    ds_read_b128 v[96:99], v5 offset:6144
    ds_read_b128 v[100:103], v5 offset:7168
    ds_read_b128 v[104:107], v5 offset:8192
    ds_read_b128 v[108:111], v5 offset:9216
    ds_read_b128 v[112:115], v5 offset:10240
    ds_read_b128 v[116:119], v5 offset:11264
    ds_read_b128 v[120:123], v5 offset:12288
    ds_read_b128 v[124:127], v5 offset:13312
    ds_read_b128 v[128:131], v5 offset:14336
    ds_read_b128 v[132:135], v5 offset:15360
    v_mfma_f32_16x16x32_bf16 v[168:171], v[176:179], v[16:19], 0
    v_mfma_f32_16x16x32_bf16 v[172:175], v[16:19], v[16:19], 0
    s_add_u32 s28, s25, 49152
    s_mov_b32 m0, s28
    s_add_u32 s27, s24, 49152
    buffer_load_dwordx4 v5, s[8:11], s27 offen lds
    s_waitcnt lgkmcnt(15)
    v_mfma_f32_16x16x32_bf16 v[136:139], v[72:75], v[16:19], 0
    s_waitcnt lgkmcnt(14)
    v_mfma_f32_16x16x32_bf16 v[140:143], v[76:79], v[16:19], 0
    s_waitcnt lgkmcnt(13)
    v_mfma_f32_16x16x32_bf16 v[144:147], v[80:83], v[16:19], 0
    s_waitcnt lgkmcnt(12)
    v_mfma_f32_16x16x32_bf16 v[148:151], v[84:87], v[16:19], 0
    s_add_u32 s29, s26, 4096
    buffer_load_dwordx4 v[40:43], v5, s[8:11], s29 offen offset:2048
    s_waitcnt lgkmcnt(11)
    v_mfma_f32_16x16x32_bf16 v[152:155], v[88:91], v[16:19], 0
    s_waitcnt lgkmcnt(10)
    v_mfma_f32_16x16x32_bf16 v[156:159], v[92:95], v[16:19], 0
    s_waitcnt lgkmcnt(9)
    v_mfma_f32_16x16x32_bf16 v[160:163], v[96:99], v[16:19], 0
    s_waitcnt lgkmcnt(8)
    v_mfma_f32_16x16x32_bf16 v[164:167], v[100:103], v[16:19], 0
    v_mfma_f32_16x16x32_bf16 v[168:171], v[176:179], v[20:23], v[168:171]
    v_mfma_f32_16x16x32_bf16 v[172:175], v[20:23], v[20:23], v[172:175]
    s_add_u32 s28, s25, 57344
    s_mov_b32 m0, s28
    s_add_u32 s27, s24, 57344
    buffer_load_dwordx4 v5, s[8:11], s27 offen lds
    s_waitcnt lgkmcnt(7)
    v_mfma_f32_16x16x32_bf16 v[136:139], v[104:107], v[20:23], v[136:139]
    s_waitcnt lgkmcnt(6)
    v_mfma_f32_16x16x32_bf16 v[140:143], v[108:111], v[20:23], v[140:143]
    s_waitcnt lgkmcnt(5)
    v_mfma_f32_16x16x32_bf16 v[144:147], v[112:115], v[20:23], v[144:147]
    s_waitcnt lgkmcnt(4)
    v_mfma_f32_16x16x32_bf16 v[148:151], v[116:119], v[20:23], v[148:151]
    s_add_u32 s29, s26, 4096
    buffer_load_dwordx4 v[44:47], v5, s[8:11], s29 offen offset:3072
    s_waitcnt lgkmcnt(3)
    v_mfma_f32_16x16x32_bf16 v[152:155], v[120:123], v[20:23], v[152:155]
    s_waitcnt lgkmcnt(2)
    v_mfma_f32_16x16x32_bf16 v[156:159], v[124:127], v[20:23], v[156:159]
    s_waitcnt lgkmcnt(1)
    v_mfma_f32_16x16x32_bf16 v[160:163], v[128:131], v[20:23], v[160:163]
    s_waitcnt lgkmcnt(0)
    v_mfma_f32_16x16x32_bf16 v[164:167], v[132:135], v[20:23], v[164:167]
    s_waitcnt vmcnt(8)
    s_barrier
    ds_read_b128 v[72:75], v5 offset:16384
    ds_read_b128 v[76:79], v5 offset:17408
    ds_read_b128 v[80:83], v5 offset:18432
    ds_read_b128 v[84:87], v5 offset:19456
    ds_read_b128 v[88:91], v5 offset:20480
    ds_read_b128 v[92:95], v5 offset:21504
    ds_read_b128 v[96:99], v5 offset:22528
    ds_read_b128 v[100:103], v5 offset:23552
    ds_read_b128 v[104:107], v5 offset:24576
    ds_read_b128 v[108:111], v5 offset:25600
    ds_read_b128 v[112:115], v5 offset:26624
    ds_read_b128 v[116:119], v5 offset:27648
    ds_read_b128 v[120:123], v5 offset:28672
    ds_read_b128 v[124:127], v5 offset:29696
    ds_read_b128 v[128:131], v5 offset:30720
    ds_read_b128 v[132:135], v5 offset:31744
    v_mfma_f32_16x16x32_bf16 v[168:171], v[176:179], v[24:27], v[168:171]
    v_mfma_f32_16x16x32_bf16 v[172:175], v[24:27], v[24:27], v[172:175]
    s_add_u32 s28, s25, 65536
    s_mov_b32 m0, s28
    s_add_u32 s27, s24, 65536
    buffer_load_dwordx4 v5, s[8:11], s27 offen lds
    s_waitcnt lgkmcnt(15)
    v_mfma_f32_16x16x32_bf16 v[136:139], v[72:75], v[24:27], v[136:139]
    s_waitcnt lgkmcnt(14)
    v_mfma_f32_16x16x32_bf16 v[140:143], v[76:79], v[24:27], v[140:143]
    s_waitcnt lgkmcnt(13)
    v_mfma_f32_16x16x32_bf16 v[144:147], v[80:83], v[24:27], v[144:147]
    s_waitcnt lgkmcnt(12)
    v_mfma_f32_16x16x32_bf16 v[148:151], v[84:87], v[24:27], v[148:151]
    s_add_u32 s29, s26, 8192
    buffer_load_dwordx4 v[48:51], v5, s[8:11], s29 offen offset:0
    s_waitcnt lgkmcnt(11)
    v_mfma_f32_16x16x32_bf16 v[152:155], v[88:91], v[24:27], v[152:155]
    s_waitcnt lgkmcnt(10)
    v_mfma_f32_16x16x32_bf16 v[156:159], v[92:95], v[24:27], v[156:159]
    s_waitcnt lgkmcnt(9)
    v_mfma_f32_16x16x32_bf16 v[160:163], v[96:99], v[24:27], v[160:163]
    s_waitcnt lgkmcnt(8)
    v_mfma_f32_16x16x32_bf16 v[164:167], v[100:103], v[24:27], v[164:167]
    v_mfma_f32_16x16x32_bf16 v[168:171], v[176:179], v[28:31], v[168:171]
    v_mfma_f32_16x16x32_bf16 v[172:175], v[28:31], v[28:31], v[172:175]
    s_add_u32 s28, s25, 73728
    s_mov_b32 m0, s28
    s_add_u32 s27, s24, 73728
    buffer_load_dwordx4 v5, s[8:11], s27 offen lds
    s_waitcnt lgkmcnt(7)
    v_mfma_f32_16x16x32_bf16 v[136:139], v[104:107], v[28:31], v[136:139]
    s_waitcnt lgkmcnt(6)
    v_mfma_f32_16x16x32_bf16 v[140:143], v[108:111], v[28:31], v[140:143]
    s_waitcnt lgkmcnt(5)
    v_mfma_f32_16x16x32_bf16 v[144:147], v[112:115], v[28:31], v[144:147]
    s_waitcnt lgkmcnt(4)
    v_mfma_f32_16x16x32_bf16 v[148:151], v[116:119], v[28:31], v[148:151]
    s_add_u32 s29, s26, 8192
    buffer_load_dwordx4 v[52:55], v5, s[8:11], s29 offen offset:1024
    s_waitcnt lgkmcnt(3)
    v_mfma_f32_16x16x32_bf16 v[152:155], v[120:123], v[28:31], v[152:155]
    s_waitcnt lgkmcnt(2)
    v_mfma_f32_16x16x32_bf16 v[156:159], v[124:127], v[28:31], v[156:159]
    s_waitcnt lgkmcnt(1)
    v_mfma_f32_16x16x32_bf16 v[160:163], v[128:131], v[28:31], v[160:163]
    s_waitcnt lgkmcnt(0)
    v_mfma_f32_16x16x32_bf16 v[164:167], v[132:135], v[28:31], v[164:167]
    s_waitcnt vmcnt(8)
    s_barrier
    ds_read_b128 v[72:75], v5 offset:32768
    ds_read_b128 v[76:79], v5 offset:33792
    ds_read_b128 v[80:83], v5 offset:34816
    ds_read_b128 v[84:87], v5 offset:35840
    ds_read_b128 v[88:91], v5 offset:36864
    ds_read_b128 v[92:95], v5 offset:37888
    ds_read_b128 v[96:99], v5 offset:38912
    ds_read_b128 v[100:103], v5 offset:39936
    ds_read_b128 v[104:107], v5 offset:40960
    ds_read_b128 v[108:111], v5 offset:41984
    ds_read_b128 v[112:115], v5 offset:43008
    ds_read_b128 v[116:119], v5 offset:44032
    ds_read_b128 v[120:123], v5 offset:45056
    ds_read_b128 v[124:127], v5 offset:46080
    ds_read_b128 v[128:131], v5 offset:47104
    ds_read_b128 v[132:135], v5 offset:48128
    v_mfma_f32_16x16x32_bf16 v[168:171], v[176:179], v[32:35], v[168:171]
    v_mfma_f32_16x16x32_bf16 v[172:175], v[32:35], v[32:35], v[172:175]
    s_add_u32 s28, s25, 81920
    s_mov_b32 m0, s28
    s_add_u32 s27, s24, 81920
    buffer_load_dwordx4 v5, s[8:11], s27 offen lds
    s_waitcnt lgkmcnt(15)
    v_mfma_f32_16x16x32_bf16 v[136:139], v[72:75], v[32:35], v[136:139]
    s_waitcnt lgkmcnt(14)
    v_mfma_f32_16x16x32_bf16 v[140:143], v[76:79], v[32:35], v[140:143]
    s_waitcnt lgkmcnt(13)
    v_mfma_f32_16x16x32_bf16 v[144:147], v[80:83], v[32:35], v[144:147]
    s_waitcnt lgkmcnt(12)
    v_mfma_f32_16x16x32_bf16 v[148:151], v[84:87], v[32:35], v[148:151]
    s_add_u32 s29, s26, 8192
    buffer_load_dwordx4 v[56:59], v5, s[8:11], s29 offen offset:2048
    s_waitcnt lgkmcnt(11)
    v_mfma_f32_16x16x32_bf16 v[152:155], v[88:91], v[32:35], v[152:155]
    s_waitcnt lgkmcnt(10)
    v_mfma_f32_16x16x32_bf16 v[156:159], v[92:95], v[32:35], v[156:159]
    s_waitcnt lgkmcnt(9)
    v_mfma_f32_16x16x32_bf16 v[160:163], v[96:99], v[32:35], v[160:163]
    s_waitcnt lgkmcnt(8)
    v_mfma_f32_16x16x32_bf16 v[164:167], v[100:103], v[32:35], v[164:167]
    v_mfma_f32_16x16x32_bf16 v[168:171], v[176:179], v[36:39], v[168:171]
    v_mfma_f32_16x16x32_bf16 v[172:175], v[36:39], v[36:39], v[172:175]
    s_add_u32 s28, s25, 90112
    s_mov_b32 m0, s28
    s_add_u32 s27, s24, 90112
    buffer_load_dwordx4 v5, s[8:11], s27 offen lds
    s_waitcnt lgkmcnt(7)
    v_mfma_f32_16x16x32_bf16 v[136:139], v[104:107], v[36:39], v[136:139]
    s_waitcnt lgkmcnt(6)
    v_mfma_f32_16x16x32_bf16 v[140:143], v[108:111], v[36:39], v[140:143]
    s_waitcnt lgkmcnt(5)
    v_mfma_f32_16x16x32_bf16 v[144:147], v[112:115], v[36:39], v[144:147]
    s_waitcnt lgkmcnt(4)
    v_mfma_f32_16x16x32_bf16 v[148:151], v[116:119], v[36:39], v[148:151]
    s_add_u32 s29, s26, 8192
    buffer_load_dwordx4 v[60:63], v5, s[8:11], s29 offen offset:3072
    s_waitcnt lgkmcnt(3)
    v_mfma_f32_16x16x32_bf16 v[152:155], v[120:123], v[36:39], v[152:155]
    s_waitcnt lgkmcnt(2)
    v_mfma_f32_16x16x32_bf16 v[156:159], v[124:127], v[36:39], v[156:159]
    s_waitcnt lgkmcnt(1)
    v_mfma_f32_16x16x32_bf16 v[160:163], v[128:131], v[36:39], v[160:163]
    s_waitcnt lgkmcnt(0)
    v_mfma_f32_16x16x32_bf16 v[164:167], v[132:135], v[36:39], v[164:167]
    s_waitcnt vmcnt(8)
    s_barrier
    ds_read_b128 v[72:75], v5 offset:49152
    ds_read_b128 v[76:79], v5 offset:50176
    ds_read_b128 v[80:83], v5 offset:51200
    ds_read_b128 v[84:87], v5 offset:52224
    ds_read_b128 v[88:91], v5 offset:53248
    ds_read_b128 v[92:95], v5 offset:54272
    ds_read_b128 v[96:99], v5 offset:55296
    ds_read_b128 v[100:103], v5 offset:56320
    ds_read_b128 v[104:107], v5 offset:57344
    ds_read_b128 v[108:111], v5 offset:58368
    ds_read_b128 v[112:115], v5 offset:59392
    ds_read_b128 v[116:119], v5 offset:60416
    ds_read_b128 v[120:123], v5 offset:61440
    ds_read_b128 v[124:127], v5 offset:62464
    ds_read_b128 v[128:131], v5 offset:63488
    ds_read_b128 v[132:135], v5 offset:64512
    v_mfma_f32_16x16x32_bf16 v[168:171], v[176:179], v[40:43], v[168:171]
    v_mfma_f32_16x16x32_bf16 v[172:175], v[40:43], v[40:43], v[172:175]
    s_add_u32 s28, s25, 98304
    s_mov_b32 m0, s28
    s_add_u32 s27, s24, 98304
    buffer_load_dwordx4 v5, s[8:11], s27 offen lds
    s_waitcnt lgkmcnt(15)
    v_mfma_f32_16x16x32_bf16 v[136:139], v[72:75], v[40:43], v[136:139]
    s_waitcnt lgkmcnt(14)
    v_mfma_f32_16x16x32_bf16 v[140:143], v[76:79], v[40:43], v[140:143]
    s_waitcnt lgkmcnt(13)
    v_mfma_f32_16x16x32_bf16 v[144:147], v[80:83], v[40:43], v[144:147]
    s_waitcnt lgkmcnt(12)
    v_mfma_f32_16x16x32_bf16 v[148:151], v[84:87], v[40:43], v[148:151]
    s_add_u32 s29, s26, 12288
    buffer_load_dwordx4 v[64:67], v5, s[8:11], s29 offen offset:0
    s_waitcnt lgkmcnt(11)
    v_mfma_f32_16x16x32_bf16 v[152:155], v[88:91], v[40:43], v[152:155]
    s_waitcnt lgkmcnt(10)
    v_mfma_f32_16x16x32_bf16 v[156:159], v[92:95], v[40:43], v[156:159]
    s_waitcnt lgkmcnt(9)
    v_mfma_f32_16x16x32_bf16 v[160:163], v[96:99], v[40:43], v[160:163]
    s_waitcnt lgkmcnt(8)
    v_mfma_f32_16x16x32_bf16 v[164:167], v[100:103], v[40:43], v[164:167]
    v_mfma_f32_16x16x32_bf16 v[168:171], v[176:179], v[44:47], v[168:171]
    v_mfma_f32_16x16x32_bf16 v[172:175], v[44:47], v[44:47], v[172:175]
    s_add_u32 s28, s25, 106496
    s_mov_b32 m0, s28
    s_add_u32 s27, s24, 106496
    buffer_load_dwordx4 v5, s[8:11], s27 offen lds
    s_waitcnt lgkmcnt(7)
    v_mfma_f32_16x16x32_bf16 v[136:139], v[104:107], v[44:47], v[136:139]
    s_waitcnt lgkmcnt(6)
    v_mfma_f32_16x16x32_bf16 v[140:143], v[108:111], v[44:47], v[140:143]
    s_waitcnt lgkmcnt(5)
    v_mfma_f32_16x16x32_bf16 v[144:147], v[112:115], v[44:47], v[144:147]
    s_waitcnt lgkmcnt(4)
    v_mfma_f32_16x16x32_bf16 v[148:151], v[116:119], v[44:47], v[148:151]
    s_add_u32 s29, s26, 12288
    buffer_load_dwordx4 v[68:71], v5, s[8:11], s29 offen offset:1024
    s_waitcnt lgkmcnt(3)
    v_mfma_f32_16x16x32_bf16 v[152:155], v[120:123], v[44:47], v[152:155]
    s_waitcnt lgkmcnt(2)
    v_mfma_f32_16x16x32_bf16 v[156:159], v[124:127], v[44:47], v[156:159]
    s_waitcnt lgkmcnt(1)
    v_mfma_f32_16x16x32_bf16 v[160:163], v[128:131], v[44:47], v[160:163]
    s_waitcnt lgkmcnt(0)
    v_mfma_f32_16x16x32_bf16 v[164:167], v[132:135], v[44:47], v[164:167]
    s_waitcnt vmcnt(8)
    s_barrier
    ds_read_b128 v[72:75], v8 offset:0
    ds_read_b128 v[76:79], v8 offset:1024
    ds_read_b128 v[80:83], v8 offset:2048
    ds_read_b128 v[84:87], v8 offset:3072
    ds_read_b128 v[88:91], v8 offset:4096
    ds_read_b128 v[92:95], v8 offset:5120
    ds_read_b128 v[96:99], v8 offset:6144
    ds_read_b128 v[100:103], v8 offset:7168
    ds_read_b128 v[104:107], v8 offset:8192
    ds_read_b128 v[108:111], v8 offset:9216
    ds_read_b128 v[112:115], v8 offset:10240
    ds_read_b128 v[116:119], v8 offset:11264
    ds_read_b128 v[120:123], v8 offset:12288
    ds_read_b128 v[124:127], v8 offset:13312
    ds_read_b128 v[128:131], v8 offset:14336
    ds_read_b128 v[132:135], v8 offset:15360
    v_mfma_f32_16x16x32_bf16 v[168:171], v[176:179], v[48:51], v[168:171]
    v_mfma_f32_16x16x32_bf16 v[172:175], v[48:51], v[48:51], v[172:175]
    buffer_load_dwordx4 v[180:183], v6, s[8:11], s30 offen offset:0
    buffer_load_dwordx2 v[212:213], v7, s[12:15], s31 offen offset:0
    s_waitcnt lgkmcnt(15)
    v_mfma_f32_16x16x32_bf16 v[136:139], v[72:75], v[48:51], v[136:139]
    s_waitcnt lgkmcnt(14)
    v_mfma_f32_16x16x32_bf16 v[140:143], v[76:79], v[48:51], v[140:143]
    s_waitcnt lgkmcnt(13)
    v_mfma_f32_16x16x32_bf16 v[144:147], v[80:83], v[48:51], v[144:147]
    s_waitcnt lgkmcnt(12)
    v_mfma_f32_16x16x32_bf16 v[148:151], v[84:87], v[48:51], v[148:151]
    buffer_load_dwordx4 v[184:187], v6, s[8:11], s30 offen offset:64
    buffer_load_dwordx2 v[214:215], v7, s[12:15], s31 offen offset:32
    s_waitcnt lgkmcnt(11)
    v_mfma_f32_16x16x32_bf16 v[152:155], v[88:91], v[48:51], v[152:155]
    s_waitcnt lgkmcnt(10)
    v_mfma_f32_16x16x32_bf16 v[156:159], v[92:95], v[48:51], v[156:159]
    s_waitcnt lgkmcnt(9)
    v_mfma_f32_16x16x32_bf16 v[160:163], v[96:99], v[48:51], v[160:163]
    s_waitcnt lgkmcnt(8)
    v_mfma_f32_16x16x32_bf16 v[164:167], v[100:103], v[48:51], v[164:167]
    v_mfma_f32_16x16x32_bf16 v[168:171], v[176:179], v[52:55], v[168:171]
    v_mfma_f32_16x16x32_bf16 v[172:175], v[52:55], v[52:55], v[172:175]
    buffer_load_dwordx4 v[188:191], v6, s[8:11], s30 offen offset:128
    buffer_load_dwordx2 v[216:217], v7, s[12:15], s31 offen offset:64
    s_waitcnt lgkmcnt(7)
    v_mfma_f32_16x16x32_bf16 v[136:139], v[104:107], v[52:55], v[136:139]
    s_waitcnt lgkmcnt(6)
    v_mfma_f32_16x16x32_bf16 v[140:143], v[108:111], v[52:55], v[140:143]
    s_waitcnt lgkmcnt(5)
    v_mfma_f32_16x16x32_bf16 v[144:147], v[112:115], v[52:55], v[144:147]
    s_waitcnt lgkmcnt(4)
    v_mfma_f32_16x16x32_bf16 v[148:151], v[116:119], v[52:55], v[148:151]
    buffer_load_dwordx4 v[192:195], v6, s[8:11], s30 offen offset:192
    buffer_load_dwordx2 v[218:219], v7, s[12:15], s31 offen offset:96
    s_waitcnt lgkmcnt(3)
    v_mfma_f32_16x16x32_bf16 v[152:155], v[120:123], v[52:55], v[152:155]
    s_waitcnt lgkmcnt(2)
    v_mfma_f32_16x16x32_bf16 v[156:159], v[124:127], v[52:55], v[156:159]
    s_waitcnt lgkmcnt(1)
    v_mfma_f32_16x16x32_bf16 v[160:163], v[128:131], v[52:55], v[160:163]
    s_waitcnt lgkmcnt(0)
    v_mfma_f32_16x16x32_bf16 v[164:167], v[132:135], v[52:55], v[164:167]
    s_waitcnt vmcnt(12)
    s_barrier
    ds_read_b128 v[72:75], v8 offset:16384
    ds_read_b128 v[76:79], v8 offset:17408
    ds_read_b128 v[80:83], v8 offset:18432
    ds_read_b128 v[84:87], v8 offset:19456
    ds_read_b128 v[88:91], v8 offset:20480
    ds_read_b128 v[92:95], v8 offset:21504
    ds_read_b128 v[96:99], v8 offset:22528
    ds_read_b128 v[100:103], v8 offset:23552
    ds_read_b128 v[104:107], v8 offset:24576
    ds_read_b128 v[108:111], v8 offset:25600
    ds_read_b128 v[112:115], v8 offset:26624
    ds_read_b128 v[116:119], v8 offset:27648
    ds_read_b128 v[120:123], v8 offset:28672
    ds_read_b128 v[124:127], v8 offset:29696
    ds_read_b128 v[128:131], v8 offset:30720
    ds_read_b128 v[132:135], v8 offset:31744
    v_mfma_f32_16x16x32_bf16 v[168:171], v[176:179], v[56:59], v[168:171]
    v_mfma_f32_16x16x32_bf16 v[172:175], v[56:59], v[56:59], v[172:175]
    buffer_load_dwordx4 v[196:199], v6, s[8:11], s30 offen offset:256
    buffer_load_dwordx2 v[220:221], v7, s[12:15], s31 offen offset:128
    s_waitcnt lgkmcnt(15)
    v_mfma_f32_16x16x32_bf16 v[136:139], v[72:75], v[56:59], v[136:139]
    s_waitcnt lgkmcnt(14)
    v_mfma_f32_16x16x32_bf16 v[140:143], v[76:79], v[56:59], v[140:143]
    s_waitcnt lgkmcnt(13)
    v_mfma_f32_16x16x32_bf16 v[144:147], v[80:83], v[56:59], v[144:147]
    s_waitcnt lgkmcnt(12)
    v_mfma_f32_16x16x32_bf16 v[148:151], v[84:87], v[56:59], v[148:151]
    buffer_load_dwordx4 v[200:203], v6, s[8:11], s30 offen offset:320
    buffer_load_dwordx2 v[222:223], v7, s[12:15], s31 offen offset:160
    s_waitcnt lgkmcnt(11)
    v_mfma_f32_16x16x32_bf16 v[152:155], v[88:91], v[56:59], v[152:155]
    s_waitcnt lgkmcnt(10)
    v_mfma_f32_16x16x32_bf16 v[156:159], v[92:95], v[56:59], v[156:159]
    s_waitcnt lgkmcnt(9)
    v_mfma_f32_16x16x32_bf16 v[160:163], v[96:99], v[56:59], v[160:163]
    s_waitcnt lgkmcnt(8)
    v_mfma_f32_16x16x32_bf16 v[164:167], v[100:103], v[56:59], v[164:167]
    v_mfma_f32_16x16x32_bf16 v[168:171], v[176:179], v[60:63], v[168:171]
    v_mfma_f32_16x16x32_bf16 v[172:175], v[60:63], v[60:63], v[172:175]
    buffer_load_dwordx4 v[204:207], v6, s[8:11], s30 offen offset:384
    buffer_load_dwordx2 v[224:225], v7, s[12:15], s31 offen offset:192
    s_waitcnt lgkmcnt(7)
    v_mfma_f32_16x16x32_bf16 v[136:139], v[104:107], v[60:63], v[136:139]
    s_waitcnt lgkmcnt(6)
    v_mfma_f32_16x16x32_bf16 v[140:143], v[108:111], v[60:63], v[140:143]
    s_waitcnt lgkmcnt(5)
    v_mfma_f32_16x16x32_bf16 v[144:147], v[112:115], v[60:63], v[144:147]
    s_waitcnt lgkmcnt(4)
    v_mfma_f32_16x16x32_bf16 v[148:151], v[116:119], v[60:63], v[148:151]
    buffer_load_dwordx4 v[208:211], v6, s[8:11], s30 offen offset:448
    buffer_load_dwordx2 v[226:227], v7, s[12:15], s31 offen offset:224
    s_waitcnt lgkmcnt(3)
    v_mfma_f32_16x16x32_bf16 v[152:155], v[120:123], v[60:63], v[152:155]
    s_waitcnt lgkmcnt(2)
    v_mfma_f32_16x16x32_bf16 v[156:159], v[124:127], v[60:63], v[156:159]
    s_waitcnt lgkmcnt(1)
    v_mfma_f32_16x16x32_bf16 v[160:163], v[128:131], v[60:63], v[160:163]
    s_waitcnt lgkmcnt(0)
    v_mfma_f32_16x16x32_bf16 v[164:167], v[132:135], v[60:63], v[164:167]
    s_waitcnt vmcnt(16)
    s_barrier
    ds_read_b128 v[72:75], v8 offset:32768
    ds_read_b128 v[76:79], v8 offset:33792
    ds_read_b128 v[80:83], v8 offset:34816
    ds_read_b128 v[84:87], v8 offset:35840
    ds_read_b128 v[88:91], v8 offset:36864
    ds_read_b128 v[92:95], v8 offset:37888
    ds_read_b128 v[96:99], v8 offset:38912
    ds_read_b128 v[100:103], v8 offset:39936
    ds_read_b128 v[104:107], v8 offset:40960
    ds_read_b128 v[108:111], v8 offset:41984
    ds_read_b128 v[112:115], v8 offset:43008
    ds_read_b128 v[116:119], v8 offset:44032
    ds_read_b128 v[120:123], v8 offset:45056
    ds_read_b128 v[124:127], v8 offset:46080
    ds_read_b128 v[128:131], v8 offset:47104
    ds_read_b128 v[132:135], v8 offset:48128
    v_mfma_f32_16x16x32_bf16 v[168:171], v[176:179], v[64:67], v[168:171]
    v_mfma_f32_16x16x32_bf16 v[172:175], v[64:67], v[64:67], v[172:175]
    s_waitcnt lgkmcnt(15)
    v_mfma_f32_16x16x32_bf16 v[136:139], v[72:75], v[64:67], v[136:139]
    s_waitcnt lgkmcnt(14)
    v_mfma_f32_16x16x32_bf16 v[140:143], v[76:79], v[64:67], v[140:143]
    s_waitcnt lgkmcnt(13)
    v_mfma_f32_16x16x32_bf16 v[144:147], v[80:83], v[64:67], v[144:147]
    s_waitcnt lgkmcnt(12)
    v_mfma_f32_16x16x32_bf16 v[148:151], v[84:87], v[64:67], v[148:151]
    s_waitcnt lgkmcnt(11)
    v_mfma_f32_16x16x32_bf16 v[152:155], v[88:91], v[64:67], v[152:155]
    s_waitcnt lgkmcnt(10)
    v_mfma_f32_16x16x32_bf16 v[156:159], v[92:95], v[64:67], v[156:159]
    s_waitcnt lgkmcnt(9)
    v_mfma_f32_16x16x32_bf16 v[160:163], v[96:99], v[64:67], v[160:163]
    s_waitcnt lgkmcnt(8)
    v_mfma_f32_16x16x32_bf16 v[164:167], v[100:103], v[64:67], v[164:167]
    v_mfma_f32_16x16x32_bf16 v[168:171], v[176:179], v[68:71], v[168:171]
    v_mfma_f32_16x16x32_bf16 v[172:175], v[68:71], v[68:71], v[172:175]
    s_waitcnt lgkmcnt(7)
    v_mfma_f32_16x16x32_bf16 v[136:139], v[104:107], v[68:71], v[136:139]
    s_waitcnt lgkmcnt(6)
    v_mfma_f32_16x16x32_bf16 v[140:143], v[108:111], v[68:71], v[140:143]
    s_waitcnt lgkmcnt(5)
    v_mfma_f32_16x16x32_bf16 v[144:147], v[112:115], v[68:71], v[144:147]
    s_waitcnt lgkmcnt(4)
    v_mfma_f32_16x16x32_bf16 v[148:151], v[116:119], v[68:71], v[148:151]
    s_waitcnt lgkmcnt(3)
    v_mfma_f32_16x16x32_bf16 v[152:155], v[120:123], v[68:71], v[152:155]
    s_waitcnt lgkmcnt(2)
    v_mfma_f32_16x16x32_bf16 v[156:159], v[124:127], v[68:71], v[156:159]
    s_waitcnt lgkmcnt(1)
    v_mfma_f32_16x16x32_bf16 v[160:163], v[128:131], v[68:71], v[160:163]
    s_waitcnt lgkmcnt(0)
    v_mfma_f32_16x16x32_bf16 v[164:167], v[132:135], v[68:71], v[164:167]
    v_cndmask_b32 v230, v172, v173, s[40:41]
    v_cndmask_b32 v230, v230, v174, s[42:43]
    v_cndmask_b32 v230, v230, v175, s[44:45]
    v_cndmask_b32 v230, 0, v230, s[46:47]
    v_mov_b32 v231, v230
    s_nop 1
    v_permlane16_swap_b32 v230, v231
    v_add_f32 v230, v230, v231
    v_mov_b32 v231, v230
    s_nop 1
    v_permlane32_swap_b32 v230, v231
    v_add_f32 v230, v230, v231
    v_mul_f32 v231, 991054117, v168
    v_mul_f32 v230, 991054117, v230
    v_fma_f32 v230, -v231, v231, v230
    v_max_f32 v230, 0, v230
    v_add_f32 v230, 925353388, v230
    v_rsq_f32 v229, v230
    s_nop 0
    v_mul_f32 v228, v231, v229
    v_sub_f32 v228, 0, v228
    s_mul_i32 s26, s23, 57344
    s_lshl_b32 s27, s22, 12
    s_add_u32 s26, s26, s27
    s_add_u32 s26, s26, 8388608
    s_mov_b32 s34, 1027024659
    s_mov_b32 s35, 3222493025
    s_waitcnt vmcnt(15)
    v_mul_f32 v16, v228, v180
    v_mul_f32 v17, v228, v181
    v_mul_f32 v18, v228, v182
    v_mul_f32 v19, v228, v183
    s_waitcnt vmcnt(13)
    v_mul_f32 v20, v228, v184
    v_mul_f32 v21, v228, v185
    v_mul_f32 v22, v228, v186
    v_mul_f32 v23, v228, v187
    v_fmac_f32 v16, v136, v229
    v_fmac_f32 v17, v137, v229
    v_fmac_f32 v18, v138, v229
    v_fmac_f32 v19, v139, v229
    v_fmac_f32 v20, v140, v229
    v_fmac_f32 v21, v141, v229
    v_fmac_f32 v22, v142, v229
    v_fmac_f32 v23, v143, v229
    v_cvt_pk_bf16_f32 v232, v16, v17
    v_cvt_pk_bf16_f32 v233, v18, v19
    v_cvt_pk_bf16_f32 v234, v20, v21
    v_cvt_pk_bf16_f32 v235, v22, v23
    v_lshlrev_b32 v16, 16, v232
    v_and_b32 v17, 4294901760, v232
    v_lshlrev_b32 v18, 16, v233
    v_and_b32 v19, 4294901760, v233
    v_lshlrev_b32 v20, 16, v234
    v_and_b32 v21, 4294901760, v234
    v_lshlrev_b32 v22, 16, v235
    v_and_b32 v23, 4294901760, v235
    v_lshlrev_b32 v24, 16, v212
    v_and_b32 v25, 4294901760, v212
    v_lshlrev_b32 v26, 16, v213
    v_and_b32 v27, 4294901760, v213
    s_waitcnt vmcnt(12)
    v_lshlrev_b32 v28, 16, v214
    v_and_b32 v29, 4294901760, v214
    v_lshlrev_b32 v30, 16, v215
    v_and_b32 v31, 4294901760, v215
    v_add_f32 v16, v16, v24
    v_add_f32 v17, v17, v25
    v_add_f32 v18, v18, v26
    v_add_f32 v19, v19, v27
    v_add_f32 v20, v20, v28
    v_add_f32 v21, v21, v29
    v_add_f32 v22, v22, v30
    v_add_f32 v23, v23, v31
    v_cvt_pk_bf16_f32 v232, v16, v17
    v_cvt_pk_bf16_f32 v233, v18, v19
    v_cvt_pk_bf16_f32 v234, v20, v21
    v_cvt_pk_bf16_f32 v235, v22, v23
    v_lshlrev_b32 v16, 16, v232
    v_and_b32 v17, 4294901760, v232
    v_lshlrev_b32 v18, 16, v233
    v_and_b32 v19, 4294901760, v233
    v_lshlrev_b32 v20, 16, v234
    v_and_b32 v21, 4294901760, v234
    v_lshlrev_b32 v22, 16, v235
    v_and_b32 v23, 4294901760, v235
    v_mul_f32 v24, v16, v16
    v_mul_f32 v25, v17, v17
    v_mul_f32 v26, v18, v18
    v_mul_f32 v27, v19, v19
    v_mul_f32 v28, v20, v20
    v_mul_f32 v29, v21, v21
    v_mul_f32 v30, v22, v22
    v_mul_f32 v31, v23, v23
    v_fma_f32 v24, v24, s34, 1.0
    v_fma_f32 v25, v25, s34, 1.0
    v_fma_f32 v26, v26, s34, 1.0
    v_fma_f32 v27, v27, s34, 1.0
    v_fma_f32 v28, v28, s34, 1.0
    v_fma_f32 v29, v29, s34, 1.0
    v_fma_f32 v30, v30, s34, 1.0
    v_fma_f32 v31, v31, s34, 1.0
    v_mul_f32 v24, v24, v16
    v_mul_f32 v25, v25, v17
    v_mul_f32 v26, v26, v18
    v_mul_f32 v27, v27, v19
    v_mul_f32 v28, v28, v20
    v_mul_f32 v29, v29, v21
    v_mul_f32 v30, v30, v22
    v_mul_f32 v31, v31, v23
    v_mul_f32 v24, s35, v24
    v_mul_f32 v25, s35, v25
    v_mul_f32 v26, s35, v26
    v_mul_f32 v27, s35, v27
    v_mul_f32 v28, s35, v28
    v_mul_f32 v29, s35, v29
    v_mul_f32 v30, s35, v30
    v_mul_f32 v31, s35, v31
    v_exp_f32 v24, v24
    v_exp_f32 v25, v25
    v_exp_f32 v26, v26
    v_exp_f32 v27, v27
    v_exp_f32 v28, v28
    v_exp_f32 v29, v29
    v_exp_f32 v30, v30
    v_exp_f32 v31, v31
    v_add_f32 v24, 1.0, v24
    v_add_f32 v25, 1.0, v25
    v_add_f32 v26, 1.0, v26
    v_add_f32 v27, 1.0, v27
    v_add_f32 v28, 1.0, v28
    v_add_f32 v29, 1.0, v29
    v_add_f32 v30, 1.0, v30
    v_add_f32 v31, 1.0, v31
    v_rcp_f32 v24, v24
    v_rcp_f32 v25, v25
    v_rcp_f32 v26, v26
    v_rcp_f32 v27, v27
    v_rcp_f32 v28, v28
    v_rcp_f32 v29, v29
    v_rcp_f32 v30, v30
    v_rcp_f32 v31, v31
    v_mul_f32 v16, v16, v24
    v_mul_f32 v17, v17, v25
    v_mul_f32 v18, v18, v26
    v_mul_f32 v19, v19, v27
    v_mul_f32 v20, v20, v28
    v_mul_f32 v21, v21, v29
    v_mul_f32 v22, v22, v30
    v_mul_f32 v23, v23, v31
    v_cvt_pk_bf16_f32 v236, v16, v17
    v_cvt_pk_bf16_f32 v237, v18, v19
    v_cvt_pk_bf16_f32 v238, v20, v21
    v_cvt_pk_bf16_f32 v239, v22, v23
    buffer_store_dwordx4 v[236:239], v5, s[8:11], s26 offen offset:0 sc1
    s_waitcnt vmcnt(12)
    v_mul_f32 v32, v228, v188
    v_mul_f32 v33, v228, v189
    v_mul_f32 v34, v228, v190
    v_mul_f32 v35, v228, v191
    s_waitcnt vmcnt(10)
    v_mul_f32 v36, v228, v192
    v_mul_f32 v37, v228, v193
    v_mul_f32 v38, v228, v194
    v_mul_f32 v39, v228, v195
    v_fmac_f32 v32, v144, v229
    v_fmac_f32 v33, v145, v229
    v_fmac_f32 v34, v146, v229
    v_fmac_f32 v35, v147, v229
    v_fmac_f32 v36, v148, v229
    v_fmac_f32 v37, v149, v229
    v_fmac_f32 v38, v150, v229
    v_fmac_f32 v39, v151, v229
    v_cvt_pk_bf16_f32 v232, v32, v33
    v_cvt_pk_bf16_f32 v233, v34, v35
    v_cvt_pk_bf16_f32 v234, v36, v37
    v_cvt_pk_bf16_f32 v235, v38, v39
    v_lshlrev_b32 v32, 16, v232
    v_and_b32 v33, 4294901760, v232
    v_lshlrev_b32 v34, 16, v233
    v_and_b32 v35, 4294901760, v233
    v_lshlrev_b32 v36, 16, v234
    v_and_b32 v37, 4294901760, v234
    v_lshlrev_b32 v38, 16, v235
    v_and_b32 v39, 4294901760, v235
    v_lshlrev_b32 v40, 16, v216
    v_and_b32 v41, 4294901760, v216
    v_lshlrev_b32 v42, 16, v217
    v_and_b32 v43, 4294901760, v217
    s_waitcnt vmcnt(9)
    v_lshlrev_b32 v44, 16, v218
    v_and_b32 v45, 4294901760, v218
    v_lshlrev_b32 v46, 16, v219
    v_and_b32 v47, 4294901760, v219
    v_add_f32 v32, v32, v40
    v_add_f32 v33, v33, v41
    v_add_f32 v34, v34, v42
    v_add_f32 v35, v35, v43
    v_add_f32 v36, v36, v44
    v_add_f32 v37, v37, v45
    v_add_f32 v38, v38, v46
    v_add_f32 v39, v39, v47
    v_cvt_pk_bf16_f32 v232, v32, v33
    v_cvt_pk_bf16_f32 v233, v34, v35
    v_cvt_pk_bf16_f32 v234, v36, v37
    v_cvt_pk_bf16_f32 v235, v38, v39
    v_lshlrev_b32 v32, 16, v232
    v_and_b32 v33, 4294901760, v232
    v_lshlrev_b32 v34, 16, v233
    v_and_b32 v35, 4294901760, v233
    v_lshlrev_b32 v36, 16, v234
    v_and_b32 v37, 4294901760, v234
    v_lshlrev_b32 v38, 16, v235
    v_and_b32 v39, 4294901760, v235
    v_mul_f32 v40, v32, v32
    v_mul_f32 v41, v33, v33
    v_mul_f32 v42, v34, v34
    v_mul_f32 v43, v35, v35
    v_mul_f32 v44, v36, v36
    v_mul_f32 v45, v37, v37
    v_mul_f32 v46, v38, v38
    v_mul_f32 v47, v39, v39
    v_fma_f32 v40, v40, s34, 1.0
    v_fma_f32 v41, v41, s34, 1.0
    v_fma_f32 v42, v42, s34, 1.0
    v_fma_f32 v43, v43, s34, 1.0
    v_fma_f32 v44, v44, s34, 1.0
    v_fma_f32 v45, v45, s34, 1.0
    v_fma_f32 v46, v46, s34, 1.0
    v_fma_f32 v47, v47, s34, 1.0
    v_mul_f32 v40, v40, v32
    v_mul_f32 v41, v41, v33
    v_mul_f32 v42, v42, v34
    v_mul_f32 v43, v43, v35
    v_mul_f32 v44, v44, v36
    v_mul_f32 v45, v45, v37
    v_mul_f32 v46, v46, v38
    v_mul_f32 v47, v47, v39
    v_mul_f32 v40, s35, v40
    v_mul_f32 v41, s35, v41
    v_mul_f32 v42, s35, v42
    v_mul_f32 v43, s35, v43
    v_mul_f32 v44, s35, v44
    v_mul_f32 v45, s35, v45
    v_mul_f32 v46, s35, v46
    v_mul_f32 v47, s35, v47
    v_exp_f32 v40, v40
    v_exp_f32 v41, v41
    v_exp_f32 v42, v42
    v_exp_f32 v43, v43
    v_exp_f32 v44, v44
    v_exp_f32 v45, v45
    v_exp_f32 v46, v46
    v_exp_f32 v47, v47
    v_add_f32 v40, 1.0, v40
    v_add_f32 v41, 1.0, v41
    v_add_f32 v42, 1.0, v42
    v_add_f32 v43, 1.0, v43
    v_add_f32 v44, 1.0, v44
    v_add_f32 v45, 1.0, v45
    v_add_f32 v46, 1.0, v46
    v_add_f32 v47, 1.0, v47
    v_rcp_f32 v40, v40
    v_rcp_f32 v41, v41
    v_rcp_f32 v42, v42
    v_rcp_f32 v43, v43
    v_rcp_f32 v44, v44
    v_rcp_f32 v45, v45
    v_rcp_f32 v46, v46
    v_rcp_f32 v47, v47
    v_mul_f32 v32, v32, v40
    v_mul_f32 v33, v33, v41
    v_mul_f32 v34, v34, v42
    v_mul_f32 v35, v35, v43
    v_mul_f32 v36, v36, v44
    v_mul_f32 v37, v37, v45
    v_mul_f32 v38, v38, v46
    v_mul_f32 v39, v39, v47
    v_cvt_pk_bf16_f32 v240, v32, v33
    v_cvt_pk_bf16_f32 v241, v34, v35
    v_cvt_pk_bf16_f32 v242, v36, v37
    v_cvt_pk_bf16_f32 v243, v38, v39
    buffer_store_dwordx4 v[240:243], v5, s[8:11], s26 offen offset:1024 sc1
    s_waitcnt vmcnt(9)
    v_mul_f32 v16, v228, v196
    v_mul_f32 v17, v228, v197
    v_mul_f32 v18, v228, v198
    v_mul_f32 v19, v228, v199
    s_waitcnt vmcnt(7)
    v_mul_f32 v20, v228, v200
    v_mul_f32 v21, v228, v201
    v_mul_f32 v22, v228, v202
    v_mul_f32 v23, v228, v203
    v_fmac_f32 v16, v152, v229
    v_fmac_f32 v17, v153, v229
    v_fmac_f32 v18, v154, v229
    v_fmac_f32 v19, v155, v229
    v_fmac_f32 v20, v156, v229
    v_fmac_f32 v21, v157, v229
    v_fmac_f32 v22, v158, v229
    v_fmac_f32 v23, v159, v229
    v_cvt_pk_bf16_f32 v232, v16, v17
    v_cvt_pk_bf16_f32 v233, v18, v19
    v_cvt_pk_bf16_f32 v234, v20, v21
    v_cvt_pk_bf16_f32 v235, v22, v23
    v_lshlrev_b32 v16, 16, v232
    v_and_b32 v17, 4294901760, v232
    v_lshlrev_b32 v18, 16, v233
    v_and_b32 v19, 4294901760, v233
    v_lshlrev_b32 v20, 16, v234
    v_and_b32 v21, 4294901760, v234
    v_lshlrev_b32 v22, 16, v235
    v_and_b32 v23, 4294901760, v235
    v_lshlrev_b32 v24, 16, v220
    v_and_b32 v25, 4294901760, v220
    v_lshlrev_b32 v26, 16, v221
    v_and_b32 v27, 4294901760, v221
    s_waitcnt vmcnt(6)
    v_lshlrev_b32 v28, 16, v222
    v_and_b32 v29, 4294901760, v222
    v_lshlrev_b32 v30, 16, v223
    v_and_b32 v31, 4294901760, v223
    v_add_f32 v16, v16, v24
    v_add_f32 v17, v17, v25
    v_add_f32 v18, v18, v26
    v_add_f32 v19, v19, v27
    v_add_f32 v20, v20, v28
    v_add_f32 v21, v21, v29
    v_add_f32 v22, v22, v30
    v_add_f32 v23, v23, v31
    v_cvt_pk_bf16_f32 v232, v16, v17
    v_cvt_pk_bf16_f32 v233, v18, v19
    v_cvt_pk_bf16_f32 v234, v20, v21
    v_cvt_pk_bf16_f32 v235, v22, v23
    v_lshlrev_b32 v16, 16, v232
    v_and_b32 v17, 4294901760, v232
    v_lshlrev_b32 v18, 16, v233
    v_and_b32 v19, 4294901760, v233
    v_lshlrev_b32 v20, 16, v234
    v_and_b32 v21, 4294901760, v234
    v_lshlrev_b32 v22, 16, v235
    v_and_b32 v23, 4294901760, v235
    v_mul_f32 v24, v16, v16
    v_mul_f32 v25, v17, v17
    v_mul_f32 v26, v18, v18
    v_mul_f32 v27, v19, v19
    v_mul_f32 v28, v20, v20
    v_mul_f32 v29, v21, v21
    v_mul_f32 v30, v22, v22
    v_mul_f32 v31, v23, v23
    v_fma_f32 v24, v24, s34, 1.0
    v_fma_f32 v25, v25, s34, 1.0
    v_fma_f32 v26, v26, s34, 1.0
    v_fma_f32 v27, v27, s34, 1.0
    v_fma_f32 v28, v28, s34, 1.0
    v_fma_f32 v29, v29, s34, 1.0
    v_fma_f32 v30, v30, s34, 1.0
    v_fma_f32 v31, v31, s34, 1.0
    v_mul_f32 v24, v24, v16
    v_mul_f32 v25, v25, v17
    v_mul_f32 v26, v26, v18
    v_mul_f32 v27, v27, v19
    v_mul_f32 v28, v28, v20
    v_mul_f32 v29, v29, v21
    v_mul_f32 v30, v30, v22
    v_mul_f32 v31, v31, v23
    v_mul_f32 v24, s35, v24
    v_mul_f32 v25, s35, v25
    v_mul_f32 v26, s35, v26
    v_mul_f32 v27, s35, v27
    v_mul_f32 v28, s35, v28
    v_mul_f32 v29, s35, v29
    v_mul_f32 v30, s35, v30
    v_mul_f32 v31, s35, v31
    v_exp_f32 v24, v24
    v_exp_f32 v25, v25
    v_exp_f32 v26, v26
    v_exp_f32 v27, v27
    v_exp_f32 v28, v28
    v_exp_f32 v29, v29
    v_exp_f32 v30, v30
    v_exp_f32 v31, v31
    v_add_f32 v24, 1.0, v24
    v_add_f32 v25, 1.0, v25
    v_add_f32 v26, 1.0, v26
    v_add_f32 v27, 1.0, v27
    v_add_f32 v28, 1.0, v28
    v_add_f32 v29, 1.0, v29
    v_add_f32 v30, 1.0, v30
    v_add_f32 v31, 1.0, v31
    v_rcp_f32 v24, v24
    v_rcp_f32 v25, v25
    v_rcp_f32 v26, v26
    v_rcp_f32 v27, v27
    v_rcp_f32 v28, v28
    v_rcp_f32 v29, v29
    v_rcp_f32 v30, v30
    v_rcp_f32 v31, v31
    v_mul_f32 v16, v16, v24
    v_mul_f32 v17, v17, v25
    v_mul_f32 v18, v18, v26
    v_mul_f32 v19, v19, v27
    v_mul_f32 v20, v20, v28
    v_mul_f32 v21, v21, v29
    v_mul_f32 v22, v22, v30
    v_mul_f32 v23, v23, v31
    v_cvt_pk_bf16_f32 v236, v16, v17
    v_cvt_pk_bf16_f32 v237, v18, v19
    v_cvt_pk_bf16_f32 v238, v20, v21
    v_cvt_pk_bf16_f32 v239, v22, v23
    buffer_store_dwordx4 v[236:239], v5, s[8:11], s26 offen offset:2048 sc1
    s_waitcnt vmcnt(6)
    v_mul_f32 v32, v228, v204
    v_mul_f32 v33, v228, v205
    v_mul_f32 v34, v228, v206
    v_mul_f32 v35, v228, v207
    s_waitcnt vmcnt(4)
    v_mul_f32 v36, v228, v208
    v_mul_f32 v37, v228, v209
    v_mul_f32 v38, v228, v210
    v_mul_f32 v39, v228, v211
    v_fmac_f32 v32, v160, v229
    v_fmac_f32 v33, v161, v229
    v_fmac_f32 v34, v162, v229
    v_fmac_f32 v35, v163, v229
    v_fmac_f32 v36, v164, v229
    v_fmac_f32 v37, v165, v229
    v_fmac_f32 v38, v166, v229
    v_fmac_f32 v39, v167, v229
    v_cvt_pk_bf16_f32 v232, v32, v33
    v_cvt_pk_bf16_f32 v233, v34, v35
    v_cvt_pk_bf16_f32 v234, v36, v37
    v_cvt_pk_bf16_f32 v235, v38, v39
    v_lshlrev_b32 v32, 16, v232
    v_and_b32 v33, 4294901760, v232
    v_lshlrev_b32 v34, 16, v233
    v_and_b32 v35, 4294901760, v233
    v_lshlrev_b32 v36, 16, v234
    v_and_b32 v37, 4294901760, v234
    v_lshlrev_b32 v38, 16, v235
    v_and_b32 v39, 4294901760, v235
    v_lshlrev_b32 v40, 16, v224
    v_and_b32 v41, 4294901760, v224
    v_lshlrev_b32 v42, 16, v225
    v_and_b32 v43, 4294901760, v225
    s_waitcnt vmcnt(3)
    v_lshlrev_b32 v44, 16, v226
    v_and_b32 v45, 4294901760, v226
    v_lshlrev_b32 v46, 16, v227
    v_and_b32 v47, 4294901760, v227
    v_add_f32 v32, v32, v40
    v_add_f32 v33, v33, v41
    v_add_f32 v34, v34, v42
    v_add_f32 v35, v35, v43
    v_add_f32 v36, v36, v44
    v_add_f32 v37, v37, v45
    v_add_f32 v38, v38, v46
    v_add_f32 v39, v39, v47
    v_cvt_pk_bf16_f32 v232, v32, v33
    v_cvt_pk_bf16_f32 v233, v34, v35
    v_cvt_pk_bf16_f32 v234, v36, v37
    v_cvt_pk_bf16_f32 v235, v38, v39
    v_lshlrev_b32 v32, 16, v232
    v_and_b32 v33, 4294901760, v232
    v_lshlrev_b32 v34, 16, v233
    v_and_b32 v35, 4294901760, v233
    v_lshlrev_b32 v36, 16, v234
    v_and_b32 v37, 4294901760, v234
    v_lshlrev_b32 v38, 16, v235
    v_and_b32 v39, 4294901760, v235
    v_mul_f32 v40, v32, v32
    v_mul_f32 v41, v33, v33
    v_mul_f32 v42, v34, v34
    v_mul_f32 v43, v35, v35
    v_mul_f32 v44, v36, v36
    v_mul_f32 v45, v37, v37
    v_mul_f32 v46, v38, v38
    v_mul_f32 v47, v39, v39
    v_fma_f32 v40, v40, s34, 1.0
    v_fma_f32 v41, v41, s34, 1.0
    v_fma_f32 v42, v42, s34, 1.0
    v_fma_f32 v43, v43, s34, 1.0
    v_fma_f32 v44, v44, s34, 1.0
    v_fma_f32 v45, v45, s34, 1.0
    v_fma_f32 v46, v46, s34, 1.0
    v_fma_f32 v47, v47, s34, 1.0
    v_mul_f32 v40, v40, v32
    v_mul_f32 v41, v41, v33
    v_mul_f32 v42, v42, v34
    v_mul_f32 v43, v43, v35
    v_mul_f32 v44, v44, v36
    v_mul_f32 v45, v45, v37
    v_mul_f32 v46, v46, v38
    v_mul_f32 v47, v47, v39
    v_mul_f32 v40, s35, v40
    v_mul_f32 v41, s35, v41
    v_mul_f32 v42, s35, v42
    v_mul_f32 v43, s35, v43
    v_mul_f32 v44, s35, v44
    v_mul_f32 v45, s35, v45
    v_mul_f32 v46, s35, v46
    v_mul_f32 v47, s35, v47
    v_exp_f32 v40, v40
    v_exp_f32 v41, v41
    v_exp_f32 v42, v42
    v_exp_f32 v43, v43
    v_exp_f32 v44, v44
    v_exp_f32 v45, v45
    v_exp_f32 v46, v46
    v_exp_f32 v47, v47
    v_add_f32 v40, 1.0, v40
    v_add_f32 v41, 1.0, v41
    v_add_f32 v42, 1.0, v42
    v_add_f32 v43, 1.0, v43
    v_add_f32 v44, 1.0, v44
    v_add_f32 v45, 1.0, v45
    v_add_f32 v46, 1.0, v46
    v_add_f32 v47, 1.0, v47
    v_rcp_f32 v40, v40
    v_rcp_f32 v41, v41
    v_rcp_f32 v42, v42
    v_rcp_f32 v43, v43
    v_rcp_f32 v44, v44
    v_rcp_f32 v45, v45
    v_rcp_f32 v46, v46
    v_rcp_f32 v47, v47
    v_mul_f32 v32, v32, v40
    v_mul_f32 v33, v33, v41
    v_mul_f32 v34, v34, v42
    v_mul_f32 v35, v35, v43
    v_mul_f32 v36, v36, v44
    v_mul_f32 v37, v37, v45
    v_mul_f32 v38, v38, v46
    v_mul_f32 v39, v39, v47
    v_cvt_pk_bf16_f32 v240, v32, v33
    v_cvt_pk_bf16_f32 v241, v34, v35
    v_cvt_pk_bf16_f32 v242, v36, v37
    v_cvt_pk_bf16_f32 v243, v38, v39
    buffer_store_dwordx4 v[240:243], v5, s[8:11], s26 offen offset:3072 sc1
    s_nop 4
L_end_k3b_kernel:
    s_endpgm

.globl k4b_kernel
.p2align 8
.type k4b_kernel,@function
k4b_kernel:
    s_cmp_ge_u32 s2, 224
    s_cbranch_scc1 L_end_k4b_kernel
    s_load_dwordx2 s[4:5], s[0:1], 88
    s_load_dwordx2 s[12:13], s[0:1], 64
    s_load_dwordx2 s[16:17], s[0:1], 72
    v_and_b32 v1, 63, v0
    v_lshrrev_b32 v2, 6, v0
    s_nop 0
    v_readfirstlane_b32 s20, v2
    v_and_b32 v3, 15, v1
    v_lshrrev_b32 v4, 4, v1
    v_lshlrev_b32 v5, 4, v1
    s_waitcnt lgkmcnt(0)
    s_mov_b32 s8, s4
    s_and_b32 s9, s5, 65535
    s_mov_b32 s10, 268435456
    s_mov_b32 s11, 131072
    s_and_b32 s13, s13, 65535
    s_mov_b32 s14, 896
    s_mov_b32 s15, 131072
    s_and_b32 s17, s17, 65535
    s_mov_b32 s18, 1835008
    s_mov_b32 s19, 131072
    s_and_b32 s26, s2, 7
    s_lshr_b32 s27, s2, 3
    s_mul_i32 s28, s27, 37
    s_lshr_b32 s28, s28, 8
    s_mul_i32 s22, s28, 7
    s_sub_u32 s22, s27, s22
    s_lshl_b32 s21, s26, 2
    s_add_u32 s21, s21, s28
    s_mul_i32 s26, s22, 229376
    s_mul_i32 s27, s20, 7168
    s_add_u32 s26, s26, s27
    s_add_u32 s26, s26, 27262976
    s_mul_i32 s28, s21, 229376
    s_add_u32 s28, s28, s27
    s_add_u32 s28, s28, 8388608
    s_add_u32 s29, s28, 0
    buffer_load_dwordx4 v[144:147], v5, s[8:11], s29 offen
    s_add_u32 s29, s26, 0
    buffer_load_dwordx4 v[80:83], v5, s[8:11], s29 offen
    s_add_u32 s29, s28, 57344
    buffer_load_dwordx4 v[148:151], v5, s[8:11], s29 offen
    s_add_u32 s29, s26, 57344
    buffer_load_dwordx4 v[84:87], v5, s[8:11], s29 offen
    s_add_u32 s29, s28, 114688
    buffer_load_dwordx4 v[152:155], v5, s[8:11], s29 offen
    s_add_u32 s29, s26, 114688
    buffer_load_dwordx4 v[88:91], v5, s[8:11], s29 offen
    s_add_u32 s29, s28, 172032
    buffer_load_dwordx4 v[156:159], v5, s[8:11], s29 offen
    s_add_u32 s29, s26, 172032
    buffer_load_dwordx4 v[92:95], v5, s[8:11], s29 offen
    s_add_u32 s29, s28, 1024
    buffer_load_dwordx4 v[160:163], v5, s[8:11], s29 offen
    s_add_u32 s29, s26, 1024
    buffer_load_dwordx4 v[96:99], v5, s[8:11], s29 offen
    s_add_u32 s29, s28, 58368
    buffer_load_dwordx4 v[164:167], v5, s[8:11], s29 offen
    s_add_u32 s29, s26, 58368
    buffer_load_dwordx4 v[100:103], v5, s[8:11], s29 offen
    s_add_u32 s29, s28, 115712
    buffer_load_dwordx4 v[168:171], v5, s[8:11], s29 offen
    s_add_u32 s29, s26, 115712
    buffer_load_dwordx4 v[104:107], v5, s[8:11], s29 offen
    s_add_u32 s29, s28, 173056
    buffer_load_dwordx4 v[172:175], v5, s[8:11], s29 offen
    s_add_u32 s29, s26, 173056
    buffer_load_dwordx4 v[108:111], v5, s[8:11], s29 offen
    s_add_u32 s29, s28, 2048
    buffer_load_dwordx4 v[176:179], v5, s[8:11], s29 offen
    s_add_u32 s29, s26, 2048
    buffer_load_dwordx4 v[112:115], v5, s[8:11], s29 offen
    s_add_u32 s29, s28, 59392
    buffer_load_dwordx4 v[180:183], v5, s[8:11], s29 offen
    s_add_u32 s29, s26, 59392
    buffer_load_dwordx4 v[116:119], v5, s[8:11], s29 offen
    s_add_u32 s29, s28, 116736
    buffer_load_dwordx4 v[184:187], v5, s[8:11], s29 offen
    s_add_u32 s29, s26, 116736
    buffer_load_dwordx4 v[120:123], v5, s[8:11], s29 offen
    s_add_u32 s29, s28, 174080
    buffer_load_dwordx4 v[188:191], v5, s[8:11], s29 offen
    s_add_u32 s29, s26, 174080
    buffer_load_dwordx4 v[124:127], v5, s[8:11], s29 offen
    s_add_u32 s29, s28, 3072
    buffer_load_dwordx4 v[192:195], v5, s[8:11], s29 offen
    s_add_u32 s29, s26, 3072
    buffer_load_dwordx4 v[128:131], v5, s[8:11], s29 offen
    s_add_u32 s29, s28, 60416
    buffer_load_dwordx4 v[196:199], v5, s[8:11], s29 offen
    s_add_u32 s29, s26, 60416
    buffer_load_dwordx4 v[132:135], v5, s[8:11], s29 offen
    s_add_u32 s29, s28, 117760
    buffer_load_dwordx4 v[200:203], v5, s[8:11], s29 offen
    s_add_u32 s29, s26, 117760
    buffer_load_dwordx4 v[136:139], v5, s[8:11], s29 offen
    s_add_u32 s29, s28, 175104
    buffer_load_dwordx4 v[204:207], v5, s[8:11], s29 offen
    s_add_u32 s29, s26, 175104
    buffer_load_dwordx4 v[140:143], v5, s[8:11], s29 offen
    s_waitcnt vmcnt(30)
    v_mfma_f32_16x16x32_bf16 v[16:19], v[80:83], v[144:147], 0
    s_waitcnt vmcnt(28)
    v_mfma_f32_16x16x32_bf16 v[20:23], v[84:87], v[144:147], 0
    s_waitcnt vmcnt(26)
    v_mfma_f32_16x16x32_bf16 v[24:27], v[88:91], v[144:147], 0
    s_waitcnt vmcnt(24)
    v_mfma_f32_16x16x32_bf16 v[28:31], v[92:95], v[144:147], 0
    v_mfma_f32_16x16x32_bf16 v[32:35], v[80:83], v[148:151], 0
    v_mfma_f32_16x16x32_bf16 v[36:39], v[84:87], v[148:151], 0
    v_mfma_f32_16x16x32_bf16 v[40:43], v[88:91], v[148:151], 0
    v_mfma_f32_16x16x32_bf16 v[44:47], v[92:95], v[148:151], 0
    v_mfma_f32_16x16x32_bf16 v[48:51], v[80:83], v[152:155], 0
    v_mfma_f32_16x16x32_bf16 v[52:55], v[84:87], v[152:155], 0
    v_mfma_f32_16x16x32_bf16 v[56:59], v[88:91], v[152:155], 0
    v_mfma_f32_16x16x32_bf16 v[60:63], v[92:95], v[152:155], 0
    v_mfma_f32_16x16x32_bf16 v[64:67], v[80:83], v[156:159], 0
    v_mfma_f32_16x16x32_bf16 v[68:71], v[84:87], v[156:159], 0
    v_mfma_f32_16x16x32_bf16 v[72:75], v[88:91], v[156:159], 0
    v_mfma_f32_16x16x32_bf16 v[76:79], v[92:95], v[156:159], 0
    s_add_u32 s29, s28, 4096
    buffer_load_dwordx4 v[144:147], v5, s[8:11], s29 offen
    s_add_u32 s29, s26, 4096
    buffer_load_dwordx4 v[80:83], v5, s[8:11], s29 offen
    s_add_u32 s29, s28, 61440
    buffer_load_dwordx4 v[148:151], v5, s[8:11], s29 offen
    s_add_u32 s29, s26, 61440
    buffer_load_dwordx4 v[84:87], v5, s[8:11], s29 offen
    s_add_u32 s29, s28, 118784
    buffer_load_dwordx4 v[152:155], v5, s[8:11], s29 offen
    s_add_u32 s29, s26, 118784
    buffer_load_dwordx4 v[88:91], v5, s[8:11], s29 offen
    s_add_u32 s29, s28, 176128
    buffer_load_dwordx4 v[156:159], v5, s[8:11], s29 offen
    s_add_u32 s29, s26, 176128
    buffer_load_dwordx4 v[92:95], v5, s[8:11], s29 offen
    s_waitcnt vmcnt(30)
    v_mfma_f32_16x16x32_bf16 v[16:19], v[96:99], v[160:163], v[16:19]
    s_waitcnt vmcnt(28)
    v_mfma_f32_16x16x32_bf16 v[20:23], v[100:103], v[160:163], v[20:23]
    s_waitcnt vmcnt(26)
    v_mfma_f32_16x16x32_bf16 v[24:27], v[104:107], v[160:163], v[24:27]
    s_waitcnt vmcnt(24)
    v_mfma_f32_16x16x32_bf16 v[28:31], v[108:111], v[160:163], v[28:31]
    v_mfma_f32_16x16x32_bf16 v[32:35], v[96:99], v[164:167], v[32:35]
    v_mfma_f32_16x16x32_bf16 v[36:39], v[100:103], v[164:167], v[36:39]
    v_mfma_f32_16x16x32_bf16 v[40:43], v[104:107], v[164:167], v[40:43]
    v_mfma_f32_16x16x32_bf16 v[44:47], v[108:111], v[164:167], v[44:47]
    v_mfma_f32_16x16x32_bf16 v[48:51], v[96:99], v[168:171], v[48:51]
    v_mfma_f32_16x16x32_bf16 v[52:55], v[100:103], v[168:171], v[52:55]
    v_mfma_f32_16x16x32_bf16 v[56:59], v[104:107], v[168:171], v[56:59]
    v_mfma_f32_16x16x32_bf16 v[60:63], v[108:111], v[168:171], v[60:63]
    v_mfma_f32_16x16x32_bf16 v[64:67], v[96:99], v[172:175], v[64:67]
    v_mfma_f32_16x16x32_bf16 v[68:71], v[100:103], v[172:175], v[68:71]
    v_mfma_f32_16x16x32_bf16 v[72:75], v[104:107], v[172:175], v[72:75]
    v_mfma_f32_16x16x32_bf16 v[76:79], v[108:111], v[172:175], v[76:79]
    s_add_u32 s29, s28, 5120
    buffer_load_dwordx4 v[160:163], v5, s[8:11], s29 offen
    s_add_u32 s29, s26, 5120
    buffer_load_dwordx4 v[96:99], v5, s[8:11], s29 offen
    s_add_u32 s29, s28, 62464
    buffer_load_dwordx4 v[164:167], v5, s[8:11], s29 offen
    s_add_u32 s29, s26, 62464
    buffer_load_dwordx4 v[100:103], v5, s[8:11], s29 offen
    s_add_u32 s29, s28, 119808
    buffer_load_dwordx4 v[168:171], v5, s[8:11], s29 offen
    s_add_u32 s29, s26, 119808
    buffer_load_dwordx4 v[104:107], v5, s[8:11], s29 offen
    s_add_u32 s29, s28, 177152
    buffer_load_dwordx4 v[172:175], v5, s[8:11], s29 offen
    s_add_u32 s29, s26, 177152
    buffer_load_dwordx4 v[108:111], v5, s[8:11], s29 offen
    s_waitcnt vmcnt(30)
    v_mfma_f32_16x16x32_bf16 v[16:19], v[112:115], v[176:179], v[16:19]
    s_waitcnt vmcnt(28)
    v_mfma_f32_16x16x32_bf16 v[20:23], v[116:119], v[176:179], v[20:23]
    s_waitcnt vmcnt(26)
    v_mfma_f32_16x16x32_bf16 v[24:27], v[120:123], v[176:179], v[24:27]
    s_waitcnt vmcnt(24)
    v_mfma_f32_16x16x32_bf16 v[28:31], v[124:127], v[176:179], v[28:31]
    v_mfma_f32_16x16x32_bf16 v[32:35], v[112:115], v[180:183], v[32:35]
    v_mfma_f32_16x16x32_bf16 v[36:39], v[116:119], v[180:183], v[36:39]
    v_mfma_f32_16x16x32_bf16 v[40:43], v[120:123], v[180:183], v[40:43]
    v_mfma_f32_16x16x32_bf16 v[44:47], v[124:127], v[180:183], v[44:47]
    v_mfma_f32_16x16x32_bf16 v[48:51], v[112:115], v[184:187], v[48:51]
    v_mfma_f32_16x16x32_bf16 v[52:55], v[116:119], v[184:187], v[52:55]
    v_mfma_f32_16x16x32_bf16 v[56:59], v[120:123], v[184:187], v[56:59]
    v_mfma_f32_16x16x32_bf16 v[60:63], v[124:127], v[184:187], v[60:63]
    v_mfma_f32_16x16x32_bf16 v[64:67], v[112:115], v[188:191], v[64:67]
    v_mfma_f32_16x16x32_bf16 v[68:71], v[116:119], v[188:191], v[68:71]
    v_mfma_f32_16x16x32_bf16 v[72:75], v[120:123], v[188:191], v[72:75]
    v_mfma_f32_16x16x32_bf16 v[76:79], v[124:127], v[188:191], v[76:79]
    s_add_u32 s29, s28, 6144
    buffer_load_dwordx4 v[176:179], v5, s[8:11], s29 offen
    s_add_u32 s29, s26, 6144
    buffer_load_dwordx4 v[112:115], v5, s[8:11], s29 offen
    s_add_u32 s29, s28, 63488
    buffer_load_dwordx4 v[180:183], v5, s[8:11], s29 offen
    s_add_u32 s29, s26, 63488
    buffer_load_dwordx4 v[116:119], v5, s[8:11], s29 offen
    s_add_u32 s29, s28, 120832
    buffer_load_dwordx4 v[184:187], v5, s[8:11], s29 offen
    s_add_u32 s29, s26, 120832
    buffer_load_dwordx4 v[120:123], v5, s[8:11], s29 offen
    s_add_u32 s29, s28, 178176
    buffer_load_dwordx4 v[188:191], v5, s[8:11], s29 offen
    s_add_u32 s29, s26, 178176
    buffer_load_dwordx4 v[124:127], v5, s[8:11], s29 offen
    s_waitcnt vmcnt(30)
    v_mfma_f32_16x16x32_bf16 v[16:19], v[128:131], v[192:195], v[16:19]
    s_waitcnt vmcnt(28)
    v_mfma_f32_16x16x32_bf16 v[20:23], v[132:135], v[192:195], v[20:23]
    s_waitcnt vmcnt(26)
    v_mfma_f32_16x16x32_bf16 v[24:27], v[136:139], v[192:195], v[24:27]
    s_waitcnt vmcnt(24)
    v_mfma_f32_16x16x32_bf16 v[28:31], v[140:143], v[192:195], v[28:31]
    v_mfma_f32_16x16x32_bf16 v[32:35], v[128:131], v[196:199], v[32:35]
    v_mfma_f32_16x16x32_bf16 v[36:39], v[132:135], v[196:199], v[36:39]
    v_mfma_f32_16x16x32_bf16 v[40:43], v[136:139], v[196:199], v[40:43]
    v_mfma_f32_16x16x32_bf16 v[44:47], v[140:143], v[196:199], v[44:47]
    v_mfma_f32_16x16x32_bf16 v[48:51], v[128:131], v[200:203], v[48:51]
    v_mfma_f32_16x16x32_bf16 v[52:55], v[132:135], v[200:203], v[52:55]
    v_mfma_f32_16x16x32_bf16 v[56:59], v[136:139], v[200:203], v[56:59]
    v_mfma_f32_16x16x32_bf16 v[60:63], v[140:143], v[200:203], v[60:63]
    v_mfma_f32_16x16x32_bf16 v[64:67], v[128:131], v[204:207], v[64:67]
    v_mfma_f32_16x16x32_bf16 v[68:71], v[132:135], v[204:207], v[68:71]
    v_mfma_f32_16x16x32_bf16 v[72:75], v[136:139], v[204:207], v[72:75]
    v_mfma_f32_16x16x32_bf16 v[76:79], v[140:143], v[204:207], v[76:79]
    s_waitcnt vmcnt(22)
    v_mfma_f32_16x16x32_bf16 v[16:19], v[80:83], v[144:147], v[16:19]
    s_waitcnt vmcnt(20)
    v_mfma_f32_16x16x32_bf16 v[20:23], v[84:87], v[144:147], v[20:23]
    s_waitcnt vmcnt(18)
    v_mfma_f32_16x16x32_bf16 v[24:27], v[88:91], v[144:147], v[24:27]
    s_waitcnt vmcnt(16)
    v_mfma_f32_16x16x32_bf16 v[28:31], v[92:95], v[144:147], v[28:31]
    v_mfma_f32_16x16x32_bf16 v[32:35], v[80:83], v[148:151], v[32:35]
    v_mfma_f32_16x16x32_bf16 v[36:39], v[84:87], v[148:151], v[36:39]
    v_mfma_f32_16x16x32_bf16 v[40:43], v[88:91], v[148:151], v[40:43]
    v_mfma_f32_16x16x32_bf16 v[44:47], v[92:95], v[148:151], v[44:47]
    v_mfma_f32_16x16x32_bf16 v[48:51], v[80:83], v[152:155], v[48:51]
    v_mfma_f32_16x16x32_bf16 v[52:55], v[84:87], v[152:155], v[52:55]
    v_mfma_f32_16x16x32_bf16 v[56:59], v[88:91], v[152:155], v[56:59]
    v_mfma_f32_16x16x32_bf16 v[60:63], v[92:95], v[152:155], v[60:63]
    v_mfma_f32_16x16x32_bf16 v[64:67], v[80:83], v[156:159], v[64:67]
    v_mfma_f32_16x16x32_bf16 v[68:71], v[84:87], v[156:159], v[68:71]
    v_mfma_f32_16x16x32_bf16 v[72:75], v[88:91], v[156:159], v[72:75]
    v_mfma_f32_16x16x32_bf16 v[76:79], v[92:95], v[156:159], v[76:79]
    s_waitcnt vmcnt(14)
    v_mfma_f32_16x16x32_bf16 v[16:19], v[96:99], v[160:163], v[16:19]
    s_waitcnt vmcnt(12)
    v_mfma_f32_16x16x32_bf16 v[20:23], v[100:103], v[160:163], v[20:23]
    s_waitcnt vmcnt(10)
    v_mfma_f32_16x16x32_bf16 v[24:27], v[104:107], v[160:163], v[24:27]
    s_waitcnt vmcnt(8)
    v_mfma_f32_16x16x32_bf16 v[28:31], v[108:111], v[160:163], v[28:31]
    v_mfma_f32_16x16x32_bf16 v[32:35], v[96:99], v[164:167], v[32:35]
    v_mfma_f32_16x16x32_bf16 v[36:39], v[100:103], v[164:167], v[36:39]
    v_mfma_f32_16x16x32_bf16 v[40:43], v[104:107], v[164:167], v[40:43]
    v_mfma_f32_16x16x32_bf16 v[44:47], v[108:111], v[164:167], v[44:47]
    v_mfma_f32_16x16x32_bf16 v[48:51], v[96:99], v[168:171], v[48:51]
    v_mfma_f32_16x16x32_bf16 v[52:55], v[100:103], v[168:171], v[52:55]
    v_mfma_f32_16x16x32_bf16 v[56:59], v[104:107], v[168:171], v[56:59]
    v_mfma_f32_16x16x32_bf16 v[60:63], v[108:111], v[168:171], v[60:63]
    v_mfma_f32_16x16x32_bf16 v[64:67], v[96:99], v[172:175], v[64:67]
    v_mfma_f32_16x16x32_bf16 v[68:71], v[100:103], v[172:175], v[68:71]
    v_mfma_f32_16x16x32_bf16 v[72:75], v[104:107], v[172:175], v[72:75]
    v_mfma_f32_16x16x32_bf16 v[76:79], v[108:111], v[172:175], v[76:79]
    s_waitcnt vmcnt(6)
    v_mfma_f32_16x16x32_bf16 v[16:19], v[112:115], v[176:179], v[16:19]
    s_waitcnt vmcnt(4)
    v_mfma_f32_16x16x32_bf16 v[20:23], v[116:119], v[176:179], v[20:23]
    s_waitcnt vmcnt(2)
    v_mfma_f32_16x16x32_bf16 v[24:27], v[120:123], v[176:179], v[24:27]
    s_waitcnt vmcnt(0)
    v_mfma_f32_16x16x32_bf16 v[28:31], v[124:127], v[176:179], v[28:31]
    v_mfma_f32_16x16x32_bf16 v[32:35], v[112:115], v[180:183], v[32:35]
    v_mfma_f32_16x16x32_bf16 v[36:39], v[116:119], v[180:183], v[36:39]
    v_mfma_f32_16x16x32_bf16 v[40:43], v[120:123], v[180:183], v[40:43]
    v_mfma_f32_16x16x32_bf16 v[44:47], v[124:127], v[180:183], v[44:47]
    v_mfma_f32_16x16x32_bf16 v[48:51], v[112:115], v[184:187], v[48:51]
    v_mfma_f32_16x16x32_bf16 v[52:55], v[116:119], v[184:187], v[52:55]
    v_mfma_f32_16x16x32_bf16 v[56:59], v[120:123], v[184:187], v[56:59]
    v_mfma_f32_16x16x32_bf16 v[60:63], v[124:127], v[184:187], v[60:63]
    v_mfma_f32_16x16x32_bf16 v[64:67], v[112:115], v[188:191], v[64:67]
    v_mfma_f32_16x16x32_bf16 v[68:71], v[116:119], v[188:191], v[68:71]
    v_mfma_f32_16x16x32_bf16 v[72:75], v[120:123], v[188:191], v[72:75]
    v_mfma_f32_16x16x32_bf16 v[76:79], v[124:127], v[188:191], v[76:79]
    s_nop 7
    s_nop 7
    s_lshr_b32 s26, s20, 1
    s_and_b32 s27, s20, 1
    s_lshl_b32 s28, s21, 2
    s_add_u32 s28, s28, s26
    s_lshl_b32 s29, s22, 1
    s_add_u32 s29, s29, s27
    s_mul_i32 s30, s28, 14336
    s_lshl_b32 s31, s29, 10
    s_add_u32 s30, s30, s31
    s_add_u32 s31, s30, 6291456
    buffer_load_dwordx4 v[200:203], v5, s[8:11], s31 offen
    v_lshlrev_b32 v6, 3, v4
    s_lshl_b32 s31, s29, 6
    buffer_load_dwordx2 v[204:205], v6, s[12:15], s31 offen
    buffer_load_dwordx2 v[206:207], v6, s[12:15], s31 offen offset:32
    s_lshl_b32 s31, s20, 14
    v_add_u32 v9, s31, v5
    ds_write_b128 v9, v[16:19] offset:0
    ds_write_b128 v9, v[20:23] offset:1024
    ds_write_b128 v9, v[24:27] offset:2048
    ds_write_b128 v9, v[28:31] offset:3072
    ds_write_b128 v9, v[32:35] offset:4096
    ds_write_b128 v9, v[36:39] offset:5120
    ds_write_b128 v9, v[40:43] offset:6144
    ds_write_b128 v9, v[44:47] offset:7168
    ds_write_b128 v9, v[48:51] offset:8192
    ds_write_b128 v9, v[52:55] offset:9216
    ds_write_b128 v9, v[56:59] offset:10240
    ds_write_b128 v9, v[60:63] offset:11264
    ds_write_b128 v9, v[64:67] offset:12288
    ds_write_b128 v9, v[68:71] offset:13312
    ds_write_b128 v9, v[72:75] offset:14336
    ds_write_b128 v9, v[76:79] offset:15360
    s_waitcnt lgkmcnt(0)
    s_barrier
    s_lshl_b32 s31, s26, 12
    s_lshl_b32 s26, s27, 11
    s_add_u32 s31, s31, s26
    v_add_u32 v9, s31, v5
    v_add_u32 v10, 65536, v9
    ds_read_b128 v[16:19], v9 offset:0
    ds_read_b128 v[20:23], v9 offset:1024
    ds_read_b128 v[24:27], v9 offset:16384
    ds_read_b128 v[28:31], v9 offset:17408
    ds_read_b128 v[32:35], v9 offset:32768
    ds_read_b128 v[36:39], v9 offset:33792
    ds_read_b128 v[40:43], v9 offset:49152
    ds_read_b128 v[44:47], v9 offset:50176
    ds_read_b128 v[48:51], v10 offset:0
    ds_read_b128 v[52:55], v10 offset:1024
    ds_read_b128 v[56:59], v10 offset:16384
    ds_read_b128 v[60:63], v10 offset:17408
    ds_read_b128 v[64:67], v10 offset:32768
    ds_read_b128 v[68:71], v10 offset:33792
    ds_read_b128 v[72:75], v10 offset:49152
    ds_read_b128 v[76:79], v10 offset:50176
    s_waitcnt lgkmcnt(13)
    v_add_f32 v16, v16, v24
    v_add_f32 v17, v17, v25
    v_add_f32 v18, v18, v26
    v_add_f32 v19, v19, v27
    s_waitcnt lgkmcnt(12)
    v_add_f32 v20, v20, v28
    v_add_f32 v21, v21, v29
    v_add_f32 v22, v22, v30
    v_add_f32 v23, v23, v31
    s_waitcnt lgkmcnt(11)
    v_add_f32 v16, v16, v32
    v_add_f32 v17, v17, v33
    v_add_f32 v18, v18, v34
    v_add_f32 v19, v19, v35
    s_waitcnt lgkmcnt(10)
    v_add_f32 v20, v20, v36
    v_add_f32 v21, v21, v37
    v_add_f32 v22, v22, v38
    v_add_f32 v23, v23, v39
    s_waitcnt lgkmcnt(9)
    v_add_f32 v16, v16, v40
    v_add_f32 v17, v17, v41
    v_add_f32 v18, v18, v42
    v_add_f32 v19, v19, v43
    s_waitcnt lgkmcnt(8)
    v_add_f32 v20, v20, v44
    v_add_f32 v21, v21, v45
    v_add_f32 v22, v22, v46
    v_add_f32 v23, v23, v47
    s_waitcnt lgkmcnt(7)
    v_add_f32 v16, v16, v48
    v_add_f32 v17, v17, v49
    v_add_f32 v18, v18, v50
    v_add_f32 v19, v19, v51
    s_waitcnt lgkmcnt(6)
    v_add_f32 v20, v20, v52
    v_add_f32 v21, v21, v53
    v_add_f32 v22, v22, v54
    v_add_f32 v23, v23, v55
    s_waitcnt lgkmcnt(5)
    v_add_f32 v16, v16, v56
    v_add_f32 v17, v17, v57
    v_add_f32 v18, v18, v58
    v_add_f32 v19, v19, v59
    s_waitcnt lgkmcnt(4)
    v_add_f32 v20, v20, v60
    v_add_f32 v21, v21, v61
    v_add_f32 v22, v22, v62
    v_add_f32 v23, v23, v63
    s_waitcnt lgkmcnt(3)
    v_add_f32 v16, v16, v64
    v_add_f32 v17, v17, v65
    v_add_f32 v18, v18, v66
    v_add_f32 v19, v19, v67
    s_waitcnt lgkmcnt(2)
    v_add_f32 v20, v20, v68
    v_add_f32 v21, v21, v69
    v_add_f32 v22, v22, v70
    v_add_f32 v23, v23, v71
    s_waitcnt lgkmcnt(1)
    v_add_f32 v16, v16, v72
    v_add_f32 v17, v17, v73
    v_add_f32 v18, v18, v74
    v_add_f32 v19, v19, v75
    s_waitcnt lgkmcnt(0)
    v_add_f32 v20, v20, v76
    v_add_f32 v21, v21, v77
    v_add_f32 v22, v22, v78
    v_add_f32 v23, v23, v79
    v_cvt_pk_bf16_f32 v24, v16, v17
    v_cvt_pk_bf16_f32 v25, v18, v19
    v_cvt_pk_bf16_f32 v26, v20, v21
    v_cvt_pk_bf16_f32 v27, v22, v23
    v_lshlrev_b32 v16, 16, v24
    v_and_b32 v17, 4294901760, v24
    v_lshlrev_b32 v18, 16, v25
    v_and_b32 v19, 4294901760, v25
    v_lshlrev_b32 v20, 16, v26
    v_and_b32 v21, 4294901760, v26
    v_lshlrev_b32 v22, 16, v27
    v_and_b32 v23, 4294901760, v27
    s_waitcnt vmcnt(1)
    v_lshlrev_b32 v24, 16, v204
    v_and_b32 v25, 4294901760, v204
    v_lshlrev_b32 v26, 16, v205
    v_and_b32 v27, 4294901760, v205
    s_waitcnt vmcnt(0)
    v_lshlrev_b32 v28, 16, v206
    v_and_b32 v29, 4294901760, v206
    v_lshlrev_b32 v30, 16, v207
    v_and_b32 v31, 4294901760, v207
    v_add_f32 v16, v16, v24
    v_add_f32 v17, v17, v25
    v_add_f32 v18, v18, v26
    v_add_f32 v19, v19, v27
    v_add_f32 v20, v20, v28
    v_add_f32 v21, v21, v29
    v_add_f32 v22, v22, v30
    v_add_f32 v23, v23, v31
    v_cvt_pk_bf16_f32 v24, v16, v17
    v_cvt_pk_bf16_f32 v25, v18, v19
    v_cvt_pk_bf16_f32 v26, v20, v21
    v_cvt_pk_bf16_f32 v27, v22, v23
    v_lshlrev_b32 v16, 16, v24
    v_and_b32 v17, 4294901760, v24
    v_lshlrev_b32 v18, 16, v25
    v_and_b32 v19, 4294901760, v25
    v_lshlrev_b32 v20, 16, v26
    v_and_b32 v21, 4294901760, v26
    v_lshlrev_b32 v22, 16, v27
    v_and_b32 v23, 4294901760, v27
    v_lshlrev_b32 v24, 16, v200
    v_and_b32 v25, 4294901760, v200
    v_lshlrev_b32 v26, 16, v201
    v_and_b32 v27, 4294901760, v201
    v_lshlrev_b32 v28, 16, v202
    v_and_b32 v29, 4294901760, v202
    v_lshlrev_b32 v30, 16, v203
    v_and_b32 v31, 4294901760, v203
    v_add_f32 v16, v16, v24
    v_add_f32 v17, v17, v25
    v_add_f32 v18, v18, v26
    v_add_f32 v19, v19, v27
    v_add_f32 v20, v20, v28
    v_add_f32 v21, v21, v29
    v_add_f32 v22, v22, v30
    v_add_f32 v23, v23, v31
    v_cvt_pk_bf16_f32 v32, v16, v17
    v_cvt_pk_bf16_f32 v33, v18, v19
    v_cvt_pk_bf16_f32 v34, v20, v21
    v_cvt_pk_bf16_f32 v35, v22, v23
    v_mul_u32_u24 v6, 896, v3
    v_lshl_add_u32 v6, v4, 3, v6
    s_mul_i32 s31, s28, 14336
    s_lshl_b32 s26, s29, 6
    s_add_u32 s31, s31, s26
    buffer_store_dwordx2 v[32:33], v6, s[16:19], s31 offen
    buffer_store_dwordx2 v[34:35], v6, s[16:19], s31 offen offset:32
    s_nop 4
L_end_k4b_kernel:
    s_endpgm

.section .rodata,"a"
.p2align 6
.amdhsa_kernel k1a_kernel
  .amdhsa_next_free_vgpr 256
  .amdhsa_next_free_sgpr 100
  .amdhsa_accum_offset 256
  .amdhsa_group_segment_fixed_size 0
  .amdhsa_kernarg_size 96
  .amdhsa_user_sgpr_count 2
  .amdhsa_user_sgpr_kernarg_segment_ptr 1
  .amdhsa_system_sgpr_workgroup_id_x 1
.end_amdhsa_kernel
.p2align 6
.amdhsa_kernel k2a_kernel
  .amdhsa_next_free_vgpr 256
  .amdhsa_next_free_sgpr 50
  .amdhsa_accum_offset 256
  .amdhsa_group_segment_fixed_size 0
  .amdhsa_kernarg_size 96
  .amdhsa_user_sgpr_count 2
  .amdhsa_user_sgpr_kernarg_segment_ptr 1
  .amdhsa_system_sgpr_workgroup_id_x 1
.end_amdhsa_kernel
.p2align 6
.amdhsa_kernel k3a_kernel
  .amdhsa_next_free_vgpr 248
  .amdhsa_next_free_sgpr 48
  .amdhsa_accum_offset 248
  .amdhsa_group_segment_fixed_size 0
  .amdhsa_kernarg_size 96
  .amdhsa_user_sgpr_count 2
  .amdhsa_user_sgpr_kernarg_segment_ptr 1
  .amdhsa_system_sgpr_workgroup_id_x 1
.end_amdhsa_kernel
.p2align 6
.amdhsa_kernel k4a_kernel
  .amdhsa_next_free_vgpr 224
  .amdhsa_next_free_sgpr 48
  .amdhsa_accum_offset 224
  .amdhsa_group_segment_fixed_size 0
  .amdhsa_kernarg_size 96
  .amdhsa_user_sgpr_count 2
  .amdhsa_user_sgpr_kernarg_segment_ptr 1
  .amdhsa_system_sgpr_workgroup_id_x 1
.end_amdhsa_kernel
.p2align 6
.amdhsa_kernel k1b_kernel
  .amdhsa_next_free_vgpr 256
  .amdhsa_next_free_sgpr 57
  .amdhsa_accum_offset 256
  .amdhsa_group_segment_fixed_size 0
  .amdhsa_kernarg_size 96
  .amdhsa_user_sgpr_count 2
  .amdhsa_user_sgpr_kernarg_segment_ptr 1
  .amdhsa_system_sgpr_workgroup_id_x 1
.end_amdhsa_kernel
.p2align 6
.amdhsa_kernel k2b_kernel
  .amdhsa_next_free_vgpr 256
  .amdhsa_next_free_sgpr 50
  .amdhsa_accum_offset 256
  .amdhsa_group_segment_fixed_size 0
  .amdhsa_kernarg_size 96
  .amdhsa_user_sgpr_count 2
  .amdhsa_user_sgpr_kernarg_segment_ptr 1
  .amdhsa_system_sgpr_workgroup_id_x 1
.end_amdhsa_kernel
.p2align 6
.amdhsa_kernel k3b_kernel
  .amdhsa_next_free_vgpr 248
  .amdhsa_next_free_sgpr 48
  .amdhsa_accum_offset 248
  .amdhsa_group_segment_fixed_size 0
  .amdhsa_kernarg_size 96
  .amdhsa_user_sgpr_count 2
  .amdhsa_user_sgpr_kernarg_segment_ptr 1
  .amdhsa_system_sgpr_workgroup_id_x 1
.end_amdhsa_kernel
.p2align 6
.amdhsa_kernel k4b_kernel
  .amdhsa_next_free_vgpr 208
  .amdhsa_next_free_sgpr 32
  .amdhsa_accum_offset 208
  .amdhsa_group_segment_fixed_size 0
  .amdhsa_kernarg_size 96
  .amdhsa_user_sgpr_count 2
  .amdhsa_user_sgpr_kernarg_segment_ptr 1
  .amdhsa_system_sgpr_workgroup_id_x 1
.end_amdhsa_kernel
```
